```python
import torch

def _softmax(x, axis=-1):
    return torch.softmax(x, dim=axis)
def _gelu(x):
    return torch.nn.functional.gelu(x, approximate="tanh")
def _silu(x):
    return torch.nn.functional.silu(x)
def _sigmoid(x):
    return torch.sigmoid(x)
def _layernorm(x, axis=-1, eps=1e-5):
    m = x.mean(dim=axis, keepdim=True)
    v = x.var(dim=axis, keepdim=True, unbiased=False)
    return (x - m) / torch.sqrt(v + eps)
def _scatter_add(tgt, idx, src, axis=0):
    return tgt.clone().index_add_(axis, idx, src)
def _segment_sum(src, seg, n):
    out = torch.zeros((n,) + src.shape[1:], dtype=src.dtype)
    return out.index_add_(0, seg, src)
def _pad(x, pw):
    flat = tuple(v for pair in reversed(pw) for v in pair)
    return torch.nn.functional.pad(x, flat)

kernel_name = 'gated_mix__sliding_local_dilated__glu_gated_glu__prompt'

def setup_inputs():

    _w = (lambda a: (lambda t: t.to(torch.bfloat16) if t.is_floating_point() else t)(torch.as_tensor(a)))
    def _A_setup():
        B, S, D = 1, 2048, 512
        return {
            "x": _w((lambda *s: torch.randn(*s, dtype=torch.bfloat16) * 0.05)(B, S, D)),
            "wqkv": _w((lambda *s: torch.randn(*s, dtype=torch.bfloat16) * 0.8)(D, 3 * D)),
            "wo": _w((lambda *s: torch.randn(*s, dtype=torch.bfloat16) * 0.05)(D, D)),
        }
    _A_in = _A_setup()

    def _B_setup():
        B, S, D, F = 1, 2048, 512, 1792
        return {
            "x": _w((lambda *s: torch.randn(*s, dtype=torch.bfloat16) * 0.05)(B, S, D)),
            "w_gate": _w((lambda *s: torch.randn(*s, dtype=torch.bfloat16) * 3.2)(D, F)),
            "w_up": _w((lambda *s: torch.randn(*s, dtype=torch.bfloat16) * 0.1)(D, F)),
            "w_down": _w((lambda *s: torch.randn(*s, dtype=torch.bfloat16) * 0.1)(F, D)),
        }
    _B_in = _B_setup()

    return {
        "A_x": _A_in["x"],
        "A_wqkv": _A_in["wqkv"],
        "A_wo": _A_in["wo"],
        "B_x": _B_in["x"],
        "B_w_gate": _B_in["w_gate"],
        "B_w_up": _B_in["w_up"],
        "B_w_down": _B_in["w_down"],
        "gate_w": _w((lambda *s: torch.randn(*s, dtype=torch.bfloat16) * 0.05)(512) * 16.0),
    }

def reference(A_x, A_wqkv, A_wo, B_x, B_w_gate, B_w_up, B_w_down, gate_w):
    def _A_ref(x, wqkv, wo):
        B, S, D = x.shape
        H = 32; Dh = D // H
        W, dil = 8, 2
        qkv = (lambda x, *d: x.permute(*d))((x @ wqkv).reshape(B, S, 3, H, Dh), 2, 0, 3, 1, 4)
        q, k, v = qkv[0], qkv[1], qkv[2]
        scale = Dh ** -0.5
        pos = torch.arange(S)
        off = torch.arange(W) * dil
        idx = pos[:, None] - off[None, :]
        mask = idx >= 0
        idx_c = torch.where(mask, idx, 0).reshape(-1)
        kg = k[:, :, idx_c, :].reshape(B, H, S, W, Dh)
        vg = v[:, :, idx_c, :].reshape(B, H, S, W, Dh)
        logits = torch.einsum("bhsd,bhswd->bhsw", q, kg) * scale
        logits = torch.where(mask[None, None, :, :], logits, -1e9)
        attn = _softmax(logits, axis=-1)
        o = torch.einsum("bhsw,bhswd->bhsd", attn, vg)
        return (lambda x, *d: x.permute(*d))(o, 0, 2, 1, 3).reshape(B, S, D) @ wo

    def _B_ref(x, w_gate, w_up, w_down):
        g = torch.einsum("bsd,df->bsf", x, w_gate)
        u = torch.einsum("bsd,df->bsf", x, w_up)
        h = _sigmoid(g) * u
        return torch.einsum("bsf,fd->bsd", h, w_down)

    x = A_x
    g = _sigmoid((x * gate_w).sum(-1, keepdims=True))
    a = _A_ref(x, A_wqkv, A_wo)
    b = _B_ref(x, B_w_gate, B_w_up, B_w_down)
    return g * a + (1 - g) * b
```

```asm
; @launch grid=(256,1,1) block=(256,1,1) lds=163840
.amdgcn_target "amdgcn-amd-amdhsa--gfx950"
.text
.globl gated_mix__sliding_local_dilated__glu_gated_glu__prompt_kernel
.p2align 8
.type gated_mix__sliding_local_dilated__glu_gated_glu__prompt_kernel,@function
gated_mix__sliding_local_dilated__glu_gated_glu__prompt_kernel:
  s_cmp_ge_u32 s2, 256
  s_cbranch_scc1 L_done
  s_cmp_ge_u32 s2, 168
  s_cselect_b32 s75, 8, 32
  s_load_dwordx2 s[8:9], s[0:1], s75
  s_load_dwordx2 s[12:13], s[0:1], 40
  s_load_dwordx2 s[4:5], s[0:1], 0
  s_load_dwordx16 s[36:51], s[0:1], 0
  s_load_dwordx4 s[52:55], s[0:1], 64
  s_load_dwordx2 s[56:57], s[0:1], 80
  s_mov_b32 s14, 1835008
  s_cselect_b32 s10, 1572864, s14
  s_mov_b32 s11, 0x20000
  s_mov_b32 s15, s11
  s_mov_b32 s7, s11
  s_mov_b32 s6, 0x200000
  s_getpc_b64 s[72:73]
  s_lshr_b32 s70, s2, 3
  s_lshl_b32 s74, s70, 7
  v_lshrrev_b32 v247, 6, v0
  v_and_b32 v246, 3, v0
  v_min_u32 v246, 2, v246
  v_mad_u32_u24 v247, v247, 3, v246
  v_lshlrev_b32 v247, 12, v247
  v_add_u32 v247, s74, v247
  global_load_dword v246, v247, s[72:73]
  v_lshrrev_b32 v250, 6, v0
  v_and_b32 v208, 63, v0
  v_readfirstlane_b32 s68, v250
  v_lshlrev_b32 v209, 4, v208
  s_and_b32 s69, s2, 7
  s_cmp_ge_u32 s70, 21
  s_cbranch_scc1 L_qkv
  s_lshr_b32 s72, s69, 1
  s_mul_i32 s72, s72, 21
  s_add_u32 s72, s72, s70
  s_mul_i32 s79, s72, 10923
  s_lshr_b32 s79, s79, 16
  s_mul_i32 s78, s79, 6
  s_sub_u32 s78, s72, s78
  s_add_u32 s72, s79, s78
  s_and_b32 s90, s72, 3
  s_and_b32 s95, s72, 1
  s_lshl_b32 s76, s68, 12
  s_and_b32 s74, s68, 1
  s_lshl_b32 s75, s74, 2
  v_lshrrev_b32 v248, 4, v208
  v_or_b32 v249, s75, v248
  v_lshlrev_b32 v250, 5, v249
  v_xor_b32 v250, v250, v209
  v_and_b32 v250, 0xff, v250
  v_lshl_add_u32 v251, s68, 3, v248
  v_mul_u32_u24 v251, 3584, v251
  s_lshl_b32 s72, s79, 8
  v_add3_u32 v176, v251, v250, s72
  v_add_u32 v177, 14336, v176
  s_xor_b32 s80, s95, 0
  s_mul_i32 s80, s80, 114688
  s_add_u32 m0, s76, 0
  s_waitcnt lgkmcnt(0)
  buffer_load_dwordx4 v176, s[8:11], s80 offen lds
  s_add_u32 m0, s76, 1024
  s_nop 0
  buffer_load_dwordx4 v177, s[8:11], s80 offen lds
  s_add_u32 m0, s76, 2048
  s_nop 0
  buffer_load_dwordx4 v176, s[12:15], s80 offen lds
  s_add_u32 m0, s76, 3072
  s_nop 0
  buffer_load_dwordx4 v177, s[12:15], s80 offen lds
  s_lshr_b32 s91, s90, 1
  s_lshl_b32 s91, s91, 7
  s_and_b32 s93, s90, 1
  s_lshl_b32 s93, s93, 6
  s_and_b32 s85, s69, 1
  s_mul_i32 s85, s85, 66
  s_lshl_b32 s77, s68, 10
  s_lshl_b32 s74, s74, 3
  v_and_b32 v250, 7, v208
  v_xor_b32 v250, v250, v249
  v_lshlrev_b32 v250, 4, v250
  v_lshrrev_b32 v251, 3, v208
  v_add_u32 v251, s74, v251
  v_lshl_add_u32 v250, v251, 10, v250
  s_cmp_ge_u32 s79, 5
  s_cselect_b32 s73, 32, 0
  s_add_u32 s72, s78, 54
  s_sub_u32 s72, s72, s73
  s_mul_i32 s82, s72, 10923
  s_lshr_b32 s82, s82, 16
  s_mul_i32 s83, s82, 6
  s_sub_u32 s83, s72, s83
  s_add_u32 s73, s73, s83
  v_mad_u32_u24 v251, v208, 6, s73
  v_subrev_u32 v252, 66, v251
  v_min_u32 v251, v251, v252
  v_mul_u32_u24 v252, 5958, v251
  v_lshrrev_b32 v252, 16, v252
  v_mul_u32_u24 v185, 6, v251
  v_mul_u32_u24 v252, 65, v252
  v_sub_u32 v185, v185, v252
  v_add_u32 v185, s85, v185
  v_cmp_lt_u32 vcc, 10, v208
  v_mov_b32 v252, 0x8000
  s_lshr_b32 s82, s68, 1
  v_cndmask_b32 v185, v185, v252, vcc
  v_lshlrev_b32 v252, 14, v185
  s_and_b32 s83, s90, 1
  s_mul_i32 s72, s83, 12288
  s_sub_u32 s94, s77, s72
  s_add_u32 s77, s77, s72
  s_mul_i32 s83, s83, 6
  s_add_u32 s82, s82, s83
  s_lshl_b32 s83, s83, 1
  v_readlane_b32 s72, v252, s82
  s_add_u32 s82, s82, 2
  v_readlane_b32 s73, v252, s82
  s_add_u32 s82, s82, 2
  v_add_u32 v178, s72, v250
  v_readlane_b32 s72, v252, s82
  s_add_u32 s82, s82, 2
  v_add_u32 v179, s73, v250
  s_sub_u32 s82, s82, s83
  v_readlane_b32 s73, v252, s82
  s_add_u32 s82, s82, 2
  v_add_u32 v180, s72, v250
  v_readlane_b32 s72, v252, s82
  s_add_u32 s82, s82, 2
  v_add_u32 v181, s73, v250
  v_readlane_b32 s73, v252, s82
  s_add_u32 s82, s82, 2
  v_add_u32 v182, s72, v250
  s_nop 0
  v_add_u32 v183, s73, v250
  s_mov_b32 s92, 0
  s_add_u32 m0, s77, 81920
  s_nop 0
  buffer_load_dwordx4 v178, s[4:7], s92 offen lds
  s_add_u32 m0, s77, 86016
  s_nop 0
  buffer_load_dwordx4 v179, s[4:7], s92 offen lds
  s_add_u32 m0, s77, 90112
  s_nop 0
  buffer_load_dwordx4 v180, s[4:7], s92 offen lds
  s_add_u32 m0, s94, 94208
  s_nop 0
  buffer_load_dwordx4 v181, s[4:7], s92 offen lds
  s_add_u32 m0, s94, 98304
  s_nop 0
  buffer_load_dwordx4 v182, s[4:7], s92 offen lds
  s_add_u32 m0, s94, 102400
  s_nop 0
  buffer_load_dwordx4 v183, s[4:7], s92 offen lds
  v_mov_b32 v244, 0
  global_load_dword v245, v244, s[48:49]
  global_load_dword v245, v244, s[40:41]
  v_lshrrev_b32 v249, 2, v208
  v_and_b32 v249, 3, v249
  v_and_b32 v250, 1, v248
  v_lshl_or_b32 v250, v250, 2, v249
  s_lshl_b32 s72, s68, 1
  v_xor_b32 v250, s72, v250
  v_lshlrev_b32 v250, 5, v250
  v_lshl_add_u32 v250, v248, 12, v250
  v_lshl_add_u32 v250, v249, 8, v250
  v_and_b32 v251, 3, v208
  v_lshl_add_u32 v186, v251, 3, v250
  v_xor_b32 v187, 32, v186
  v_add_u32 v188, 0x10000, v186
  v_add_u32 v189, 0x10000, v187
  v_and_b32 v249, 15, v208
  v_lshrrev_b32 v250, 1, v249
  v_xor_b32 v250, v250, v248
  v_lshlrev_b32 v250, 4, v250
  v_lshl_add_u32 v250, v249, 7, v250
  v_xor_b32 v250, s93, v250
  v_xor_b32 v251, 64, v250
  v_add_u32 v190, 81920, v250
  v_add_u32 v191, 81920, v251
  v_add_u32 v192, 106496, v250
  v_add_u32 v193, 106496, v251
  v_add_u32 v194, 131072, v250
  v_add_u32 v195, 131072, v251
  s_and_b32 s72, s69, 6
  s_cmp_lg_u32 s72, 2
  s_cbranch_scc1 L_h3ffn
  s_lshl_b32 s72, s70, 2
  s_add_u32 s72, s72, s68
  s_mul_i32 s72, s72, 12288
  v_min_u32 v243, 11, v208
  v_lshlrev_b32 v243, 10, v243
  v_add_u32 v243, s72, v243
  global_load_dword v242, v243, s[38:39] offset:384
L_h3ffn:
  s_xor_b32 s80, s95, 1
  s_mul_i32 s80, s80, 114688
  s_add_u32 m0, s76, 16384
  s_nop 0
  buffer_load_dwordx4 v176, s[8:11], s80 offen lds
  s_add_u32 m0, s76, 17408
  s_nop 0
  buffer_load_dwordx4 v177, s[8:11], s80 offen lds
  s_add_u32 m0, s76, 18432
  s_nop 0
  buffer_load_dwordx4 v176, s[12:15], s80 offen lds
  s_add_u32 m0, s76, 19456
  s_nop 0
  buffer_load_dwordx4 v177, s[12:15], s80 offen lds
  s_xor_b32 s92, s91, 0
  s_add_u32 s92, s92, 128
  s_add_u32 m0, s77, 106496
  s_nop 0
  buffer_load_dwordx4 v178, s[4:7], s92 offen lds
  s_add_u32 m0, s77, 110592
  s_nop 0
  buffer_load_dwordx4 v179, s[4:7], s92 offen lds
  s_add_u32 m0, s77, 114688
  s_nop 0
  buffer_load_dwordx4 v180, s[4:7], s92 offen lds
  s_add_u32 m0, s94, 118784
  s_nop 0
  buffer_load_dwordx4 v181, s[4:7], s92 offen lds
  s_add_u32 m0, s94, 122880
  s_nop 0
  buffer_load_dwordx4 v182, s[4:7], s92 offen lds
  s_add_u32 m0, s94, 126976
  s_nop 0
  buffer_load_dwordx4 v183, s[4:7], s92 offen lds
  s_xor_b32 s80, s90, 0
  s_add_u32 s80, s80, 2
  s_mul_i32 s80, s80, 114688
  s_add_u32 m0, s76, 32768
  s_nop 0
  buffer_load_dwordx4 v176, s[8:11], s80 offen lds
  s_add_u32 m0, s76, 33792
  s_nop 0
  buffer_load_dwordx4 v177, s[8:11], s80 offen lds
  s_add_u32 m0, s76, 34816
  s_nop 0
  buffer_load_dwordx4 v176, s[12:15], s80 offen lds
  s_add_u32 m0, s76, 35840
  s_nop 0
  buffer_load_dwordx4 v177, s[12:15], s80 offen lds
  s_waitcnt vmcnt(16)
  s_barrier
  ds_read_b64_tr_b16 a[104:105], v186 offset:0
  ds_read_b64_tr_b16 a[106:107], v186 offset:1024
  ds_read_b64_tr_b16 a[108:109], v187 offset:0
  ds_read_b64_tr_b16 a[110:111], v187 offset:1024
  ds_read_b64_tr_b16 a[112:113], v186 offset:2048
  ds_read_b64_tr_b16 a[114:115], v186 offset:3072
  ds_read_b64_tr_b16 a[116:117], v187 offset:2048
  ds_read_b64_tr_b16 a[118:119], v187 offset:3072
  ds_read_b128 a[168:171], v190 offset:0
  ds_read_b128 a[172:175], v191 offset:0
  ds_read_b128 a[176:179], v190 offset:2048
  ds_read_b128 a[180:183], v191 offset:2048
  ds_read_b128 a[184:187], v190 offset:4096
  ds_read_b128 a[188:191], v191 offset:4096
  ds_read_b128 a[192:195], v190 offset:6144
  ds_read_b128 a[196:199], v191 offset:6144
  ds_read_b128 a[200:203], v190 offset:8192
  ds_read_b128 a[204:207], v191 offset:8192
  ds_read_b128 a[208:211], v190 offset:10240
  ds_read_b128 a[212:215], v191 offset:10240
  ds_read_b128 a[216:219], v190 offset:12288
  ds_read_b128 a[220:223], v191 offset:12288
  ds_read_b128 a[224:227], v190 offset:14336
  ds_read_b128 a[228:231], v191 offset:14336
  ds_read_b128 a[232:235], v190 offset:16384
  ds_read_b128 a[236:239], v191 offset:16384
  ds_read_b128 a[240:243], v190 offset:18432
  ds_read_b128 a[244:247], v191 offset:18432
  ds_read_b128 a[248:251], v190 offset:20480
  ds_read_b128 a[252:255], v191 offset:20480
  s_waitcnt vmcnt(10)
  s_barrier
  ds_read_b64_tr_b16 a[120:121], v186 offset:16384
  ds_read_b64_tr_b16 a[122:123], v186 offset:17408
  ds_read_b64_tr_b16 a[124:125], v187 offset:16384
  ds_read_b64_tr_b16 a[126:127], v187 offset:17408
  ds_read_b64_tr_b16 a[128:129], v186 offset:18432
  ds_read_b64_tr_b16 a[130:131], v186 offset:19456
  ds_read_b64_tr_b16 a[132:133], v187 offset:18432
  ds_read_b64_tr_b16 a[134:135], v187 offset:19456
  s_waitcnt lgkmcnt(0)
  v_mfma_f32_16x16x32_bf16 v[0:3], a[104:107], a[168:171], 0
  s_lshl_b32 s72, s2, 13
  s_lshl_b32 s73, s68, 11
  s_add_u32 s72, s72, s73
  v_mfma_f32_16x16x32_bf16 v[0:3], a[120:123], a[172:175], v[0:3]
  buffer_load_dwordx4 v[224:227], v209, s[4:7], s72 offen
  v_mfma_f32_16x16x32_bf16 v[4:7], a[124:127], a[172:175], 0
  v_mfma_f32_16x16x32_bf16 v[4:7], a[108:111], a[168:171], v[4:7]
  v_mfma_f32_16x16x32_bf16 v[8:11], a[112:115], a[168:171], 0
  v_mfma_f32_16x16x32_bf16 v[8:11], a[128:131], a[172:175], v[8:11]
  v_mfma_f32_16x16x32_bf16 v[12:15], a[132:135], a[172:175], 0
  buffer_load_dwordx4 v[228:231], v209, s[4:7], s72 offen offset:1024
  v_mfma_f32_16x16x32_bf16 v[12:15], a[116:119], a[168:171], v[12:15]
  v_mfma_f32_16x16x32_bf16 v[28:31], a[116:119], a[176:179], 0
  v_mfma_f32_16x16x32_bf16 v[28:31], a[132:135], a[180:183], v[28:31]
  v_mfma_f32_16x16x32_bf16 v[24:27], a[128:131], a[180:183], 0
  v_mfma_f32_16x16x32_bf16 v[24:27], a[112:115], a[176:179], v[24:27]
  v_mfma_f32_16x16x32_bf16 v[20:23], a[108:111], a[176:179], 0
  global_load_dwordx4 v[232:235], v209, s[50:51]
  s_lshr_b32 s3, s72, 7
  v_mfma_f32_16x16x32_bf16 v[20:23], a[124:127], a[180:183], v[20:23]
  v_mfma_f32_16x16x32_bf16 v[16:19], a[120:123], a[180:183], 0
  v_mfma_f32_16x16x32_bf16 v[16:19], a[104:107], a[176:179], v[16:19]
  v_mfma_f32_16x16x32_bf16 v[32:35], a[104:107], a[184:187], 0
  v_mfma_f32_16x16x32_bf16 v[32:35], a[120:123], a[188:191], v[32:35]
  v_mfma_f32_16x16x32_bf16 v[36:39], a[124:127], a[188:191], 0
  v_mfma_f32_16x16x32_bf16 v[36:39], a[108:111], a[184:187], v[36:39]
  v_mfma_f32_16x16x32_bf16 v[40:43], a[112:115], a[184:187], 0
  v_mfma_f32_16x16x32_bf16 v[40:43], a[128:131], a[188:191], v[40:43]
  v_mfma_f32_16x16x32_bf16 v[44:47], a[132:135], a[188:191], 0
  v_mfma_f32_16x16x32_bf16 v[44:47], a[116:119], a[184:187], v[44:47]
  v_mfma_f32_16x16x32_bf16 v[60:63], a[116:119], a[192:195], 0
  v_mfma_f32_16x16x32_bf16 v[60:63], a[132:135], a[196:199], v[60:63]
  v_mfma_f32_16x16x32_bf16 v[56:59], a[128:131], a[196:199], 0
  v_mfma_f32_16x16x32_bf16 v[56:59], a[112:115], a[192:195], v[56:59]
  v_mfma_f32_16x16x32_bf16 v[52:55], a[108:111], a[192:195], 0
  v_mfma_f32_16x16x32_bf16 v[52:55], a[124:127], a[196:199], v[52:55]
  v_mfma_f32_16x16x32_bf16 v[48:51], a[120:123], a[196:199], 0
  v_mfma_f32_16x16x32_bf16 v[48:51], a[104:107], a[192:195], v[48:51]
  v_mfma_f32_16x16x32_bf16 v[64:67], a[104:107], a[200:203], 0
  v_mfma_f32_16x16x32_bf16 v[64:67], a[120:123], a[204:207], v[64:67]
  v_mfma_f32_16x16x32_bf16 v[68:71], a[124:127], a[204:207], 0
  s_xor_b32 s80, s90, 1
  s_add_u32 s80, s80, 2
  s_mul_i32 s80, s80, 114688
  s_add_u32 m0, s76, 49152
  v_mfma_f32_16x16x32_bf16 v[68:71], a[108:111], a[200:203], v[68:71]
  buffer_load_dwordx4 v176, s[8:11], s80 offen lds
  s_add_u32 m0, s76, 50176
  v_mfma_f32_16x16x32_bf16 v[72:75], a[112:115], a[200:203], 0
  buffer_load_dwordx4 v177, s[8:11], s80 offen lds
  v_mfma_f32_16x16x32_bf16 v[72:75], a[128:131], a[204:207], v[72:75]
  s_add_u32 m0, s76, 51200
  v_mfma_f32_16x16x32_bf16 v[76:79], a[132:135], a[204:207], 0
  buffer_load_dwordx4 v176, s[12:15], s80 offen lds
  v_mfma_f32_16x16x32_bf16 v[76:79], a[116:119], a[200:203], v[76:79]
  s_add_u32 m0, s76, 52224
  v_mfma_f32_16x16x32_bf16 v[92:95], a[116:119], a[208:211], 0
  buffer_load_dwordx4 v177, s[12:15], s80 offen lds
  v_mfma_f32_16x16x32_bf16 v[92:95], a[132:135], a[212:215], v[92:95]
  v_mfma_f32_16x16x32_bf16 v[88:91], a[128:131], a[212:215], 0
  s_waitcnt vmcnt(7)
  s_barrier
  v_mfma_f32_16x16x32_bf16 v[88:91], a[112:115], a[208:211], v[88:91]
  ds_read_b64_tr_b16 a[136:137], v186 offset:32768
  v_mfma_f32_16x16x32_bf16 v[84:87], a[108:111], a[208:211], 0
  s_xor_b32 s92, s91, 128
  s_add_u32 s92, s92, 128
  s_add_u32 m0, s77, 131072
  v_mfma_f32_16x16x32_bf16 v[84:87], a[124:127], a[212:215], v[84:87]
  buffer_load_dwordx4 v178, s[4:7], s92 offen lds
  ds_read_b64_tr_b16 a[138:139], v186 offset:33792
  v_mfma_f32_16x16x32_bf16 v[80:83], a[120:123], a[212:215], 0
  ds_read_b64_tr_b16 a[140:141], v187 offset:32768
  ds_read_b128 a[168:171], v192 offset:0
  v_mfma_f32_16x16x32_bf16 v[80:83], a[104:107], a[208:211], v[80:83]
  s_add_u32 m0, s77, 135168
  ds_read_b64_tr_b16 a[142:143], v187 offset:33792
  ds_read_b128 a[172:175], v193 offset:0
  v_mfma_f32_16x16x32_bf16 v[96:99], a[104:107], a[216:219], 0
  buffer_load_dwordx4 v179, s[4:7], s92 offen lds
  ds_read_b128 a[176:179], v192 offset:2048
  v_mfma_f32_16x16x32_bf16 v[96:99], a[120:123], a[220:223], v[96:99]
  ds_read_b64_tr_b16 a[144:145], v186 offset:34816
  ds_read_b128 a[180:183], v193 offset:2048
  v_mfma_f32_16x16x32_bf16 v[100:103], a[124:127], a[220:223], 0
  s_add_u32 m0, s77, 139264
  ds_read_b128 a[184:187], v192 offset:4096
  v_mfma_f32_16x16x32_bf16 v[100:103], a[108:111], a[216:219], v[100:103]
  buffer_load_dwordx4 v180, s[4:7], s92 offen lds
  ds_read_b64_tr_b16 a[146:147], v186 offset:35840
  v_mfma_f32_16x16x32_bf16 v[104:107], a[112:115], a[216:219], 0
  ds_read_b64_tr_b16 a[148:149], v187 offset:34816
  ds_read_b128 a[188:191], v193 offset:4096
  v_mfma_f32_16x16x32_bf16 v[104:107], a[128:131], a[220:223], v[104:107]
  s_add_u32 m0, s94, 143360
  ds_read_b128 a[192:195], v192 offset:6144
  v_mfma_f32_16x16x32_bf16 v[108:111], a[132:135], a[220:223], 0
  buffer_load_dwordx4 v181, s[4:7], s92 offen lds
  ds_read_b64_tr_b16 a[150:151], v187 offset:35840
  v_mfma_f32_16x16x32_bf16 v[108:111], a[116:119], a[216:219], v[108:111]
  ds_read_b128 a[196:199], v193 offset:6144
  v_mfma_f32_16x16x32_bf16 v[124:127], a[116:119], a[224:227], 0
  s_add_u32 m0, s94, 147456
  ds_read_b128 a[200:203], v192 offset:8192
  v_mfma_f32_16x16x32_bf16 v[124:127], a[132:135], a[228:231], v[124:127]
  buffer_load_dwordx4 v182, s[4:7], s92 offen lds
  ds_read_b128 a[204:207], v193 offset:8192
  v_mfma_f32_16x16x32_bf16 v[120:123], a[128:131], a[228:231], 0
  ds_read_b128 a[208:211], v192 offset:10240
  v_mfma_f32_16x16x32_bf16 v[120:123], a[112:115], a[224:227], v[120:123]
  s_add_u32 m0, s94, 151552
  ds_read_b128 a[212:215], v193 offset:10240
  v_mfma_f32_16x16x32_bf16 v[116:119], a[108:111], a[224:227], 0
  buffer_load_dwordx4 v183, s[4:7], s92 offen lds
  s_xor_b32 s80, s90, 2
  s_add_u32 s80, s80, 2
  v_mfma_f32_16x16x32_bf16 v[116:119], a[124:127], a[228:231], v[116:119]
  s_mul_i32 s80, s80, 114688
  ds_read_b128 a[216:219], v192 offset:12288
  v_mfma_f32_16x16x32_bf16 v[112:115], a[120:123], a[228:231], 0
  s_add_u32 m0, s76, 65536
  ds_read_b128 a[220:223], v193 offset:12288
  v_mfma_f32_16x16x32_bf16 v[112:115], a[104:107], a[224:227], v[112:115]
  buffer_load_dwordx4 v176, s[8:11], s80 offen lds
  v_mfma_f32_16x16x32_bf16 v[128:131], a[104:107], a[232:235], 0
  ds_read_b128 a[224:227], v192 offset:14336
  v_mfma_f32_16x16x32_bf16 v[128:131], a[120:123], a[236:239], v[128:131]
  s_add_u32 m0, s76, 66560
  ds_read_b128 a[228:231], v193 offset:14336
  v_mfma_f32_16x16x32_bf16 v[132:135], a[124:127], a[236:239], 0
  buffer_load_dwordx4 v177, s[8:11], s80 offen lds
  v_mfma_f32_16x16x32_bf16 v[132:135], a[108:111], a[232:235], v[132:135]
  v_mfma_f32_16x16x32_bf16 v[136:139], a[112:115], a[232:235], 0
  s_add_u32 m0, s76, 67584
  v_mfma_f32_16x16x32_bf16 v[136:139], a[128:131], a[236:239], v[136:139]
  buffer_load_dwordx4 v176, s[12:15], s80 offen lds
  v_mfma_f32_16x16x32_bf16 v[140:143], a[132:135], a[236:239], 0
  v_mfma_f32_16x16x32_bf16 v[140:143], a[116:119], a[232:235], v[140:143]
  s_add_u32 m0, s76, 68608
  s_waitcnt vmcnt(9) lgkmcnt(9)
  s_barrier
  v_mfma_f32_16x16x32_bf16 v[156:159], a[116:119], a[240:243], 0
  buffer_load_dwordx4 v177, s[12:15], s80 offen lds
  s_xor_b32 s80, s90, 3
  s_add_u32 s80, s80, 2
  v_mfma_f32_16x16x32_bf16 v[156:159], a[132:135], a[244:247], v[156:159]
  s_mul_i32 s80, s80, 114688
  ds_read_b64_tr_b16 a[152:153], v186 offset:49152
  ds_read_b64_tr_b16 a[154:155], v186 offset:50176
  v_mfma_f32_16x16x32_bf16 v[152:155], a[128:131], a[244:247], 0
  s_add_u32 m0, s76, 0
  ds_read_b64_tr_b16 a[156:157], v187 offset:49152
  ds_read_b128 a[232:235], v192 offset:16384
  v_mfma_f32_16x16x32_bf16 v[152:155], a[112:115], a[240:243], v[152:155]
  buffer_load_dwordx4 v176, s[8:11], s80 offen lds
  ds_read_b64_tr_b16 a[158:159], v187 offset:50176
  v_mfma_f32_16x16x32_bf16 v[148:151], a[108:111], a[240:243], 0
  ds_read_b128 a[236:239], v193 offset:16384
  v_mfma_f32_16x16x32_bf16 v[148:151], a[124:127], a[244:247], v[148:151]
  s_add_u32 m0, s76, 1024
  ds_read_b64_tr_b16 a[160:161], v186 offset:51200
  v_mfma_f32_16x16x32_bf16 v[144:147], a[120:123], a[244:247], 0
  buffer_load_dwordx4 v177, s[8:11], s80 offen lds
  ds_read_b64_tr_b16 a[162:163], v186 offset:52224
  v_mfma_f32_16x16x32_bf16 v[144:147], a[104:107], a[240:243], v[144:147]
  ds_read_b64_tr_b16 a[164:165], v187 offset:51200
  v_mfma_f32_16x16x32_bf16 v[160:163], a[104:107], a[248:251], 0
  s_add_u32 m0, s76, 2048
  ds_read_b64_tr_b16 a[166:167], v187 offset:52224
  ds_read_b128 a[240:243], v192 offset:18432
  v_mfma_f32_16x16x32_bf16 v[160:163], a[120:123], a[252:255], v[160:163]
  buffer_load_dwordx4 v176, s[12:15], s80 offen lds
  ds_read_b128 a[244:247], v193 offset:18432
  v_mfma_f32_16x16x32_bf16 v[164:167], a[124:127], a[252:255], 0
  v_mfma_f32_16x16x32_bf16 v[164:167], a[108:111], a[248:251], v[164:167]
  s_add_u32 m0, s76, 3072
  v_mfma_f32_16x16x32_bf16 v[168:171], a[112:115], a[248:251], 0
  buffer_load_dwordx4 v177, s[12:15], s80 offen lds
  v_mfma_f32_16x16x32_bf16 v[168:171], a[128:131], a[252:255], v[168:171]
  v_mfma_f32_16x16x32_bf16 v[172:175], a[132:135], a[252:255], 0
  v_mfma_f32_16x16x32_bf16 v[172:175], a[116:119], a[248:251], v[172:175]
  s_waitcnt lgkmcnt(2)
  v_mfma_f32_16x16x32_bf16 v[0:3], a[136:139], a[168:171], v[0:3]
  s_xor_b32 s92, s91, 256
  s_add_u32 s92, s92, 128
  s_add_u32 m0, s77, 81920
  v_mfma_f32_16x16x32_bf16 v[0:3], a[152:155], a[172:175], v[0:3]
  buffer_load_dwordx4 v178, s[4:7], s92 offen lds
  ds_read_b128 a[248:251], v192 offset:20480
  v_mfma_f32_16x16x32_bf16 v[4:7], a[156:159], a[172:175], v[4:7]
  ds_read_b128 a[252:255], v193 offset:20480
  v_mfma_f32_16x16x32_bf16 v[4:7], a[140:143], a[168:171], v[4:7]
  s_add_u32 m0, s77, 86016
  v_mfma_f32_16x16x32_bf16 v[8:11], a[144:147], a[168:171], v[8:11]
  buffer_load_dwordx4 v179, s[4:7], s92 offen lds
  v_mfma_f32_16x16x32_bf16 v[8:11], a[160:163], a[172:175], v[8:11]
  s_mov_b32 s16, s56
  s_mov_b32 s17, s57
  v_mfma_f32_16x16x32_bf16 v[12:15], a[164:167], a[172:175], v[12:15]
  s_add_u32 m0, s77, 90112
  s_mov_b32 s18, 9437184
  s_mov_b32 s19, 0x20000
  v_mfma_f32_16x16x32_bf16 v[12:15], a[148:151], a[168:171], v[12:15]
  buffer_load_dwordx4 v180, s[4:7], s92 offen lds
  v_mfma_f32_16x16x32_bf16 v[28:31], a[148:151], a[176:179], v[28:31]
  s_add_u32 s32, s56, 9437184
  s_addc_u32 s33, s57, 0
  v_mfma_f32_16x16x32_bf16 v[28:31], a[164:167], a[180:183], v[28:31]
  s_add_u32 m0, s94, 94208
  s_mov_b32 s89, 0x3f803f80
  v_mfma_f32_16x16x32_bf16 v[24:27], a[160:163], a[180:183], v[24:27]
  buffer_load_dwordx4 v181, s[4:7], s92 offen lds
  s_mov_b32 s34, 16384
  v_mfma_f32_16x16x32_bf16 v[24:27], a[144:147], a[176:179], v[24:27]
  v_lshlrev_b32 v240, 16, v232
  v_mfma_f32_16x16x32_bf16 v[20:23], a[140:143], a[176:179], v[20:23]
  s_add_u32 m0, s94, 98304
  s_mov_b32 s35, 0x20000
  v_mfma_f32_16x16x32_bf16 v[20:23], a[156:159], a[180:183], v[20:23]
  buffer_load_dwordx4 v182, s[4:7], s92 offen lds
  v_and_b32 v232, 0xffff0000, v232
  v_mfma_f32_16x16x32_bf16 v[16:19], a[152:155], a[180:183], v[16:19]
  v_mfma_f32_16x16x32_bf16 v[16:19], a[136:139], a[176:179], v[16:19]
  s_add_u32 m0, s94, 102400
  v_mfma_f32_16x16x32_bf16 v[32:35], a[136:139], a[184:187], v[32:35]
  buffer_load_dwordx4 v183, s[4:7], s92 offen lds
  s_xor_b32 s80, s90, 4
  s_add_u32 s80, s80, 2
  v_mfma_f32_16x16x32_bf16 v[32:35], a[152:155], a[188:191], v[32:35]
  s_mul_i32 s80, s80, 114688
  v_lshlrev_b32 v241, 16, v224
  v_mfma_f32_16x16x32_bf16 v[36:39], a[156:159], a[188:191], v[36:39]
  s_add_u32 m0, s76, 16384
  v_and_b32 v224, 0xffff0000, v224
  v_mfma_f32_16x16x32_bf16 v[36:39], a[140:143], a[184:187], v[36:39]
  buffer_load_dwordx4 v176, s[8:11], s80 offen lds
  v_mfma_f32_16x16x32_bf16 v[40:43], a[144:147], a[184:187], v[40:43]
  s_add_u32 s60, s56, 9453568
  s_addc_u32 s61, s57, 0
  v_mfma_f32_16x16x32_bf16 v[40:43], a[160:163], a[188:191], v[40:43]
  s_add_u32 m0, s76, 17408
  s_mov_b32 s62, 131072
  s_mov_b32 s63, 0x20000
  v_mfma_f32_16x16x32_bf16 v[44:47], a[164:167], a[188:191], v[44:47]
  buffer_load_dwordx4 v177, s[8:11], s80 offen lds
  v_mul_f32 v241, v241, v240
  v_mfma_f32_16x16x32_bf16 v[44:47], a[148:151], a[184:187], v[44:47]
  v_mul_f32 v224, v224, v232
  v_mfma_f32_16x16x32_bf16 v[60:63], a[148:151], a[192:195], v[60:63]
  s_add_u32 m0, s76, 18432
  v_mfma_f32_16x16x32_bf16 v[60:63], a[164:167], a[196:199], v[60:63]
  buffer_load_dwordx4 v176, s[12:15], s80 offen lds
  v_cvt_pk_bf16_f32 v224, v241, v224
  v_mfma_f32_16x16x32_bf16 v[56:59], a[160:163], a[196:199], v[56:59]
  s_mov_b32 s64, s54
  s_mov_b32 s65, s55
  v_mfma_f32_16x16x32_bf16 v[56:59], a[144:147], a[192:195], v[56:59]
  s_add_u32 m0, s76, 19456
  s_mov_b32 s66, 192
  s_mov_b32 s67, 0x20000
  v_mfma_f32_16x16x32_bf16 v[52:55], a[140:143], a[192:195], v[52:55]
  buffer_load_dwordx4 v177, s[12:15], s80 offen lds
  v_dot2_f32_bf16 v222, v224, s89, 0
  v_mfma_f32_16x16x32_bf16 v[52:55], a[156:159], a[196:199], v[52:55]
  v_lshlrev_b32 v241, 16, v228
  v_mfma_f32_16x16x32_bf16 v[48:51], a[152:155], a[196:199], v[48:51]
  v_mfma_f32_16x16x32_bf16 v[48:51], a[136:139], a[192:195], v[48:51]
  v_mfma_f32_16x16x32_bf16 v[64:67], a[136:139], a[200:203], v[64:67]
  v_and_b32 v228, 0xffff0000, v228
  v_mfma_f32_16x16x32_bf16 v[64:67], a[152:155], a[204:207], v[64:67]
  v_mfma_f32_16x16x32_bf16 v[68:71], a[156:159], a[204:207], v[68:71]
  v_mul_f32 v241, v241, v240
  v_mfma_f32_16x16x32_bf16 v[68:71], a[140:143], a[200:203], v[68:71]
  v_mfma_f32_16x16x32_bf16 v[72:75], a[144:147], a[200:203], v[72:75]
  v_mul_f32 v228, v228, v232
  v_mfma_f32_16x16x32_bf16 v[72:75], a[160:163], a[204:207], v[72:75]
  v_mfma_f32_16x16x32_bf16 v[76:79], a[164:167], a[204:207], v[76:79]
  v_cvt_pk_bf16_f32 v228, v241, v228
  v_mfma_f32_16x16x32_bf16 v[76:79], a[148:151], a[200:203], v[76:79]
  v_mfma_f32_16x16x32_bf16 v[92:95], a[148:151], a[208:211], v[92:95]
  v_mfma_f32_16x16x32_bf16 v[92:95], a[164:167], a[212:215], v[92:95]
  v_dot2_f32_bf16 v223, v228, s89, 0
  v_mfma_f32_16x16x32_bf16 v[88:91], a[160:163], a[212:215], v[88:91]
  s_waitcnt vmcnt(14) lgkmcnt(0)
  s_barrier
  v_mfma_f32_16x16x32_bf16 v[88:91], a[144:147], a[208:211], v[88:91]
  ds_read_b64_tr_b16 a[104:105], v188 offset:0
  v_lshlrev_b32 v240, 16, v233
  v_mfma_f32_16x16x32_bf16 v[84:87], a[140:143], a[208:211], v[84:87]
  ds_read_b64_tr_b16 a[106:107], v188 offset:1024
  v_mfma_f32_16x16x32_bf16 v[84:87], a[156:159], a[212:215], v[84:87]
  ds_read_b128 a[168:171], v194 offset:0
  v_and_b32 v233, 0xffff0000, v233
  v_mfma_f32_16x16x32_bf16 v[80:83], a[152:155], a[212:215], v[80:83]
  ds_read_b64_tr_b16 a[108:109], v189 offset:0
  ds_read_b128 a[172:175], v195 offset:0
  v_mfma_f32_16x16x32_bf16 v[80:83], a[136:139], a[208:211], v[80:83]
  ds_read_b64_tr_b16 a[110:111], v189 offset:1024
  ds_read_b128 a[176:179], v194 offset:2048
  v_mfma_f32_16x16x32_bf16 v[96:99], a[136:139], a[216:219], v[96:99]
  ds_read_b128 a[180:183], v195 offset:2048
  v_lshlrev_b32 v241, 16, v225
  v_mfma_f32_16x16x32_bf16 v[96:99], a[152:155], a[220:223], v[96:99]
  ds_read_b64_tr_b16 a[112:113], v188 offset:2048
  ds_read_b128 a[184:187], v194 offset:4096
  v_mfma_f32_16x16x32_bf16 v[100:103], a[156:159], a[220:223], v[100:103]
  ds_read_b128 a[188:191], v195 offset:4096
  v_and_b32 v225, 0xffff0000, v225
  v_mfma_f32_16x16x32_bf16 v[100:103], a[140:143], a[216:219], v[100:103]
  ds_read_b64_tr_b16 a[114:115], v188 offset:3072
  ds_read_b128 a[192:195], v194 offset:6144
  v_mfma_f32_16x16x32_bf16 v[104:107], a[144:147], a[216:219], v[104:107]
  ds_read_b64_tr_b16 a[116:117], v189 offset:2048
  ds_read_b128 a[196:199], v195 offset:6144
  v_mfma_f32_16x16x32_bf16 v[104:107], a[160:163], a[220:223], v[104:107]
  ds_read_b128 a[200:203], v194 offset:8192
  v_mul_f32 v241, v241, v240
  v_mfma_f32_16x16x32_bf16 v[108:111], a[164:167], a[220:223], v[108:111]
  ds_read_b64_tr_b16 a[118:119], v189 offset:3072
  ds_read_b128 a[204:207], v195 offset:8192
  v_mfma_f32_16x16x32_bf16 v[108:111], a[148:151], a[216:219], v[108:111]
  ds_read_b128 a[208:211], v194 offset:10240
  v_mul_f32 v225, v225, v233
  v_mfma_f32_16x16x32_bf16 v[124:127], a[148:151], a[224:227], v[124:127]
  ds_read_b128 a[212:215], v195 offset:10240
  v_mfma_f32_16x16x32_bf16 v[124:127], a[164:167], a[228:231], v[124:127]
  ds_read_b128 a[216:219], v194 offset:12288
  v_cvt_pk_bf16_f32 v225, v241, v225
  v_mfma_f32_16x16x32_bf16 v[120:123], a[160:163], a[228:231], v[120:123]
  ds_read_b128 a[220:223], v195 offset:12288
  v_mfma_f32_16x16x32_bf16 v[120:123], a[144:147], a[224:227], v[120:123]
  v_dot2_f32_bf16 v222, v225, s89, v222
  v_mfma_f32_16x16x32_bf16 v[116:119], a[140:143], a[224:227], v[116:119]
  s_mov_b32 s24, s48
  s_mov_b32 s25, s49
  v_mfma_f32_16x16x32_bf16 v[116:119], a[156:159], a[228:231], v[116:119]
  v_lshlrev_b32 v241, 16, v229
  s_mov_b32 s26, 1835008
  v_mfma_f32_16x16x32_bf16 v[112:115], a[152:155], a[228:231], v[112:115]
  s_mov_b32 s27, 0x20000
  v_mfma_f32_16x16x32_bf16 v[112:115], a[136:139], a[224:227], v[112:115]
  v_and_b32 v229, 0xffff0000, v229
  v_mfma_f32_16x16x32_bf16 v[128:131], a[136:139], a[232:235], v[128:131]
  ds_read_b128 a[224:227], v194 offset:14336
  v_mfma_f32_16x16x32_bf16 v[128:131], a[152:155], a[236:239], v[128:131]
  ds_read_b128 a[228:231], v195 offset:14336
  v_mfma_f32_16x16x32_bf16 v[132:135], a[156:159], a[236:239], v[132:135]
  v_mul_f32 v241, v241, v240
  v_mfma_f32_16x16x32_bf16 v[132:135], a[140:143], a[232:235], v[132:135]
  s_mov_b32 s28, s52
  s_mov_b32 s29, s53
  v_mfma_f32_16x16x32_bf16 v[136:139], a[144:147], a[232:235], v[136:139]
  v_mul_f32 v229, v229, v233
  s_mov_b32 s30, 2097152
  v_mfma_f32_16x16x32_bf16 v[136:139], a[160:163], a[236:239], v[136:139]
  s_mov_b32 s31, 0x20000
  s_mov_b32 s22, 1835008
  v_mfma_f32_16x16x32_bf16 v[140:143], a[164:167], a[236:239], v[140:143]
  v_cvt_pk_bf16_f32 v229, v241, v229
  v_mfma_f32_16x16x32_bf16 v[140:143], a[148:151], a[232:235], v[140:143]
  s_waitcnt vmcnt(10) lgkmcnt(7)
  s_barrier
  v_mfma_f32_16x16x32_bf16 v[156:159], a[148:151], a[240:243], v[156:159]
  ds_read_b64_tr_b16 a[120:121], v186 offset:0
  ds_read_b128 a[232:235], v194 offset:16384
  v_mfma_f32_16x16x32_bf16 v[156:159], a[164:167], a[244:247], v[156:159]
  ds_read_b64_tr_b16 a[122:123], v186 offset:1024
  ds_read_b128 a[236:239], v195 offset:16384
  v_mfma_f32_16x16x32_bf16 v[152:155], a[160:163], a[244:247], v[152:155]
  ds_read_b64_tr_b16 a[124:125], v187 offset:0
  v_dot2_f32_bf16 v223, v229, s89, v223
  v_mfma_f32_16x16x32_bf16 v[152:155], a[144:147], a[240:243], v[152:155]
  ds_read_b64_tr_b16 a[126:127], v187 offset:1024
  v_lshlrev_b32 v240, 16, v234
  v_mfma_f32_16x16x32_bf16 v[148:151], a[140:143], a[240:243], v[148:151]
  s_xor_b32 s80, s90, 5
  s_add_u32 s80, s80, 2
  s_mul_i32 s80, s80, 114688
  s_add_u32 m0, s76, 32768
  v_mfma_f32_16x16x32_bf16 v[148:151], a[156:159], a[244:247], v[148:151]
  buffer_load_dwordx4 v176, s[8:11], s80 offen lds
  ds_read_b64_tr_b16 a[128:129], v186 offset:2048
  v_mfma_f32_16x16x32_bf16 v[144:147], a[152:155], a[244:247], v[144:147]
  s_add_u32 m0, s76, 33792
  ds_read_b64_tr_b16 a[130:131], v186 offset:3072
  v_and_b32 v234, 0xffff0000, v234
  v_mfma_f32_16x16x32_bf16 v[144:147], a[136:139], a[240:243], v[144:147]
  buffer_load_dwordx4 v177, s[8:11], s80 offen lds
  ds_read_b64_tr_b16 a[132:133], v187 offset:2048
  v_mfma_f32_16x16x32_bf16 v[160:163], a[136:139], a[248:251], v[160:163]
  s_add_u32 m0, s76, 34816
  ds_read_b64_tr_b16 a[134:135], v187 offset:3072
  ds_read_b128 a[240:243], v194 offset:18432
  v_mfma_f32_16x16x32_bf16 v[160:163], a[152:155], a[252:255], v[160:163]
  buffer_load_dwordx4 v176, s[12:15], s80 offen lds
  ds_read_b128 a[244:247], v195 offset:18432
  v_mfma_f32_16x16x32_bf16 v[164:167], a[156:159], a[252:255], v[164:167]
  v_lshlrev_b32 v241, 16, v226
  v_and_b32 v226, 0xffff0000, v226
  v_mfma_f32_16x16x32_bf16 v[164:167], a[140:143], a[248:251], v[164:167]
  s_add_u32 m0, s76, 35840
  v_mfma_f32_16x16x32_bf16 v[168:171], a[144:147], a[248:251], v[168:171]
  buffer_load_dwordx4 v177, s[12:15], s80 offen lds
  v_mul_f32 v241, v241, v240
  v_mfma_f32_16x16x32_bf16 v[168:171], a[160:163], a[252:255], v[168:171]
  s_cmp_lt_u32 s69, 4
  s_cselect_b32 s20, s40, s48
  s_cselect_b32 s21, s41, s49
  s_cselect_b32 s22, 524288, s22
  v_mfma_f32_16x16x32_bf16 v[172:175], a[164:167], a[252:255], v[172:175]
  v_mul_f32 v226, v226, v234
  s_mov_b32 s23, 0x20000
  v_mfma_f32_16x16x32_bf16 v[172:175], a[148:151], a[248:251], v[172:175]
  s_waitcnt lgkmcnt(2)
  s_mov_b32 s86, 3216550459
  v_mfma_f32_16x16x32_bf16 v[0:3], a[104:107], a[168:171], v[0:3]
  s_xor_b32 s92, s91, 384
  s_add_u32 s92, s92, 128
  s_add_u32 m0, s77, 106496
  v_mfma_f32_16x16x32_bf16 v[0:3], a[120:123], a[172:175], v[0:3]
  buffer_load_dwordx4 v178, s[4:7], s92 offen lds
  ds_read_b128 a[248:251], v194 offset:20480
  v_mfma_f32_16x16x32_bf16 v[4:7], a[124:127], a[172:175], v[4:7]
  ds_read_b128 a[252:255], v195 offset:20480
  v_cvt_pk_bf16_f32 v226, v241, v226
  v_mfma_f32_16x16x32_bf16 v[4:7], a[108:111], a[168:171], v[4:7]
  v_dot2_f32_bf16 v222, v226, s89, v222
  v_lshlrev_b32 v213, 2, v208
  v_mfma_f32_16x16x32_bf16 v[8:11], a[112:115], a[168:171], v[8:11]
  s_add_u32 m0, s77, 110592
  buffer_load_dword v213, v213, s[64:67], 0 offen sc1
  s_mov_b32 s87, 3216550459
  v_mfma_f32_16x16x32_bf16 v[8:11], a[128:131], a[172:175], v[8:11]
  buffer_load_dwordx4 v179, s[4:7], s92 offen lds
  v_lshlrev_b32 v241, 16, v230
  v_mfma_f32_16x16x32_bf16 v[12:15], a[132:135], a[172:175], v[12:15]
  s_lshr_b32 s48, s69, 2
  s_lshr_b32 s71, s70, 2
  s_xor_b32 s71, s71, 4
  v_mfma_f32_16x16x32_bf16 v[12:15], a[116:119], a[168:171], v[12:15]
  v_and_b32 v230, 0xffff0000, v230
  s_lshl_b32 s71, s71, 7
  v_mfma_f32_16x16x32_bf16 v[28:31], a[116:119], a[176:179], v[28:31]
  s_add_u32 m0, s77, 114688
  s_lshl_b32 s84, s68, 12
  s_mul_i32 s82, s68, 163840
  v_mfma_f32_16x16x32_bf16 v[28:31], a[132:135], a[180:183], v[28:31]
  buffer_load_dwordx4 v180, s[4:7], s92 offen lds
  v_mul_f32 v241, v241, v240
  v_mfma_f32_16x16x32_bf16 v[24:27], a[128:131], a[180:183], v[24:27]
  s_mul_i32 s83, s68, 131072
  s_mul_i32 s72, s68, 294912
  s_add_u32 s72, s72, 655360
  v_mfma_f32_16x16x32_bf16 v[24:27], a[112:115], a[176:179], v[24:27]
  s_add_u32 s73, s72, 163840
  v_mfma_f32_16x16x32_bf16 v[20:23], a[108:111], a[176:179], v[20:23]
  v_mul_f32 v230, v230, v234
  v_mfma_f32_16x16x32_bf16 v[20:23], a[124:127], a[180:183], v[20:23]
  s_add_u32 m0, s94, 118784
  v_mfma_f32_16x16x32_bf16 v[16:19], a[120:123], a[180:183], v[16:19]
  buffer_load_dwordx4 v181, s[4:7], s92 offen lds
  v_cvt_pk_bf16_f32 v230, v241, v230
  v_mfma_f32_16x16x32_bf16 v[16:19], a[104:107], a[176:179], v[16:19]
  v_mfma_f32_16x16x32_bf16 v[32:35], a[104:107], a[184:187], v[32:35]
  v_dot2_f32_bf16 v223, v230, s89, v223
  v_mfma_f32_16x16x32_bf16 v[32:35], a[120:123], a[188:191], v[32:35]
  s_add_u32 m0, s94, 122880
  v_mfma_f32_16x16x32_bf16 v[36:39], a[124:127], a[188:191], v[36:39]
  buffer_load_dwordx4 v182, s[4:7], s92 offen lds
  v_mfma_f32_16x16x32_bf16 v[36:39], a[108:111], a[184:187], v[36:39]
  v_lshlrev_b32 v240, 16, v235
  v_mfma_f32_16x16x32_bf16 v[40:43], a[112:115], a[184:187], v[40:43]
  s_cmp_eq_u32 s48, 0
  s_cselect_b32 s82, s82, s72
  s_cselect_b32 s83, s83, s73
  v_mfma_f32_16x16x32_bf16 v[40:43], a[128:131], a[188:191], v[40:43]
  s_add_u32 m0, s94, 126976
  v_and_b32 v235, 0xffff0000, v235
  v_lshrrev_b32 v236, 4, v208
  v_mfma_f32_16x16x32_bf16 v[44:47], a[132:135], a[188:191], v[44:47]
  buffer_load_dwordx4 v183, s[4:7], s92 offen lds
  v_lshlrev_b32 v236, 1, v236
  v_mfma_f32_16x16x32_bf16 v[44:47], a[116:119], a[184:187], v[44:47]
  s_xor_b32 s80, s90, 6
  v_lshlrev_b32 v241, 16, v227
  v_mfma_f32_16x16x32_bf16 v[60:63], a[116:119], a[192:195], v[60:63]
  s_add_u32 s80, s80, 2
  v_and_b32 v237, 7, v208
  v_xor_b32 v237, v237, v236
  v_mfma_f32_16x16x32_bf16 v[60:63], a[132:135], a[196:199], v[60:63]
  s_mul_i32 s80, s80, 114688
  v_and_b32 v227, 0xffff0000, v227
  v_lshlrev_b32 v237, 4, v237
  v_mfma_f32_16x16x32_bf16 v[56:59], a[128:131], a[196:199], v[56:59]
  s_add_u32 m0, s76, 49152
  v_lshrrev_b32 v238, 3, v208
  v_lshl_add_u32 v237, v238, 10, v237
  v_mfma_f32_16x16x32_bf16 v[56:59], a[112:115], a[192:195], v[56:59]
  buffer_load_dwordx4 v176, s[8:11], s80 offen lds
  v_add_u32 v212, s71, v237
  v_mfma_f32_16x16x32_bf16 v[52:55], a[108:111], a[192:195], v[52:55]
  v_mul_f32 v241, v241, v240
  v_add_u32 v204, 7168, v212
  v_mfma_f32_16x16x32_bf16 v[52:55], a[124:127], a[196:199], v[52:55]
  v_add_u32 v205, 14336, v212
  v_add_u32 v206, 21504, v212
  v_mfma_f32_16x16x32_bf16 v[48:51], a[120:123], a[196:199], v[48:51]
  s_add_u32 m0, s76, 50176
  v_mul_f32 v227, v227, v235
  v_lshlrev_b32 v214, 20, v238
  v_mfma_f32_16x16x32_bf16 v[48:51], a[104:107], a[192:195], v[48:51]
  buffer_load_dwordx4 v177, s[8:11], s80 offen lds
  v_lshrrev_b32 v236, 2, v208
  v_mfma_f32_16x16x32_bf16 v[64:67], a[104:107], a[200:203], v[64:67]
  v_cvt_pk_bf16_f32 v227, v241, v227
  v_and_b32 v237, 3, v238
  v_mfma_f32_16x16x32_bf16 v[64:67], a[120:123], a[204:207], v[64:67]
  v_lshlrev_b32 v237, 5, v237
  v_lshl_add_u32 v237, v236, 7, v237
  v_mfma_f32_16x16x32_bf16 v[68:71], a[124:127], a[204:207], v[68:71]
  s_add_u32 m0, s76, 51200
  v_dot2_f32_bf16 v222, v227, s89, v222
  v_and_b32 v238, 3, v208
  v_mfma_f32_16x16x32_bf16 v[68:71], a[108:111], a[200:203], v[68:71]
  buffer_load_dwordx4 v176, s[12:15], s80 offen lds
  v_mfma_f32_16x16x32_bf16 v[72:75], a[112:115], a[200:203], v[72:75]
  v_lshl_add_u32 v237, v238, 3, v237
  v_mfma_f32_16x16x32_bf16 v[72:75], a[128:131], a[204:207], v[72:75]
  v_lshlrev_b32 v241, 16, v231
  v_mfma_f32_16x16x32_bf16 v[76:79], a[132:135], a[204:207], v[76:79]
  v_add_u32 v217, s84, v237
  v_mfma_f32_16x16x32_bf16 v[76:79], a[116:119], a[200:203], v[76:79]
  s_add_u32 m0, s76, 52224
  v_and_b32 v231, 0xffff0000, v231
  v_mfma_f32_16x16x32_bf16 v[92:95], a[116:119], a[208:211], v[92:95]
  buffer_load_dwordx4 v177, s[12:15], s80 offen lds
  v_xor_b32 v218, 32, v217
  v_mfma_f32_16x16x32_bf16 v[92:95], a[132:135], a[212:215], v[92:95]
  v_mul_f32 v241, v241, v240
  v_mfma_f32_16x16x32_bf16 v[88:91], a[128:131], a[212:215], v[88:91]
  s_waitcnt vmcnt(15) lgkmcnt(0)
  s_barrier
  v_xor_b32 v219, 64, v217
  v_mfma_f32_16x16x32_bf16 v[88:91], a[112:115], a[208:211], v[88:91]
  ds_read_b64_tr_b16 a[136:137], v186 offset:16384
  v_mfma_f32_16x16x32_bf16 v[84:87], a[108:111], a[208:211], v[84:87]
  s_xor_b32 s80, s90, 7
  s_add_u32 s80, s80, 2
  s_mul_i32 s80, s80, 114688
  s_add_u32 m0, s76, 65536
  v_mfma_f32_16x16x32_bf16 v[84:87], a[124:127], a[212:215], v[84:87]
  buffer_load_dwordx4 v176, s[8:11], s80 offen lds
  ds_read_b64_tr_b16 a[138:139], v186 offset:17408
  v_mfma_f32_16x16x32_bf16 v[80:83], a[120:123], a[212:215], v[80:83]
  ds_read_b64_tr_b16 a[140:141], v187 offset:16384
  ds_read_b128 a[168:171], v190 offset:0
  v_mfma_f32_16x16x32_bf16 v[80:83], a[104:107], a[208:211], v[80:83]
  s_add_u32 m0, s76, 66560
  ds_read_b64_tr_b16 a[142:143], v187 offset:17408
  v_mfma_f32_16x16x32_bf16 v[96:99], a[104:107], a[216:219], v[96:99]
  buffer_load_dwordx4 v177, s[8:11], s80 offen lds
  ds_read_b128 a[172:175], v191 offset:0
  v_mfma_f32_16x16x32_bf16 v[96:99], a[120:123], a[220:223], v[96:99]
  ds_read_b64_tr_b16 a[144:145], v186 offset:18432
  ds_read_b128 a[176:179], v190 offset:2048
  v_mfma_f32_16x16x32_bf16 v[100:103], a[124:127], a[220:223], v[100:103]
  ds_read_b128 a[180:183], v191 offset:2048
  v_mul_f32 v231, v231, v235
  v_mfma_f32_16x16x32_bf16 v[100:103], a[108:111], a[216:219], v[100:103]
  s_add_u32 m0, s76, 67584
  ds_read_b64_tr_b16 a[146:147], v186 offset:19456
  ds_read_b128 a[184:187], v190 offset:4096
  v_mfma_f32_16x16x32_bf16 v[104:107], a[112:115], a[216:219], v[104:107]
  buffer_load_dwordx4 v176, s[12:15], s80 offen lds
  ds_read_b64_tr_b16 a[148:149], v187 offset:18432
  v_mfma_f32_16x16x32_bf16 v[104:107], a[128:131], a[220:223], v[104:107]
  ds_read_b128 a[188:191], v191 offset:4096
  v_cvt_pk_bf16_f32 v231, v241, v231
  v_mfma_f32_16x16x32_bf16 v[108:111], a[132:135], a[220:223], v[108:111]
  ds_read_b64_tr_b16 a[150:151], v187 offset:19456
  ds_read_b128 a[192:195], v190 offset:6144
  v_mfma_f32_16x16x32_bf16 v[108:111], a[116:119], a[216:219], v[108:111]
  s_add_u32 m0, s76, 68608
  ds_read_b128 a[196:199], v191 offset:6144
  v_mfma_f32_16x16x32_bf16 v[124:127], a[116:119], a[224:227], v[124:127]
  buffer_load_dwordx4 v177, s[12:15], s80 offen lds
  ds_read_b128 a[200:203], v190 offset:8192
  v_mfma_f32_16x16x32_bf16 v[124:127], a[132:135], a[228:231], v[124:127]
  ds_read_b128 a[204:207], v191 offset:8192
  v_dot2_f32_bf16 v223, v231, s89, v223
  v_mfma_f32_16x16x32_bf16 v[120:123], a[128:131], a[228:231], v[120:123]
  s_xor_b32 s92, s91, 512
  s_add_u32 s92, s92, 128
  s_add_u32 m0, s77, 131072
  v_mfma_f32_16x16x32_bf16 v[120:123], a[112:115], a[224:227], v[120:123]
  buffer_load_dwordx4 v178, s[4:7], s92 offen lds
  ds_read_b128 a[208:211], v190 offset:10240
  v_mfma_f32_16x16x32_bf16 v[116:119], a[108:111], a[224:227], v[116:119]
  ds_read_b128 a[212:215], v191 offset:10240
  v_xor_b32 v220, 96, v217
  v_mfma_f32_16x16x32_bf16 v[116:119], a[124:127], a[228:231], v[116:119]
  ds_read_b128 a[216:219], v190 offset:12288
  v_add_u32 v200, 131072, v217
  v_mfma_f32_16x16x32_bf16 v[112:115], a[120:123], a[228:231], v[112:115]
  ds_read_b128 a[220:223], v191 offset:12288
  v_add_u32 v201, 131072, v218
  v_mfma_f32_16x16x32_bf16 v[112:115], a[104:107], a[224:227], v[112:115]
  s_add_u32 m0, s77, 135168
  v_add_u32 v202, 131072, v219
  v_mfma_f32_16x16x32_bf16 v[128:131], a[104:107], a[232:235], v[128:131]
  buffer_load_dwordx4 v179, s[4:7], s92 offen lds
  ds_read_b128 a[224:227], v190 offset:14336
  v_mfma_f32_16x16x32_bf16 v[128:131], a[120:123], a[236:239], v[128:131]
  ds_read_b128 a[228:231], v191 offset:14336
  v_add_u32 v203, 131072, v220
  v_mfma_f32_16x16x32_bf16 v[132:135], a[124:127], a[236:239], v[132:135]
  v_permlane32_swap_b32 v222, v223
  v_mfma_f32_16x16x32_bf16 v[132:135], a[108:111], a[232:235], v[132:135]
  v_add_f32 v223, v222, v223
  v_mov_b32 v222, v223
  v_mfma_f32_16x16x32_bf16 v[136:139], a[112:115], a[232:235], v[136:139]
  s_add_u32 m0, s77, 139264
  v_and_b32 v239, 31, v208
  v_lshlrev_b32 v239, 20, v239
  v_mfma_f32_16x16x32_bf16 v[136:139], a[128:131], a[236:239], v[136:139]
  buffer_load_dwordx4 v180, s[4:7], s92 offen lds
  v_mov_b32 v211, 1
  v_mfma_f32_16x16x32_bf16 v[140:143], a[132:135], a[236:239], v[140:143]
  v_permlane16_swap_b32 v222, v223
  v_mfma_f32_16x16x32_bf16 v[140:143], a[116:119], a[232:235], v[140:143]
  s_waitcnt vmcnt(18) lgkmcnt(10)
  s_barrier
  v_mfma_f32_16x16x32_bf16 v[156:159], a[116:119], a[240:243], v[156:159]
  ds_read_b64_tr_b16 a[152:153], v186 offset:32768
  ds_read_b128 a[232:235], v190 offset:16384
  v_mfma_f32_16x16x32_bf16 v[156:159], a[132:135], a[244:247], v[156:159]
  s_add_u32 m0, s94, 143360
  ds_read_b64_tr_b16 a[154:155], v186 offset:33792
  ds_read_b128 a[236:239], v191 offset:16384
  v_mfma_f32_16x16x32_bf16 v[152:155], a[128:131], a[244:247], v[152:155]
  buffer_load_dwordx4 v181, s[4:7], s92 offen lds
  ds_read_b64_tr_b16 a[156:157], v187 offset:32768
  v_mfma_f32_16x16x32_bf16 v[152:155], a[112:115], a[240:243], v[152:155]
  ds_read_b64_tr_b16 a[158:159], v187 offset:33792
  v_add_f32 v223, v222, v223
  v_mfma_f32_16x16x32_bf16 v[148:151], a[108:111], a[240:243], v[148:151]
  s_lshl_b32 s73, s68, 11
  s_lshl_b32 s49, s2, 13
  s_add_u32 s49, s49, s73
  v_mfma_f32_16x16x32_bf16 v[148:151], a[124:127], a[244:247], v[148:151]
  ds_read_b64_tr_b16 a[160:161], v186 offset:34816
  v_add_f32_dpp v223, v223, v223 row_ror:8 row_mask:0xf bank_mask:0xf
  v_mfma_f32_16x16x32_bf16 v[144:147], a[120:123], a[244:247], v[144:147]
  s_add_u32 m0, s94, 147456
  ds_read_b64_tr_b16 a[162:163], v186 offset:35840
  s_and_b32 s72, s69, 3
  v_mfma_f32_16x16x32_bf16 v[144:147], a[104:107], a[240:243], v[144:147]
  buffer_load_dwordx4 v182, s[4:7], s92 offen lds
  ds_read_b64_tr_b16 a[164:165], v187 offset:34816
  v_mfma_f32_16x16x32_bf16 v[160:163], a[104:107], a[248:251], v[160:163]
  ds_read_b64_tr_b16 a[166:167], v187 offset:35840
  ds_read_b128 a[240:243], v190 offset:18432
  v_mfma_f32_16x16x32_bf16 v[160:163], a[120:123], a[252:255], v[160:163]
  ds_read_b128 a[244:247], v191 offset:18432
  v_add_f32_dpp v223, v223, v223 row_ror:4 row_mask:0xf bank_mask:0xf
  v_mfma_f32_16x16x32_bf16 v[164:167], a[124:127], a[252:255], v[164:167]
  s_lshl_b32 s72, s72, 2
  s_and_b32 s73, s70, 3
  s_add_u32 s72, s72, s73
  v_mfma_f32_16x16x32_bf16 v[164:167], a[108:111], a[248:251], v[164:167]
  s_add_u32 m0, s94, 151552
  v_add_f32_dpp v223, v223, v223 row_ror:2 row_mask:0xf bank_mask:0xf
  s_lshl_b32 s72, s72, 1
  v_mfma_f32_16x16x32_bf16 v[168:171], a[112:115], a[248:251], v[168:171]
  buffer_load_dwordx4 v183, s[4:7], s92 offen lds
  s_lshl_b32 s73, s48, 1
  v_mfma_f32_16x16x32_bf16 v[168:171], a[128:131], a[252:255], v[168:171]
  v_add_f32_dpp v223, v223, v223 row_ror:1 row_mask:0xf bank_mask:0xf
  v_cvt_pk_bf16_f32 v223, v223, v223
  v_mfma_f32_16x16x32_bf16 v[172:175], a[132:135], a[252:255], v[172:175]
  v_and_b32 v223, 0xffff0000, v223
  v_mul_f32 v223, 3216550459, v223
  v_mfma_f32_16x16x32_bf16 v[172:175], a[116:119], a[248:251], v[172:175]
  s_waitcnt lgkmcnt(2)
  v_lshrrev_b32 v236, 1, v208
  v_mfma_f32_16x16x32_bf16 v[0:3], a[136:139], a[168:171], v[0:3]
  s_xor_b32 s80, s90, 8
  s_add_u32 s80, s80, 2
  s_mul_i32 s80, s80, 114688
  s_add_u32 m0, s76, 0
  v_mfma_f32_16x16x32_bf16 v[0:3], a[152:155], a[172:175], v[0:3]
  buffer_load_dwordx4 v176, s[8:11], s80 offen lds
  ds_read_b128 a[248:251], v190 offset:20480
  v_mfma_f32_16x16x32_bf16 v[4:7], a[156:159], a[172:175], v[4:7]
  ds_read_b128 a[252:255], v191 offset:20480
  v_and_b32 v237, 1, v208
  v_mfma_f32_16x16x32_bf16 v[4:7], a[140:143], a[168:171], v[4:7]
  s_add_u32 m0, s76, 1024
  v_exp_f32 v223, v223
  v_mfma_f32_16x16x32_bf16 v[8:11], a[144:147], a[168:171], v[8:11]
  buffer_load_dwordx4 v177, s[8:11], s80 offen lds
  v_lshrrev_b32 v222, 5, v208
  v_mfma_f32_16x16x32_bf16 v[8:11], a[160:163], a[172:175], v[8:11]
  v_add_f32 v223, 1.0, v223
  v_add_u32 v236, s73, v236
  v_mfma_f32_16x16x32_bf16 v[12:15], a[164:167], a[172:175], v[12:15]
  s_add_u32 m0, s76, 2048
  v_rcp_f32 v223, v223
  v_mfma_f32_16x16x32_bf16 v[12:15], a[148:151], a[168:171], v[12:15]
  buffer_load_dwordx4 v176, s[12:15], s80 offen lds
  v_lshl_add_u32 v239, v222, 3, v239
  v_mfma_f32_16x16x32_bf16 v[28:31], a[148:151], a[176:179], v[28:31]
  v_cvt_pk_bf16_f32 v223, v223, v223
  v_and_b32 v223, 0xffff0000, v223
  v_mfma_f32_16x16x32_bf16 v[28:31], a[164:167], a[180:183], v[28:31]
  s_add_u32 m0, s76, 3072
  v_and_b32 v236, 3, v236
  v_lshl_add_u32 v236, v236, 5, v237
  v_mfma_f32_16x16x32_bf16 v[24:27], a[160:163], a[180:183], v[24:27]
  buffer_load_dwordx4 v177, s[12:15], s80 offen lds
  v_sub_f32 v222, 1.0, v223
  v_mfma_f32_16x16x32_bf16 v[24:27], a[144:147], a[176:179], v[24:27]
  v_add_u32 v236, s72, v236
  v_mov_b32 v237, v236
  v_mfma_f32_16x16x32_bf16 v[20:23], a[140:143], a[176:179], v[20:23]
  v_cvt_pk_bf16_f32 v222, v222, v222
  v_cmp_lt_u32 vcc, 64, v236
  v_mfma_f32_16x16x32_bf16 v[20:23], a[156:159], a[180:183], v[20:23]
  v_mfma_f32_16x16x32_bf16 v[16:19], a[152:155], a[180:183], v[16:19]
  v_addc_co_u32 v237, vcc, 0, v237, vcc
  v_cmp_lt_u32 vcc, 85, v236
  v_mfma_f32_16x16x32_bf16 v[16:19], a[136:139], a[176:179], v[16:19]
  v_and_b32 v222, 0xffff0000, v222
  v_mfma_f32_16x16x32_bf16 v[32:35], a[136:139], a[184:187], v[32:35]
  v_addc_co_u32 v237, vcc, 0, v237, vcc
  v_cmp_lt_u32 vcc, 106, v236
  v_mfma_f32_16x16x32_bf16 v[32:35], a[152:155], a[188:191], v[32:35]
  v_rcp_f32 v222, v222
  v_mfma_f32_16x16x32_bf16 v[36:39], a[156:159], a[188:191], v[36:39]
  v_addc_co_u32 v237, vcc, 0, v237, vcc
  v_and_b32 v236, 1, v237
  v_mfma_f32_16x16x32_bf16 v[36:39], a[140:143], a[184:187], v[36:39]
  v_min_f32 v222, 1900671690, v222
  v_mul_u32_u24 v236, 66, v236
  v_mfma_f32_16x16x32_bf16 v[40:43], a[144:147], a[184:187], v[40:43]
  v_lshrrev_b32 v237, 1, v237
  v_mul_u32_u24 v238, 5958, v237
  v_mfma_f32_16x16x32_bf16 v[40:43], a[160:163], a[188:191], v[40:43]
  v_lshrrev_b32 v238, 16, v238
  v_mfma_f32_16x16x32_bf16 v[44:47], a[164:167], a[188:191], v[44:47]
  v_mfma_f32_16x16x32_bf16 v[44:47], a[148:151], a[184:187], v[44:47]
  v_mul_u32_u24 v216, 6, v237
  v_mfma_f32_16x16x32_bf16 v[60:63], a[148:151], a[192:195], v[60:63]
  s_waitcnt vmcnt(23)
  v_cmp_eq_u32 s[100:101], 0, v213
  s_and_b32 s101, s101, 0xffff
  s_or_b32 s88, s100, s101
  s_cbranch_scc1 L_rdyf
L_rdyf_ret:
  v_mfma_f32_16x16x32_bf16 v[60:63], a[164:167], a[196:199], v[60:63]
  buffer_store_dwordx2 v[222:223], v239, s[32:35], s3 offen sc1
  v_mul_u32_u24 v238, 65, v238
  v_mfma_f32_16x16x32_bf16 v[56:59], a[160:163], a[196:199], v[56:59]
  v_mfma_f32_16x16x32_bf16 v[56:59], a[144:147], a[192:195], v[56:59]
  v_mfma_f32_16x16x32_bf16 v[52:55], a[140:143], a[192:195], v[52:55]
  v_sub_u32 v216, v216, v238
  v_mfma_f32_16x16x32_bf16 v[52:55], a[156:159], a[196:199], v[52:55]
  v_mfma_f32_16x16x32_bf16 v[48:51], a[152:155], a[196:199], v[48:51]
  v_add_u32 v216, v236, v216
  v_mfma_f32_16x16x32_bf16 v[48:51], a[136:139], a[192:195], v[48:51]
  v_mfma_f32_16x16x32_bf16 v[64:67], a[136:139], a[200:203], v[64:67]
  s_xor_b32 s72, s48, 1
  v_mfma_f32_16x16x32_bf16 v[64:67], a[152:155], a[204:207], v[64:67]
  v_mfma_f32_16x16x32_bf16 v[68:71], a[156:159], a[204:207], v[68:71]
  s_lshl_b32 s72, s72, 2
  v_mfma_f32_16x16x32_bf16 v[68:71], a[140:143], a[200:203], v[68:71]
  v_mfma_f32_16x16x32_bf16 v[72:75], a[144:147], a[200:203], v[72:75]
  s_add_u32 s72, s72, s68
  v_mfma_f32_16x16x32_bf16 v[72:75], a[160:163], a[204:207], v[72:75]
  v_mfma_f32_16x16x32_bf16 v[76:79], a[164:167], a[204:207], v[76:79]
  s_lshl_b32 s72, s72, 7
  v_mfma_f32_16x16x32_bf16 v[76:79], a[148:151], a[200:203], v[76:79]
  v_mfma_f32_16x16x32_bf16 v[92:95], a[148:151], a[208:211], v[92:95]
  v_xor_b32 v221, 3, v208
  v_mfma_f32_16x16x32_bf16 v[92:95], a[164:167], a[212:215], v[92:95]
  v_mfma_f32_16x16x32_bf16 v[88:91], a[160:163], a[212:215], v[88:91]
  s_waitcnt vmcnt(15) lgkmcnt(0)
  s_barrier
  v_lshlrev_b32 v221, 20, v221
  v_mfma_f32_16x16x32_bf16 v[88:91], a[144:147], a[208:211], v[88:91]
  ds_read_b64_tr_b16 a[104:105], v186 offset:49152
  v_mfma_f32_16x16x32_bf16 v[84:87], a[140:143], a[208:211], v[84:87]
  ds_read_b64_tr_b16 a[106:107], v186 offset:50176
  v_lshl_add_u32 v221, v216, 10, v221
  v_mfma_f32_16x16x32_bf16 v[84:87], a[156:159], a[212:215], v[84:87]
  ds_read_b128 a[168:171], v192 offset:0
  v_mfma_f32_16x16x32_bf16 v[80:83], a[152:155], a[212:215], v[80:83]
  ds_read_b64_tr_b16 a[108:109], v187 offset:49152
  ds_read_b128 a[172:175], v193 offset:0
  v_mfma_f32_16x16x32_bf16 v[80:83], a[136:139], a[208:211], v[80:83]
  ds_read_b64_tr_b16 a[110:111], v187 offset:50176
  ds_read_b128 a[176:179], v192 offset:2048
  v_mfma_f32_16x16x32_bf16 v[96:99], a[136:139], a[216:219], v[96:99]
  ds_read_b128 a[180:183], v193 offset:2048
  v_add_u32 v221, s72, v221
  v_mfma_f32_16x16x32_bf16 v[96:99], a[152:155], a[220:223], v[96:99]
  ds_read_b64_tr_b16 a[112:113], v186 offset:51200
  ds_read_b128 a[184:187], v192 offset:4096
  v_mfma_f32_16x16x32_bf16 v[100:103], a[156:159], a[220:223], v[100:103]
  ds_read_b128 a[188:191], v193 offset:4096
  v_cmp_le_u32 vcc, 7, v208
  v_mfma_f32_16x16x32_bf16 v[100:103], a[140:143], a[216:219], v[100:103]
  ds_read_b64_tr_b16 a[114:115], v186 offset:52224
  ds_read_b128 a[192:195], v192 offset:6144
  v_mfma_f32_16x16x32_bf16 v[104:107], a[144:147], a[216:219], v[104:107]
  ds_read_b64_tr_b16 a[116:117], v187 offset:51200
  ds_read_b128 a[196:199], v193 offset:6144
  v_mfma_f32_16x16x32_bf16 v[104:107], a[160:163], a[220:223], v[104:107]
  ds_read_b128 a[200:203], v192 offset:8192
  v_mov_b32 v207, 9
  v_mfma_f32_16x16x32_bf16 v[108:111], a[164:167], a[220:223], v[108:111]
  ds_read_b64_tr_b16 a[118:119], v187 offset:52224
  ds_read_b128 a[204:207], v193 offset:8192
  v_mfma_f32_16x16x32_bf16 v[108:111], a[148:151], a[216:219], v[108:111]
  ds_read_b128 a[208:211], v192 offset:10240
  v_mov_b32 v238, 17
  v_mfma_f32_16x16x32_bf16 v[124:127], a[148:151], a[224:227], v[124:127]
  ds_read_b128 a[212:215], v193 offset:10240
  v_cndmask_b32 v207, v207, v238, vcc
  v_mfma_f32_16x16x32_bf16 v[124:127], a[164:167], a[228:231], v[124:127]
  ds_read_b128 a[216:219], v192 offset:12288
  s_lshl_b32 s72, s48, 2
  v_mfma_f32_16x16x32_bf16 v[120:123], a[160:163], a[228:231], v[120:123]
  ds_read_b128 a[220:223], v193 offset:12288
  s_add_u32 s72, s72, s68
  v_mfma_f32_16x16x32_bf16 v[120:123], a[144:147], a[224:227], v[120:123]
  v_mfma_f32_16x16x32_bf16 v[116:119], a[140:143], a[224:227], v[116:119]
  s_mul_i32 s55, s72, 9216
  v_mfma_f32_16x16x32_bf16 v[116:119], a[156:159], a[228:231], v[116:119]
  v_mfma_f32_16x16x32_bf16 v[112:115], a[152:155], a[228:231], v[112:115]
  s_lshl_b32 s72, s72, 7
  v_mfma_f32_16x16x32_bf16 v[112:115], a[136:139], a[224:227], v[112:115]
  v_mfma_f32_16x16x32_bf16 v[128:131], a[136:139], a[232:235], v[128:131]
  s_xor_b32 s80, s90, 9
  s_add_u32 s80, s80, 2
  s_mul_i32 s80, s80, 114688
  s_add_u32 m0, s76, 16384
  v_mfma_f32_16x16x32_bf16 v[128:131], a[152:155], a[236:239], v[128:131]
  buffer_load_dwordx4 v176, s[8:11], s80 offen lds
  ds_read_b128 a[224:227], v192 offset:14336
  v_mfma_f32_16x16x32_bf16 v[132:135], a[156:159], a[236:239], v[132:135]
  ds_read_b128 a[228:231], v193 offset:14336
  v_lshl_add_u32 v214, v216, 10, v214
  v_mfma_f32_16x16x32_bf16 v[132:135], a[140:143], a[232:235], v[132:135]
  s_add_u32 m0, s76, 17408
  v_add_u32 v214, s72, v214
  v_mfma_f32_16x16x32_bf16 v[136:139], a[144:147], a[232:235], v[136:139]
  buffer_load_dwordx4 v177, s[8:11], s80 offen lds
  v_mfma_f32_16x16x32_bf16 v[136:139], a[160:163], a[236:239], v[136:139]
  v_readlane_b32 s36, v185, 0
  v_mfma_f32_16x16x32_bf16 v[140:143], a[164:167], a[236:239], v[140:143]
  s_add_u32 m0, s76, 18432
  v_mfma_f32_16x16x32_bf16 v[140:143], a[148:151], a[232:235], v[140:143]
  buffer_load_dwordx4 v176, s[12:15], s80 offen lds
  s_waitcnt vmcnt(14) lgkmcnt(7)
  s_barrier
  v_mfma_f32_16x16x32_bf16 v[156:159], a[148:151], a[240:243], v[156:159]
  ds_read_b64_tr_b16 a[120:121], v188 offset:0
  ds_read_b128 a[232:235], v192 offset:16384
  v_mfma_f32_16x16x32_bf16 v[156:159], a[164:167], a[244:247], v[156:159]
  s_add_u32 m0, s76, 19456
  ds_read_b64_tr_b16 a[122:123], v188 offset:1024
  ds_read_b128 a[236:239], v193 offset:16384
  v_mfma_f32_16x16x32_bf16 v[152:155], a[160:163], a[244:247], v[152:155]
  buffer_load_dwordx4 v177, s[12:15], s80 offen lds
  s_xor_b32 s92, s91, 640
  v_mfma_f32_16x16x32_bf16 v[152:155], a[144:147], a[240:243], v[152:155]
  s_add_u32 s92, s92, 128
  ds_read_b64_tr_b16 a[124:125], v189 offset:0
  ds_read_b64_tr_b16 a[126:127], v189 offset:1024
  v_mfma_f32_16x16x32_bf16 v[148:151], a[140:143], a[240:243], v[148:151]
  s_add_u32 m0, s77, 81920
  v_readlane_b32 s37, v185, 1
  v_readlane_b32 s38, v185, 2
  v_mfma_f32_16x16x32_bf16 v[148:151], a[156:159], a[244:247], v[148:151]
  buffer_load_dwordx4 v178, s[4:7], s92 offen lds
  ds_read_b64_tr_b16 a[128:129], v188 offset:2048
  v_mfma_f32_16x16x32_bf16 v[144:147], a[152:155], a[244:247], v[144:147]
  ds_read_b64_tr_b16 a[130:131], v188 offset:3072
  v_readlane_b32 s39, v185, 3
  v_mfma_f32_16x16x32_bf16 v[144:147], a[136:139], a[240:243], v[144:147]
  s_add_u32 m0, s77, 86016
  ds_read_b64_tr_b16 a[132:133], v189 offset:2048
  v_mfma_f32_16x16x32_bf16 v[160:163], a[136:139], a[248:251], v[160:163]
  buffer_load_dwordx4 v179, s[4:7], s92 offen lds
  ds_read_b64_tr_b16 a[134:135], v189 offset:3072
  v_mfma_f32_16x16x32_bf16 v[160:163], a[152:155], a[252:255], v[160:163]
  ds_read_b128 a[240:243], v192 offset:18432
  v_readlane_b32 s40, v185, 4
  v_mfma_f32_16x16x32_bf16 v[164:167], a[156:159], a[252:255], v[164:167]
  ds_read_b128 a[244:247], v193 offset:18432
  v_readlane_b32 s41, v185, 5
  v_mfma_f32_16x16x32_bf16 v[164:167], a[140:143], a[248:251], v[164:167]
  s_add_u32 m0, s77, 90112
  v_readlane_b32 s42, v185, 6
  v_readlane_b32 s43, v185, 7
  v_mfma_f32_16x16x32_bf16 v[168:171], a[144:147], a[248:251], v[168:171]
  buffer_load_dwordx4 v180, s[4:7], s92 offen lds
  v_mfma_f32_16x16x32_bf16 v[168:171], a[160:163], a[252:255], v[168:171]
  v_readlane_b32 s44, v185, 8
  v_mfma_f32_16x16x32_bf16 v[172:175], a[164:167], a[252:255], v[172:175]
  v_mfma_f32_16x16x32_bf16 v[172:175], a[148:151], a[248:251], v[172:175]
  s_waitcnt lgkmcnt(2)
  v_readlane_b32 s45, v185, 9
  v_mfma_f32_16x16x32_bf16 v[0:3], a[104:107], a[168:171], v[0:3]
  s_xor_b32 s92, s91, 640
  s_add_u32 s92, s92, 128
  s_add_u32 m0, s94, 94208
  v_mfma_f32_16x16x32_bf16 v[0:3], a[120:123], a[172:175], v[0:3]
  buffer_load_dwordx4 v181, s[4:7], s92 offen lds
  ds_read_b128 a[248:251], v192 offset:20480
  v_mfma_f32_16x16x32_bf16 v[4:7], a[124:127], a[172:175], v[4:7]
  ds_read_b128 a[252:255], v193 offset:20480
  v_readlane_b32 s46, v185, 10
  v_mfma_f32_16x16x32_bf16 v[4:7], a[108:111], a[168:171], v[4:7]
  s_add_u32 m0, s94, 98304
  s_lshl_b32 s72, s79, 2
  v_mfma_f32_16x16x32_bf16 v[8:11], a[112:115], a[168:171], v[8:11]
  buffer_load_dwordx4 v182, s[4:7], s92 offen lds
  v_mfma_f32_16x16x32_bf16 v[8:11], a[128:131], a[172:175], v[8:11]
  s_add_u32 s72, s72, s68
  v_mfma_f32_16x16x32_bf16 v[12:15], a[132:135], a[172:175], v[12:15]
  v_mfma_f32_16x16x32_bf16 v[12:15], a[116:119], a[168:171], v[12:15]
  s_add_u32 m0, s94, 102400
  s_mul_i32 s73, s72, 13108
  v_mfma_f32_16x16x32_bf16 v[28:31], a[116:119], a[176:179], v[28:31]
  buffer_load_dwordx4 v183, s[4:7], s92 offen lds
  s_xor_b32 s80, s90, 10
  v_mfma_f32_16x16x32_bf16 v[28:31], a[132:135], a[180:183], v[28:31]
  s_add_u32 s80, s80, 2
  s_lshr_b32 s73, s73, 16
  v_mfma_f32_16x16x32_bf16 v[24:27], a[128:131], a[180:183], v[24:27]
  s_mul_i32 s80, s80, 114688
  v_mfma_f32_16x16x32_bf16 v[24:27], a[112:115], a[176:179], v[24:27]
  s_add_u32 m0, s76, 32768
  s_lshl_b32 s73, s73, 2
  v_mfma_f32_16x16x32_bf16 v[20:23], a[108:111], a[176:179], v[20:23]
  buffer_load_dwordx4 v176, s[8:11], s80 offen lds
  v_mfma_f32_16x16x32_bf16 v[20:23], a[124:127], a[180:183], v[20:23]
  s_min_u32 s73, s73, 16
  v_mfma_f32_16x16x32_bf16 v[16:19], a[120:123], a[180:183], v[16:19]
  v_mfma_f32_16x16x32_bf16 v[16:19], a[104:107], a[176:179], v[16:19]
  s_add_u32 m0, s76, 33792
  s_add_u32 s72, s72, s73
  v_mfma_f32_16x16x32_bf16 v[32:35], a[104:107], a[184:187], v[32:35]
  buffer_load_dwordx4 v177, s[8:11], s80 offen lds
  v_mfma_f32_16x16x32_bf16 v[32:35], a[120:123], a[188:191], v[32:35]
  s_mul_i32 s73, s72, 7282
  v_mfma_f32_16x16x32_bf16 v[36:39], a[124:127], a[188:191], v[36:39]
  v_mfma_f32_16x16x32_bf16 v[36:39], a[108:111], a[184:187], v[36:39]
  s_add_u32 m0, s76, 34816
  v_mfma_f32_16x16x32_bf16 v[40:43], a[112:115], a[184:187], v[40:43]
  buffer_load_dwordx4 v176, s[12:15], s80 offen lds
  s_lshr_b32 s73, s73, 16
  v_mfma_f32_16x16x32_bf16 v[40:43], a[128:131], a[188:191], v[40:43]
  v_mfma_f32_16x16x32_bf16 v[44:47], a[132:135], a[188:191], v[44:47]
  s_lshl_b32 s73, s73, 7
  v_mfma_f32_16x16x32_bf16 v[44:47], a[116:119], a[184:187], v[44:47]
  s_add_u32 m0, s76, 35840
  v_mfma_f32_16x16x32_bf16 v[60:63], a[116:119], a[192:195], v[60:63]
  buffer_load_dwordx4 v177, s[12:15], s80 offen lds
  s_xor_b32 s80, s90, 11
  v_mfma_f32_16x16x32_bf16 v[60:63], a[132:135], a[196:199], v[60:63]
  s_add_u32 s80, s80, 2
  v_lshlrev_b32 v210, 20, v208
  v_mfma_f32_16x16x32_bf16 v[56:59], a[128:131], a[196:199], v[56:59]
  s_mul_i32 s80, s80, 114688
  v_add_u32 v210, s73, v210
  v_mfma_f32_16x16x32_bf16 v[56:59], a[112:115], a[192:195], v[56:59]
  s_add_u32 m0, s76, 49152
  v_mfma_f32_16x16x32_bf16 v[52:55], a[108:111], a[192:195], v[52:55]
  buffer_load_dwordx4 v176, s[8:11], s80 offen lds
  s_lshl_b32 s85, s72, 10
  v_mfma_f32_16x16x32_bf16 v[52:55], a[124:127], a[196:199], v[52:55]
  v_mfma_f32_16x16x32_bf16 v[48:51], a[120:123], a[196:199], v[48:51]
  v_lshrrev_b32 v248, 4, v208
  v_mfma_f32_16x16x32_bf16 v[48:51], a[104:107], a[192:195], v[48:51]
  s_add_u32 m0, s76, 50176
  v_mfma_f32_16x16x32_bf16 v[64:67], a[104:107], a[200:203], v[64:67]
  buffer_load_dwordx4 v177, s[8:11], s80 offen lds
  v_lshlrev_b32 v248, 2, v248
  v_mfma_f32_16x16x32_bf16 v[64:67], a[120:123], a[204:207], v[64:67]
  v_mfma_f32_16x16x32_bf16 v[68:71], a[124:127], a[204:207], v[68:71]
  v_and_b32 v249, 15, v208
  v_mfma_f32_16x16x32_bf16 v[68:71], a[108:111], a[200:203], v[68:71]
  s_add_u32 m0, s76, 51200
  v_mfma_f32_16x16x32_bf16 v[72:75], a[112:115], a[200:203], v[72:75]
  buffer_load_dwordx4 v176, s[12:15], s80 offen lds
  v_lshlrev_b32 v249, 3, v249
  v_mfma_f32_16x16x32_bf16 v[72:75], a[128:131], a[204:207], v[72:75]
  v_mfma_f32_16x16x32_bf16 v[76:79], a[132:135], a[204:207], v[76:79]
  v_min_u32 v250, 127, v185
  v_mfma_f32_16x16x32_bf16 v[76:79], a[116:119], a[200:203], v[76:79]
  s_add_u32 m0, s76, 52224
  v_mfma_f32_16x16x32_bf16 v[92:95], a[116:119], a[208:211], v[92:95]
  buffer_load_dwordx4 v177, s[12:15], s80 offen lds
  ds_bpermute_b32 v196, v248, v250 offset:0
  v_mfma_f32_16x16x32_bf16 v[92:95], a[132:135], a[212:215], v[92:95]
  v_mfma_f32_16x16x32_bf16 v[88:91], a[128:131], a[212:215], v[88:91]
  s_waitcnt vmcnt(19) lgkmcnt(0)
  s_barrier
  ds_bpermute_b32 v197, v248, v250 offset:16
  v_mfma_f32_16x16x32_bf16 v[88:91], a[112:115], a[208:211], v[88:91]
  ds_read_b64_tr_b16 a[136:137], v186 offset:0
  v_mfma_f32_16x16x32_bf16 v[84:87], a[108:111], a[208:211], v[84:87]
  s_xor_b32 s80, s95, 14
  s_mul_i32 s80, s80, 114688
  s_add_u32 m0, s76, 65536
  v_mfma_f32_16x16x32_bf16 v[84:87], a[124:127], a[212:215], v[84:87]
  buffer_load_dwordx4 v176, s[8:11], s80 offen lds
  ds_read_b64_tr_b16 a[138:139], v186 offset:1024
  v_mfma_f32_16x16x32_bf16 v[80:83], a[120:123], a[212:215], v[80:83]
  ds_read_b64_tr_b16 a[140:141], v187 offset:0
  ds_read_b128 a[168:171], v194 offset:0
  v_mfma_f32_16x16x32_bf16 v[80:83], a[104:107], a[208:211], v[80:83]
  ds_read_b64_tr_b16 a[142:143], v187 offset:1024
  ds_read_b128 a[172:175], v195 offset:0
  v_mfma_f32_16x16x32_bf16 v[96:99], a[104:107], a[216:219], v[96:99]
  s_add_u32 m0, s76, 66560
  ds_read_b128 a[176:179], v194 offset:2048
  ds_bpermute_b32 v198, v248, v250 offset:32
  v_mfma_f32_16x16x32_bf16 v[96:99], a[120:123], a[220:223], v[96:99]
  buffer_load_dwordx4 v177, s[8:11], s80 offen lds
  ds_read_b64_tr_b16 a[144:145], v186 offset:2048
  v_mfma_f32_16x16x32_bf16 v[100:103], a[124:127], a[220:223], v[100:103]
  ds_read_b128 a[180:183], v195 offset:2048
  v_mfma_f32_16x16x32_bf16 v[100:103], a[108:111], a[216:219], v[100:103]
  ds_read_b64_tr_b16 a[146:147], v186 offset:3072
  ds_read_b128 a[184:187], v194 offset:4096
  v_mfma_f32_16x16x32_bf16 v[104:107], a[112:115], a[216:219], v[104:107]
  s_add_u32 m0, s76, 67584
  ds_read_b64_tr_b16 a[148:149], v187 offset:2048
  ds_read_b128 a[188:191], v195 offset:4096
  v_mfma_f32_16x16x32_bf16 v[104:107], a[128:131], a[220:223], v[104:107]
  buffer_load_dwordx4 v176, s[12:15], s80 offen lds
  ds_read_b128 a[192:195], v194 offset:6144
  v_mfma_f32_16x16x32_bf16 v[108:111], a[132:135], a[220:223], v[108:111]
  ds_read_b64_tr_b16 a[150:151], v187 offset:3072
  ds_read_b128 a[196:199], v195 offset:6144
  v_mfma_f32_16x16x32_bf16 v[108:111], a[116:119], a[216:219], v[108:111]
  ds_read_b128 a[200:203], v194 offset:8192
  s_waitcnt lgkmcnt(10)
  v_mfma_f32_16x16x32_bf16 v[124:127], a[116:119], a[224:227], v[124:127]
  ds_read_b128 a[204:207], v195 offset:8192
  v_lshl_add_u32 v196, v196, 7, v249
  v_mfma_f32_16x16x32_bf16 v[124:127], a[132:135], a[228:231], v[124:127]
  s_add_u32 m0, s76, 68608
  ds_read_b128 a[208:211], v194 offset:10240
  v_lshl_add_u32 v197, v197, 7, v249
  v_mfma_f32_16x16x32_bf16 v[120:123], a[128:131], a[228:231], v[120:123]
  buffer_load_dwordx4 v177, s[12:15], s80 offen lds
  ds_read_b128 a[212:215], v195 offset:10240
  v_mfma_f32_16x16x32_bf16 v[120:123], a[112:115], a[224:227], v[120:123]
  ds_read_b128 a[216:219], v194 offset:12288
  v_lshl_add_u32 v198, v198, 7, v249
  v_mfma_f32_16x16x32_bf16 v[116:119], a[108:111], a[224:227], v[116:119]
  s_mov_b32 s92, 896
  ds_read_b128 a[220:223], v195 offset:12288
  s_and_b32 s72, s69, 3
  v_mfma_f32_16x16x32_bf16 v[116:119], a[124:127], a[228:231], v[116:119]
  s_add_u32 m0, s77, 106496
  s_lshl_b32 s72, s72, 5
  s_add_u32 s72, s72, s70
  v_mfma_f32_16x16x32_bf16 v[112:115], a[120:123], a[228:231], v[112:115]
  buffer_load_dwordx4 v178, s[4:7], s92 offen lds
  s_mul_i32 s73, s72, 1280
  v_mfma_f32_16x16x32_bf16 v[112:115], a[104:107], a[224:227], v[112:115]
  s_mul_i32 s74, s70, 5120
  v_mfma_f32_16x16x32_bf16 v[128:131], a[104:107], a[232:235], v[128:131]
  ds_read_b128 a[224:227], v194 offset:14336
  v_mfma_f32_16x16x32_bf16 v[128:131], a[120:123], a[236:239], v[128:131]
  s_add_u32 m0, s77, 110592
  ds_read_b128 a[228:231], v195 offset:14336
  s_add_u32 s74, s74, 384
  v_mfma_f32_16x16x32_bf16 v[132:135], a[124:127], a[236:239], v[132:135]
  buffer_load_dwordx4 v179, s[4:7], s92 offen lds
  v_mfma_f32_16x16x32_bf16 v[132:135], a[108:111], a[232:235], v[132:135]
  v_cmp_gt_u32 vcc, 16, v208
  v_mfma_f32_16x16x32_bf16 v[136:139], a[112:115], a[232:235], v[136:139]
  v_mfma_f32_16x16x32_bf16 v[136:139], a[128:131], a[236:239], v[136:139]
  v_min_u32 v254, 9, v208
  v_mfma_f32_16x16x32_bf16 v[140:143], a[132:135], a[236:239], v[140:143]
  s_add_u32 m0, s77, 114688
  v_mfma_f32_16x16x32_bf16 v[140:143], a[116:119], a[232:235], v[140:143]
  buffer_load_dwordx4 v180, s[4:7], s92 offen lds
  s_waitcnt vmcnt(21) lgkmcnt(9)
  s_barrier
  v_mfma_f32_16x16x32_bf16 v[156:159], a[116:119], a[240:243], v[156:159]
  ds_read_b64_tr_b16 a[152:153], v186 offset:16384
  ds_read_b128 a[232:235], v194 offset:16384
  v_mfma_f32_16x16x32_bf16 v[156:159], a[132:135], a[244:247], v[156:159]
  ds_read_b64_tr_b16 a[154:155], v186 offset:17408
  ds_read_b128 a[236:239], v195 offset:16384
  v_mfma_f32_16x16x32_bf16 v[152:155], a[128:131], a[244:247], v[152:155]
  s_add_u32 m0, s94, 118784
  ds_read_b64_tr_b16 a[156:157], v187 offset:16384
  v_lshl_add_u32 v254, v254, 7, s73
  v_mfma_f32_16x16x32_bf16 v[152:155], a[112:115], a[240:243], v[152:155]
  buffer_load_dwordx4 v181, s[4:7], s92 offen lds
  ds_read_b64_tr_b16 a[158:159], v187 offset:17408
  v_mfma_f32_16x16x32_bf16 v[148:151], a[108:111], a[240:243], v[148:151]
  v_min_u32 v237, 20, v208
  v_subrev_u32 v237, 16, v237
  v_mfma_f32_16x16x32_bf16 v[148:151], a[124:127], a[244:247], v[148:151]
  ds_read_b64_tr_b16 a[160:161], v186 offset:18432
  v_lshl_add_u32 v237, v237, 10, s74
  v_mfma_f32_16x16x32_bf16 v[144:147], a[120:123], a[244:247], v[144:147]
  s_add_u32 m0, s94, 122880
  ds_read_b64_tr_b16 a[162:163], v186 offset:19456
  v_mfma_f32_16x16x32_bf16 v[144:147], a[104:107], a[240:243], v[144:147]
  buffer_load_dwordx4 v182, s[4:7], s92 offen lds
  ds_read_b64_tr_b16 a[164:165], v187 offset:18432
  v_mfma_f32_16x16x32_bf16 v[160:163], a[104:107], a[248:251], v[160:163]
  ds_read_b64_tr_b16 a[166:167], v187 offset:19456
  ds_read_b128 a[240:243], v194 offset:18432
  v_mfma_f32_16x16x32_bf16 v[160:163], a[120:123], a[252:255], v[160:163]
  ds_read_b128 a[244:247], v195 offset:18432
  v_cndmask_b32 v254, v237, v254, vcc
  v_mfma_f32_16x16x32_bf16 v[164:167], a[124:127], a[252:255], v[164:167]
  s_lshl_b32 s73, s72, 10
  v_mfma_f32_16x16x32_bf16 v[164:167], a[108:111], a[248:251], v[164:167]
  s_add_u32 m0, s94, 126976
  s_lshl_b32 s74, s70, 12
  v_mfma_f32_16x16x32_bf16 v[168:171], a[112:115], a[248:251], v[168:171]
  buffer_load_dwordx4 v183, s[4:7], s92 offen lds
  v_mfma_f32_16x16x32_bf16 v[168:171], a[128:131], a[252:255], v[168:171]
  s_add_u32 s74, s74, 384
  v_mfma_f32_16x16x32_bf16 v[172:175], a[132:135], a[252:255], v[172:175]
  v_mfma_f32_16x16x32_bf16 v[172:175], a[116:119], a[248:251], v[172:175]
  s_waitcnt lgkmcnt(2)
  v_and_b32 v255, 7, v208
  v_mfma_f32_16x16x32_bf16 v[0:3], a[136:139], a[168:171], v[0:3]
  ds_read_b128 a[248:251], v194 offset:20480
  v_mfma_f32_16x16x32_bf16 v[0:3], a[152:155], a[172:175], v[0:3]
  ds_read_b128 a[252:255], v195 offset:20480
  v_lshl_add_u32 v255, v255, 7, s73
  v_mfma_f32_16x16x32_bf16 v[4:7], a[156:159], a[172:175], v[4:7]
  v_mfma_f32_16x16x32_bf16 v[4:7], a[140:143], a[168:171], v[4:7]
  v_and_b32 v237, 3, v208
  v_mfma_f32_16x16x32_bf16 v[8:11], a[144:147], a[168:171], v[8:11]
  v_mfma_f32_16x16x32_bf16 v[8:11], a[160:163], a[172:175], v[8:11]
  v_lshl_add_u32 v237, v237, 10, s74
  v_mfma_f32_16x16x32_bf16 v[12:15], a[164:167], a[172:175], v[12:15]
  v_mfma_f32_16x16x32_bf16 v[12:15], a[148:151], a[168:171], v[12:15]
  v_cndmask_b32 v255, v237, v255, vcc
  v_mfma_f32_16x16x32_bf16 v[28:31], a[148:151], a[176:179], v[28:31]
  v_mfma_f32_16x16x32_bf16 v[28:31], a[164:167], a[180:183], v[28:31]
  v_mfma_f32_16x16x32_bf16 v[24:27], a[160:163], a[180:183], v[24:27]
  v_mfma_f32_16x16x32_bf16 v[24:27], a[144:147], a[176:179], v[24:27]
  v_mfma_f32_16x16x32_bf16 v[20:23], a[140:143], a[176:179], v[20:23]
  s_xor_b32 s80, s95, 15
  s_mul_i32 s80, s80, 114688
  s_add_u32 m0, s76, 0
  v_mfma_f32_16x16x32_bf16 v[20:23], a[156:159], a[180:183], v[20:23]
  buffer_load_dwordx4 v176, s[8:11], s80 offen lds
  v_mfma_f32_16x16x32_bf16 v[16:19], a[152:155], a[180:183], v[16:19]
  v_mfma_f32_16x16x32_bf16 v[16:19], a[136:139], a[176:179], v[16:19]
  s_add_u32 m0, s76, 1024
  v_mfma_f32_16x16x32_bf16 v[32:35], a[136:139], a[184:187], v[32:35]
  buffer_load_dwordx4 v177, s[8:11], s80 offen lds
  v_mfma_f32_16x16x32_bf16 v[32:35], a[152:155], a[188:191], v[32:35]
  buffer_load_dword v240, v196, s[32:35], 0 offen sc1
  v_mfma_f32_16x16x32_bf16 v[36:39], a[156:159], a[188:191], v[36:39]
  v_mfma_f32_16x16x32_bf16 v[36:39], a[140:143], a[184:187], v[36:39]
  s_add_u32 m0, s76, 2048
  v_mfma_f32_16x16x32_bf16 v[40:43], a[144:147], a[184:187], v[40:43]
  buffer_load_dwordx4 v176, s[12:15], s80 offen lds
  v_mfma_f32_16x16x32_bf16 v[40:43], a[160:163], a[188:191], v[40:43]
  v_mfma_f32_16x16x32_bf16 v[44:47], a[164:167], a[188:191], v[44:47]
  buffer_load_dword v244, v197, s[32:35], 0 offen sc1
  v_mfma_f32_16x16x32_bf16 v[44:47], a[148:151], a[184:187], v[44:47]
  s_add_u32 m0, s76, 3072
  v_mfma_f32_16x16x32_bf16 v[60:63], a[148:151], a[192:195], v[60:63]
  buffer_load_dwordx4 v177, s[12:15], s80 offen lds
  v_mfma_f32_16x16x32_bf16 v[60:63], a[164:167], a[196:199], v[60:63]
  v_mfma_f32_16x16x32_bf16 v[56:59], a[160:163], a[196:199], v[56:59]
  v_mfma_f32_16x16x32_bf16 v[56:59], a[144:147], a[192:195], v[56:59]
  v_mfma_f32_16x16x32_bf16 v[52:55], a[140:143], a[192:195], v[52:55]
  buffer_load_dword v248, v198, s[32:35], 0 offen sc1
  v_mfma_f32_16x16x32_bf16 v[52:55], a[156:159], a[196:199], v[52:55]
  v_mfma_f32_16x16x32_bf16 v[48:51], a[152:155], a[196:199], v[48:51]
  v_mfma_f32_16x16x32_bf16 v[48:51], a[136:139], a[192:195], v[48:51]
  buffer_load_dword v232, v254, s[24:27], s82 offen
  v_mfma_f32_16x16x32_bf16 v[64:67], a[136:139], a[200:203], v[64:67]
  buffer_load_dword v233, v255, s[20:23], s83 offen
  v_mfma_f32_16x16x32_bf16 v[64:67], a[152:155], a[204:207], v[64:67]
  v_mfma_f32_16x16x32_bf16 v[68:71], a[156:159], a[204:207], v[68:71]
  v_mfma_f32_16x16x32_bf16 v[68:71], a[140:143], a[200:203], v[68:71]
  v_mfma_f32_16x16x32_bf16 v[72:75], a[144:147], a[200:203], v[72:75]
  v_mfma_f32_16x16x32_bf16 v[72:75], a[160:163], a[204:207], v[72:75]
  v_mfma_f32_16x16x32_bf16 v[76:79], a[164:167], a[204:207], v[76:79]
  v_mfma_f32_16x16x32_bf16 v[76:79], a[148:151], a[200:203], v[76:79]
  v_mfma_f32_16x16x32_bf16 v[92:95], a[148:151], a[208:211], v[92:95]
  v_mfma_f32_16x16x32_bf16 v[92:95], a[164:167], a[212:215], v[92:95]
  v_mfma_f32_16x16x32_bf16 v[88:91], a[160:163], a[212:215], v[88:91]
  s_waitcnt vmcnt(19) lgkmcnt(0)
  s_barrier
  v_mfma_f32_16x16x32_bf16 v[88:91], a[144:147], a[208:211], v[88:91]
  v_mfma_f32_16x16x32_bf16 v[84:87], a[140:143], a[208:211], v[84:87]
  ds_read_b64_tr_b16 a[104:105], v186 offset:32768
  v_mfma_f32_16x16x32_bf16 v[84:87], a[156:159], a[212:215], v[84:87]
  ds_read_b64_tr_b16 a[106:107], v186 offset:33792
  v_mfma_f32_16x16x32_bf16 v[80:83], a[152:155], a[212:215], v[80:83]
  ds_read_b64_tr_b16 a[108:109], v187 offset:32768
  v_mfma_f32_16x16x32_bf16 v[80:83], a[136:139], a[208:211], v[80:83]
  ds_read_b64_tr_b16 a[110:111], v187 offset:33792
  v_mfma_f32_16x16x32_bf16 v[96:99], a[136:139], a[216:219], v[96:99]
  ds_read_b64_tr_b16 a[112:113], v186 offset:34816
  v_mfma_f32_16x16x32_bf16 v[96:99], a[152:155], a[220:223], v[96:99]
  ds_read_b64_tr_b16 a[114:115], v186 offset:35840
  v_mfma_f32_16x16x32_bf16 v[100:103], a[156:159], a[220:223], v[100:103]
  ds_read_b64_tr_b16 a[116:117], v187 offset:34816
  v_mfma_f32_16x16x32_bf16 v[100:103], a[140:143], a[216:219], v[100:103]
  ds_read_b64_tr_b16 a[118:119], v187 offset:35840
  v_mfma_f32_16x16x32_bf16 v[104:107], a[144:147], a[216:219], v[104:107]
  ds_read_b64_tr_b16 a[120:121], v186 offset:49152
  v_mfma_f32_16x16x32_bf16 v[104:107], a[160:163], a[220:223], v[104:107]
  ds_read_b64_tr_b16 a[122:123], v186 offset:50176
  v_mfma_f32_16x16x32_bf16 v[108:111], a[164:167], a[220:223], v[108:111]
  ds_read_b64_tr_b16 a[124:125], v187 offset:49152
  v_mfma_f32_16x16x32_bf16 v[108:111], a[148:151], a[216:219], v[108:111]
  ds_read_b64_tr_b16 a[126:127], v187 offset:50176
  v_mfma_f32_16x16x32_bf16 v[124:127], a[148:151], a[224:227], v[124:127]
  ds_read_b64_tr_b16 a[128:129], v186 offset:51200
  v_mfma_f32_16x16x32_bf16 v[124:127], a[164:167], a[228:231], v[124:127]
  ds_read_b64_tr_b16 a[130:131], v186 offset:52224
  v_mfma_f32_16x16x32_bf16 v[120:123], a[160:163], a[228:231], v[120:123]
  ds_read_b64_tr_b16 a[132:133], v187 offset:51200
  v_mfma_f32_16x16x32_bf16 v[120:123], a[144:147], a[224:227], v[120:123]
  ds_read_b64_tr_b16 a[134:135], v187 offset:52224
  v_mfma_f32_16x16x32_bf16 v[116:119], a[140:143], a[224:227], v[116:119]
  v_mfma_f32_16x16x32_bf16 v[116:119], a[156:159], a[228:231], v[116:119]
  v_mfma_f32_16x16x32_bf16 v[112:115], a[152:155], a[228:231], v[112:115]
  s_waitcnt vmcnt(2)
  v_min_u32 v213, v240, v244
  v_min_u32 v213, v248, v213
  v_mfma_f32_16x16x32_bf16 v[112:115], a[136:139], a[224:227], v[112:115]
  v_mfma_f32_16x16x32_bf16 v[128:131], a[136:139], a[232:235], v[128:131]
  v_cmp_eq_u32 vcc, 0, v213
  s_cbranch_vccnz L_gf
L_gf_ret:
  v_mfma_f32_16x16x32_bf16 v[128:131], a[152:155], a[236:239], v[128:131]
  v_mov_b32 v242, v240
  v_mov_b32 v246, v244
  v_mfma_f32_16x16x32_bf16 v[132:135], a[156:159], a[236:239], v[132:135]
  s_waitcnt lgkmcnt(0)
  s_barrier
  v_mov_b32 v250, v248
  v_mfma_f32_16x16x32_bf16 v[132:135], a[140:143], a[232:235], v[132:135]
  ds_read_b128 a[200:203], v190 offset:0
  ds_read_b128 a[204:207], v191 offset:0
  v_mfma_f32_16x16x32_bf16 v[136:139], a[144:147], a[232:235], v[136:139]
  ds_read_b128 a[208:211], v192 offset:0
  s_add_u32 s81, s82, 0
  v_mfma_f32_16x16x32_bf16 v[136:139], a[160:163], a[236:239], v[136:139]
  ds_read_b128 a[212:215], v193 offset:0
  ds_read_b64_tr_b16 a[168:169], v188 offset:0
  v_mfma_f32_16x16x32_bf16 v[140:143], a[164:167], a[236:239], v[140:143]
  ds_read_b64_tr_b16 a[170:171], v188 offset:1024
  v_mfma_f32_16x16x32_bf16 v[140:143], a[148:151], a[232:235], v[140:143]
  ds_read_b64_tr_b16 a[172:173], v189 offset:0
  ds_read_b64_tr_b16 a[174:175], v189 offset:1024
  v_mfma_f32_16x16x32_bf16 v[156:159], a[148:151], a[240:243], v[156:159]
  ds_read_b64_tr_b16 a[176:177], v188 offset:2048
  s_add_u32 m0, s84, 131072
  v_mfma_f32_16x16x32_bf16 v[156:159], a[164:167], a[244:247], v[156:159]
  ds_read_b64_tr_b16 a[178:179], v188 offset:3072
  buffer_load_dwordx4 v212, s[24:27], s81 offen offset:0 lds
  v_mfma_f32_16x16x32_bf16 v[152:155], a[160:163], a[244:247], v[152:155]
  ds_read_b64_tr_b16 a[180:181], v189 offset:2048
  ds_read_b64_tr_b16 a[182:183], v189 offset:3072
  v_mfma_f32_16x16x32_bf16 v[152:155], a[144:147], a[240:243], v[152:155]
  ds_read_b64_tr_b16 a[184:185], v186 offset:0
  v_mfma_f32_16x16x32_bf16 v[148:151], a[140:143], a[240:243], v[148:151]
  ds_read_b64_tr_b16 a[186:187], v186 offset:1024
  ds_read_b64_tr_b16 a[188:189], v187 offset:0
  v_mfma_f32_16x16x32_bf16 v[148:151], a[156:159], a[244:247], v[148:151]
  ds_read_b64_tr_b16 a[190:191], v187 offset:1024
  buffer_load_dwordx4 v204, s[24:27], s81 offen offset:1024 lds
  v_mfma_f32_16x16x32_bf16 v[144:147], a[152:155], a[244:247], v[144:147]
  ds_read_b64_tr_b16 a[192:193], v186 offset:2048
  ds_read_b64_tr_b16 a[194:195], v186 offset:3072
  v_mfma_f32_16x16x32_bf16 v[144:147], a[136:139], a[240:243], v[144:147]
  ds_read_b64_tr_b16 a[196:197], v187 offset:2048
  v_mfma_f32_16x16x32_bf16 v[160:163], a[136:139], a[248:251], v[160:163]
  ds_read_b64_tr_b16 a[198:199], v187 offset:3072
  v_mfma_f32_16x16x32_bf16 v[160:163], a[152:155], a[252:255], v[160:163]
  v_permlane32_swap_b32 v240, v242
  v_mfma_f32_16x16x32_bf16 v[164:167], a[156:159], a[252:255], v[164:167]
  v_permlane32_swap_b32 v244, v246
  v_mfma_f32_16x16x32_bf16 v[164:167], a[140:143], a[248:251], v[164:167]
  v_permlane32_swap_b32 v248, v250
  v_mfma_f32_16x16x32_bf16 v[168:171], a[144:147], a[248:251], v[168:171]
  v_mov_b32 v241, v240
  v_mov_b32 v243, v242
  v_mfma_f32_16x16x32_bf16 v[168:171], a[160:163], a[252:255], v[168:171]
  v_mov_b32 v245, v244
  v_mov_b32 v247, v246
  v_mfma_f32_16x16x32_bf16 v[172:175], a[164:167], a[252:255], v[172:175]
  s_waitcnt lgkmcnt(0)
  s_barrier
  v_mov_b32 v249, v248
  v_mfma_f32_16x16x32_bf16 v[172:175], a[148:151], a[248:251], v[172:175]
  v_mov_b32 v251, v250
  buffer_load_dwordx4 v205, s[24:27], s81 offen offset:2048 lds
  v_mfma_f32_16x16x32_bf16 v[0:3], a[104:107], a[200:203], v[0:3]
  ds_read_b128 a[216:219], v190 offset:2048
  v_mfma_f32_16x16x32_bf16 v[0:3], a[120:123], a[204:207], v[0:3]
  ds_read_b128 a[220:223], v191 offset:2048
  v_mfma_f32_16x16x32_bf16 v[0:3], a[168:171], a[208:211], v[0:3]
  ds_read_b128 a[224:227], v192 offset:2048
  v_mfma_f32_16x16x32_bf16 v[0:3], a[184:187], a[212:215], v[0:3]
  ds_read_b128 a[228:231], v193 offset:2048
  buffer_load_dwordx4 v206, s[24:27], s81 offen offset:3072 lds
  v_mfma_f32_16x16x32_bf16 v[4:7], a[188:191], a[212:215], v[4:7]
  v_permlane16_swap_b32 v240, v241
  v_mfma_f32_16x16x32_bf16 v[4:7], a[172:175], a[208:211], v[4:7]
  v_permlane16_swap_b32 v242, v243
  v_mfma_f32_16x16x32_bf16 v[4:7], a[124:127], a[204:207], v[4:7]
  v_permlane16_swap_b32 v244, v245
  v_mfma_f32_16x16x32_bf16 v[4:7], a[108:111], a[200:203], v[4:7]
  v_permlane16_swap_b32 v246, v247
  v_mfma_f32_16x16x32_bf16 v[8:11], a[112:115], a[200:203], v[8:11]
  v_permlane16_swap_b32 v248, v249
  v_mfma_f32_16x16x32_bf16 v[8:11], a[128:131], a[204:207], v[8:11]
  v_permlane16_swap_b32 v250, v251
  v_mfma_f32_16x16x32_bf16 v[8:11], a[176:179], a[208:211], v[8:11]
  s_add_u32 s81, s82, 32768
  s_add_u32 m0, s84, 147456
  v_mfma_f32_16x16x32_bf16 v[8:11], a[192:195], a[212:215], v[8:11]
  buffer_load_dwordx4 v212, s[24:27], s81 offen offset:0 lds
  v_mfma_f32_16x16x32_bf16 v[12:15], a[196:199], a[212:215], v[12:15]
  v_mfma_f32_16x16x32_bf16 v[12:15], a[180:183], a[208:211], v[12:15]
  v_mfma_f32_16x16x32_bf16 v[12:15], a[132:135], a[204:207], v[12:15]
  v_mfma_f32_16x16x32_bf16 v[12:15], a[116:119], a[200:203], v[12:15]
  s_waitcnt lgkmcnt(0)
  buffer_load_dwordx4 v204, s[24:27], s81 offen offset:1024 lds
  v_mfma_f32_16x16x32_bf16 v[16:19], a[104:107], a[216:219], v[16:19]
  ds_read_b128 a[200:203], v190 offset:4096
  v_pk_mul_f32 v[0:1], v[0:1], s[86:87]
  v_pk_mul_f32 v[2:3], v[2:3], s[86:87]
  v_pk_mul_f32 v[4:5], v[4:5], s[86:87]
  v_pk_mul_f32 v[6:7], v[6:7], s[86:87]
  v_mfma_f32_16x16x32_bf16 v[16:19], a[120:123], a[220:223], v[16:19]
  v_exp_f32 v0, v0
  v_mfma_f32_16x16x32_bf16 v[16:19], a[168:171], a[224:227], v[16:19]
  buffer_load_dwordx4 v205, s[24:27], s81 offen offset:2048 lds
  v_exp_f32 v1, v1
  v_mfma_f32_16x16x32_bf16 v[16:19], a[184:187], a[228:231], v[16:19]
  v_exp_f32 v2, v2
  v_mfma_f32_16x16x32_bf16 v[20:23], a[188:191], a[228:231], v[20:23]
  v_exp_f32 v3, v3
  v_mfma_f32_16x16x32_bf16 v[20:23], a[172:175], a[224:227], v[20:23]
  v_exp_f32 v4, v4
  v_mfma_f32_16x16x32_bf16 v[20:23], a[124:127], a[220:223], v[20:23]
  buffer_load_dwordx4 v206, s[24:27], s81 offen offset:3072 lds
  v_exp_f32 v5, v5
  v_mfma_f32_16x16x32_bf16 v[20:23], a[108:111], a[216:219], v[20:23]
  ds_read_b128 a[204:207], v191 offset:4096
  s_add_u32 s81, s82, 65536
  v_exp_f32 v6, v6
  v_exp_f32 v7, v7
  v_pk_fma_f32 v[0:1], v[0:1], v[240:241], v[240:241] op_sel_hi:[1,0,0]
  v_pk_fma_f32 v[2:3], v[2:3], v[240:241], v[240:241] op_sel_hi:[1,0,0]
  v_pk_fma_f32 v[4:5], v[4:5], v[240:241], v[240:241] op_sel_hi:[1,0,0]
  v_pk_fma_f32 v[6:7], v[6:7], v[240:241], v[240:241] op_sel_hi:[1,0,0]
  v_mfma_f32_16x16x32_bf16 v[24:27], a[112:115], a[216:219], v[24:27]
  ds_read_b128 a[208:211], v192 offset:4096
  ds_read_b128 a[212:215], v193 offset:4096
  v_mfma_f32_16x16x32_bf16 v[24:27], a[128:131], a[220:223], v[24:27]
  s_add_u32 m0, s84, 16384
  v_rcp_f32 v0, v0
  v_mfma_f32_16x16x32_bf16 v[24:27], a[176:179], a[224:227], v[24:27]
  buffer_load_dwordx4 v212, s[24:27], s81 offen offset:0 lds
  v_rcp_f32 v1, v1
  v_mfma_f32_16x16x32_bf16 v[24:27], a[192:195], a[228:231], v[24:27]
  v_rcp_f32 v2, v2
  v_mfma_f32_16x16x32_bf16 v[28:31], a[196:199], a[228:231], v[28:31]
  s_mul_i32 s80, s36, 73728
  v_rcp_f32 v3, v3
  v_mfma_f32_16x16x32_bf16 v[28:31], a[180:183], a[224:227], v[28:31]
  s_add_u32 s80, s80, s85
  v_rcp_f32 v4, v4
  v_mfma_f32_16x16x32_bf16 v[28:31], a[132:135], a[220:223], v[28:31]
  buffer_load_dwordx4 v204, s[24:27], s81 offen offset:1024 lds
  v_rcp_f32 v5, v5
  v_mfma_f32_16x16x32_bf16 v[28:31], a[116:119], a[216:219], v[28:31]
  s_waitcnt lgkmcnt(0)
  v_rcp_f32 v6, v6
  v_rcp_f32 v7, v7
  v_pk_mul_f32 v[0:1], v[0:1], v[8:9]
  v_pk_mul_f32 v[2:3], v[2:3], v[10:11]
  v_pk_mul_f32 v[4:5], v[4:5], v[12:13]
  v_pk_mul_f32 v[6:7], v[6:7], v[14:15]
  v_mfma_f32_16x16x32_bf16 v[32:35], a[104:107], a[200:203], v[32:35]
  ds_read_b128 a[216:219], v190 offset:6144
  buffer_load_dwordx4 v205, s[24:27], s81 offen offset:2048 lds
  v_cvt_pk_bf16_f32 v8, v0, v1
  v_cvt_pk_bf16_f32 v9, v2, v3
  v_cvt_pk_bf16_f32 v10, v4, v5
  v_cvt_pk_bf16_f32 v11, v6, v7
  buffer_store_dwordx4 v[8:11], v209, s[16:19], s80 offen sc1
  v_pk_mul_f32 v[16:17], v[16:17], s[86:87]
  v_pk_mul_f32 v[18:19], v[18:19], s[86:87]
  v_pk_mul_f32 v[20:21], v[20:21], s[86:87]
  v_pk_mul_f32 v[22:23], v[22:23], s[86:87]
  v_mfma_f32_16x16x32_bf16 v[32:35], a[120:123], a[204:207], v[32:35]
  v_exp_f32 v16, v16
  v_mfma_f32_16x16x32_bf16 v[32:35], a[168:171], a[208:211], v[32:35]
  buffer_load_dwordx4 v206, s[24:27], s81 offen offset:3072 lds
  v_exp_f32 v17, v17
  v_mfma_f32_16x16x32_bf16 v[32:35], a[184:187], a[212:215], v[32:35]
  v_exp_f32 v18, v18
  v_mfma_f32_16x16x32_bf16 v[36:39], a[188:191], a[212:215], v[36:39]
  v_mov_b32 v252, -1
  s_add_u32 s81, s82, 98304
  s_add_u32 m0, s84, 32768
  v_exp_f32 v19, v19
  v_mfma_f32_16x16x32_bf16 v[36:39], a[172:175], a[208:211], v[36:39]
  v_mov_b32 v253, -1
  buffer_load_dwordx4 v212, s[24:27], s81 offen offset:0 lds
  v_exp_f32 v20, v20
  v_mfma_f32_16x16x32_bf16 v[36:39], a[124:127], a[204:207], v[36:39]
  v_mov_b32 v254, -1
  v_exp_f32 v21, v21
  v_mfma_f32_16x16x32_bf16 v[36:39], a[108:111], a[200:203], v[36:39]
  ds_read_b128 a[220:223], v191 offset:6144
  v_mov_b32 v255, -1
  v_exp_f32 v22, v22
  v_exp_f32 v23, v23
  v_pk_fma_f32 v[16:17], v[16:17], v[240:241], v[240:241] op_sel:[0,1,1] op_sel_hi:[1,1,1]
  v_pk_fma_f32 v[18:19], v[18:19], v[240:241], v[240:241] op_sel:[0,1,1] op_sel_hi:[1,1,1]
  v_pk_fma_f32 v[20:21], v[20:21], v[240:241], v[240:241] op_sel:[0,1,1] op_sel_hi:[1,1,1]
  v_pk_fma_f32 v[22:23], v[22:23], v[240:241], v[240:241] op_sel:[0,1,1] op_sel_hi:[1,1,1]
  v_mfma_f32_16x16x32_bf16 v[40:43], a[112:115], a[200:203], v[40:43]
  ds_read_b128 a[224:227], v192 offset:6144
  ds_read_b128 a[228:231], v193 offset:6144
  s_add_u32 s12, s16, 9584640
  s_addc_u32 s13, s17, 0
  v_mfma_f32_16x16x32_bf16 v[40:43], a[128:131], a[204:207], v[40:43]
  s_mov_b32 s14, 2097152
  buffer_load_dwordx4 v204, s[24:27], s81 offen offset:1024 lds
  v_rcp_f32 v16, v16
  v_mfma_f32_16x16x32_bf16 v[40:43], a[176:179], a[208:211], v[40:43]
  s_mov_b32 s15, 0x20000
  v_rcp_f32 v17, v17
  v_mfma_f32_16x16x32_bf16 v[40:43], a[192:195], a[212:215], v[40:43]
  s_xor_b32 s50, s49, 32768
  v_rcp_f32 v18, v18
  v_mfma_f32_16x16x32_bf16 v[44:47], a[196:199], a[212:215], v[44:47]
  s_mul_i32 s80, s37, 73728
  buffer_store_dwordx4 v[252:255], v209, s[12:15], s50 offen offset:0 sc1
  v_rcp_f32 v19, v19
  v_mfma_f32_16x16x32_bf16 v[44:47], a[180:183], a[208:211], v[44:47]
  s_add_u32 s80, s80, s85
  buffer_store_dwordx4 v[252:255], v209, s[12:15], s50 offen offset:1024 sc1
  buffer_load_dwordx4 v205, s[24:27], s81 offen offset:2048 lds
  v_rcp_f32 v20, v20
  v_mfma_f32_16x16x32_bf16 v[44:47], a[132:135], a[204:207], v[44:47]
  v_rcp_f32 v21, v21
  v_mfma_f32_16x16x32_bf16 v[44:47], a[116:119], a[200:203], v[44:47]
  s_waitcnt lgkmcnt(0)
  v_rcp_f32 v22, v22
  v_rcp_f32 v23, v23
  v_pk_mul_f32 v[16:17], v[16:17], v[24:25]
  v_pk_mul_f32 v[18:19], v[18:19], v[26:27]
  v_pk_mul_f32 v[20:21], v[20:21], v[28:29]
  v_pk_mul_f32 v[22:23], v[22:23], v[30:31]
  v_mfma_f32_16x16x32_bf16 v[48:51], a[104:107], a[216:219], v[48:51]
  ds_read_b128 a[200:203], v190 offset:8192
  buffer_load_dwordx4 v206, s[24:27], s81 offen offset:3072 lds
  v_cvt_pk_bf16_f32 v24, v16, v17
  v_cvt_pk_bf16_f32 v25, v18, v19
  v_cvt_pk_bf16_f32 v26, v20, v21
  v_cvt_pk_bf16_f32 v27, v22, v23
  buffer_store_dwordx4 v[24:27], v209, s[16:19], s80 offen sc1
  v_pk_mul_f32 v[32:33], v[32:33], s[86:87]
  v_pk_mul_f32 v[34:35], v[34:35], s[86:87]
  v_pk_mul_f32 v[36:37], v[36:37], s[86:87]
  v_pk_mul_f32 v[38:39], v[38:39], s[86:87]
  v_mfma_f32_16x16x32_bf16 v[48:51], a[120:123], a[220:223], v[48:51]
  s_waitcnt vmcnt(16)
  ds_read_b64_tr_b16 a[0:1], v200 offset:0
  ds_read_b64_tr_b16 a[2:3], v200 offset:2048
  v_exp_f32 v32, v32
  v_mfma_f32_16x16x32_bf16 v[48:51], a[168:171], a[224:227], v[48:51]
  ds_read_b64_tr_b16 a[4:5], v201 offset:0
  ds_read_b64_tr_b16 a[6:7], v201 offset:2048
  ds_read_b64_tr_b16 a[8:9], v202 offset:0
  v_exp_f32 v33, v33
  v_mfma_f32_16x16x32_bf16 v[48:51], a[184:187], a[228:231], v[48:51]
  ds_read_b64_tr_b16 a[10:11], v202 offset:2048
  ds_read_b64_tr_b16 a[12:13], v203 offset:0
  ds_read_b64_tr_b16 a[14:15], v203 offset:2048
  v_exp_f32 v34, v34
  v_mfma_f32_16x16x32_bf16 v[52:55], a[188:191], a[228:231], v[52:55]
  s_add_u32 s81, s82, 131072
  s_add_u32 m0, s84, 49152
  v_exp_f32 v35, v35
  v_mfma_f32_16x16x32_bf16 v[52:55], a[172:175], a[224:227], v[52:55]
  buffer_load_dwordx4 v212, s[24:27], s81 offen offset:0 lds
  v_exp_f32 v36, v36
  v_mfma_f32_16x16x32_bf16 v[52:55], a[124:127], a[220:223], v[52:55]
  v_exp_f32 v37, v37
  v_mfma_f32_16x16x32_bf16 v[52:55], a[108:111], a[216:219], v[52:55]
  ds_read_b128 a[204:207], v191 offset:8192
  v_exp_f32 v38, v38
  v_exp_f32 v39, v39
  v_pk_fma_f32 v[32:33], v[32:33], v[242:243], v[242:243] op_sel_hi:[1,0,0]
  v_pk_fma_f32 v[34:35], v[34:35], v[242:243], v[242:243] op_sel_hi:[1,0,0]
  v_pk_fma_f32 v[36:37], v[36:37], v[242:243], v[242:243] op_sel_hi:[1,0,0]
  v_pk_fma_f32 v[38:39], v[38:39], v[242:243], v[242:243] op_sel_hi:[1,0,0]
  v_mfma_f32_16x16x32_bf16 v[56:59], a[112:115], a[216:219], v[56:59]
  ds_read_b128 a[208:211], v192 offset:8192
  ds_read_b128 a[212:215], v193 offset:8192
  v_mfma_f32_16x16x32_bf16 v[56:59], a[128:131], a[220:223], v[56:59]
  buffer_load_dwordx4 v204, s[24:27], s81 offen offset:1024 lds
  v_rcp_f32 v32, v32
  v_mfma_f32_16x16x32_bf16 v[56:59], a[176:179], a[224:227], v[56:59]
  v_rcp_f32 v33, v33
  v_mfma_f32_16x16x32_bf16 v[56:59], a[192:195], a[228:231], v[56:59]
  v_rcp_f32 v34, v34
  v_mfma_f32_16x16x32_bf16 v[60:63], a[196:199], a[228:231], v[60:63]
  s_mul_i32 s80, s38, 73728
  v_rcp_f32 v35, v35
  v_mfma_f32_16x16x32_bf16 v[60:63], a[180:183], a[224:227], v[60:63]
  s_add_u32 s80, s80, s85
  buffer_load_dwordx4 v205, s[24:27], s81 offen offset:2048 lds
  v_rcp_f32 v36, v36
  v_mfma_f32_16x16x32_bf16 v[60:63], a[132:135], a[220:223], v[60:63]
  v_rcp_f32 v37, v37
  v_mfma_f32_16x16x32_bf16 v[60:63], a[116:119], a[216:219], v[60:63]
  s_waitcnt lgkmcnt(0)
  v_rcp_f32 v38, v38
  v_rcp_f32 v39, v39
  v_pk_mul_f32 v[32:33], v[32:33], v[40:41]
  v_pk_mul_f32 v[34:35], v[34:35], v[42:43]
  v_pk_mul_f32 v[36:37], v[36:37], v[44:45]
  v_pk_mul_f32 v[38:39], v[38:39], v[46:47]
  v_mfma_f32_16x16x32_bf16 v[64:67], a[104:107], a[200:203], v[64:67]
  ds_read_b128 a[216:219], v190 offset:10240
  buffer_load_dwordx4 v206, s[24:27], s81 offen offset:3072 lds
  v_cvt_pk_bf16_f32 v40, v32, v33
  v_cvt_pk_bf16_f32 v41, v34, v35
  v_cvt_pk_bf16_f32 v42, v36, v37
  v_cvt_pk_bf16_f32 v43, v38, v39
  buffer_store_dwordx4 v[40:43], v209, s[16:19], s80 offen sc1
  v_pk_mul_f32 v[48:49], v[48:49], s[86:87]
  v_pk_mul_f32 v[50:51], v[50:51], s[86:87]
  v_pk_mul_f32 v[52:53], v[52:53], s[86:87]
  v_pk_mul_f32 v[54:55], v[54:55], s[86:87]
  v_mfma_f32_16x16x32_bf16 v[64:67], a[120:123], a[204:207], v[64:67]
  s_waitcnt vmcnt(13)
  s_lshl_b32 s3, s36, 10
  buffer_atomic_add v211, v210, s[60:63], s3 offen sc1
  v_exp_f32 v48, v48
  v_mfma_f32_16x16x32_bf16 v[64:67], a[168:171], a[208:211], v[64:67]
  ds_read_b64_tr_b16 a[16:17], v200 offset:16384
  ds_read_b64_tr_b16 a[18:19], v200 offset:18432
  ds_read_b64_tr_b16 a[20:21], v201 offset:16384
  v_exp_f32 v49, v49
  v_mfma_f32_16x16x32_bf16 v[64:67], a[184:187], a[212:215], v[64:67]
  ds_read_b64_tr_b16 a[22:23], v201 offset:18432
  ds_read_b64_tr_b16 a[24:25], v202 offset:16384
  ds_read_b64_tr_b16 a[26:27], v202 offset:18432
  v_exp_f32 v50, v50
  v_mfma_f32_16x16x32_bf16 v[68:71], a[188:191], a[212:215], v[68:71]
  ds_read_b64_tr_b16 a[28:29], v203 offset:16384
  ds_read_b64_tr_b16 a[30:31], v203 offset:18432
  v_exp_f32 v51, v51
  v_mfma_f32_16x16x32_bf16 v[68:71], a[172:175], a[208:211], v[68:71]
  s_add_u32 s81, s83, 0
  s_add_u32 m0, s84, 131072
  v_exp_f32 v52, v52
  v_mfma_f32_16x16x32_bf16 v[68:71], a[124:127], a[204:207], v[68:71]
  buffer_load_dwordx4 v212, s[20:23], s81 offen offset:0 lds
  v_exp_f32 v53, v53
  v_mfma_f32_16x16x32_bf16 v[68:71], a[108:111], a[200:203], v[68:71]
  ds_read_b128 a[220:223], v191 offset:10240
  v_exp_f32 v54, v54
  v_exp_f32 v55, v55
  v_pk_fma_f32 v[48:49], v[48:49], v[242:243], v[242:243] op_sel:[0,1,1] op_sel_hi:[1,1,1]
  v_pk_fma_f32 v[50:51], v[50:51], v[242:243], v[242:243] op_sel:[0,1,1] op_sel_hi:[1,1,1]
  v_pk_fma_f32 v[52:53], v[52:53], v[242:243], v[242:243] op_sel:[0,1,1] op_sel_hi:[1,1,1]
  v_pk_fma_f32 v[54:55], v[54:55], v[242:243], v[242:243] op_sel:[0,1,1] op_sel_hi:[1,1,1]
  v_mfma_f32_16x16x32_bf16 v[72:75], a[112:115], a[200:203], v[72:75]
  ds_read_b128 a[224:227], v192 offset:10240
  ds_read_b128 a[228:231], v193 offset:10240
  v_mfma_f32_16x16x32_bf16 v[72:75], a[128:131], a[204:207], v[72:75]
  buffer_load_dwordx4 v204, s[20:23], s81 offen offset:1024 lds
  v_rcp_f32 v48, v48
  v_mfma_f32_16x16x32_bf16 v[72:75], a[176:179], a[208:211], v[72:75]
  v_rcp_f32 v49, v49
  v_mfma_f32_16x16x32_bf16 v[72:75], a[192:195], a[212:215], v[72:75]
  v_rcp_f32 v50, v50
  v_mfma_f32_16x16x32_bf16 v[76:79], a[196:199], a[212:215], v[76:79]
  s_mul_i32 s80, s39, 73728
  v_rcp_f32 v51, v51
  v_mfma_f32_16x16x32_bf16 v[76:79], a[180:183], a[208:211], v[76:79]
  s_add_u32 s80, s80, s85
  buffer_load_dwordx4 v205, s[20:23], s81 offen offset:2048 lds
  v_rcp_f32 v52, v52
  v_mfma_f32_16x16x32_bf16 v[76:79], a[132:135], a[204:207], v[76:79]
  s_waitcnt vmcnt(16)
  ds_read_b64_tr_b16 a[32:33], v217 offset:16384
  ds_read_b64_tr_b16 a[34:35], v217 offset:18432
  v_rcp_f32 v53, v53
  v_mfma_f32_16x16x32_bf16 v[76:79], a[116:119], a[200:203], v[76:79]
  s_waitcnt lgkmcnt(2)
  ds_read_b64_tr_b16 a[36:37], v218 offset:16384
  ds_read_b64_tr_b16 a[38:39], v218 offset:18432
  v_rcp_f32 v54, v54
  v_rcp_f32 v55, v55
  v_pk_mul_f32 v[48:49], v[48:49], v[56:57]
  v_pk_mul_f32 v[50:51], v[50:51], v[58:59]
  v_pk_mul_f32 v[52:53], v[52:53], v[60:61]
  v_pk_mul_f32 v[54:55], v[54:55], v[62:63]
  v_mfma_f32_16x16x32_bf16 v[80:83], a[104:107], a[216:219], v[80:83]
  ds_read_b128 a[200:203], v190 offset:12288
  buffer_load_dwordx4 v206, s[20:23], s81 offen offset:3072 lds
  ds_read_b64_tr_b16 a[40:41], v219 offset:16384
  v_cvt_pk_bf16_f32 v56, v48, v49
  v_cvt_pk_bf16_f32 v57, v50, v51
  v_cvt_pk_bf16_f32 v58, v52, v53
  v_cvt_pk_bf16_f32 v59, v54, v55
  buffer_store_dwordx4 v[56:59], v209, s[16:19], s80 offen sc1
  v_pk_mul_f32 v[64:65], v[64:65], s[86:87]
  v_pk_mul_f32 v[66:67], v[66:67], s[86:87]
  v_pk_mul_f32 v[68:69], v[68:69], s[86:87]
  v_pk_mul_f32 v[70:71], v[70:71], s[86:87]
  v_mfma_f32_16x16x32_bf16 v[80:83], a[120:123], a[220:223], v[80:83]
  s_waitcnt vmcnt(14)
  buffer_atomic_add v211, v221, s[60:63], 0 offen sc1
  ds_read_b64_tr_b16 a[42:43], v219 offset:18432
  v_exp_f32 v64, v64
  v_mfma_f32_16x16x32_bf16 v[80:83], a[168:171], a[224:227], v[80:83]
  ds_read_b64_tr_b16 a[44:45], v220 offset:16384
  ds_read_b64_tr_b16 a[46:47], v220 offset:18432
  v_exp_f32 v65, v65
  v_mfma_f32_16x16x32_bf16 v[80:83], a[184:187], a[228:231], v[80:83]
  s_waitcnt vmcnt(12)
  s_lshl_b32 s3, s37, 10
  buffer_atomic_add v211, v210, s[60:63], s3 offen sc1
  s_add_u32 s81, s83, 32768
  v_exp_f32 v66, v66
  v_mfma_f32_16x16x32_bf16 v[84:87], a[188:191], a[228:231], v[84:87]
  s_add_u32 m0, s84, 147456
  v_exp_f32 v67, v67
  v_mfma_f32_16x16x32_bf16 v[84:87], a[172:175], a[224:227], v[84:87]
  buffer_load_dwordx4 v212, s[20:23], s81 offen offset:0 lds
  v_exp_f32 v68, v68
  v_mfma_f32_16x16x32_bf16 v[84:87], a[124:127], a[220:223], v[84:87]
  v_exp_f32 v69, v69
  v_mfma_f32_16x16x32_bf16 v[84:87], a[108:111], a[216:219], v[84:87]
  ds_read_b128 a[204:207], v191 offset:12288
  v_exp_f32 v70, v70
  v_exp_f32 v71, v71
  v_pk_fma_f32 v[64:65], v[64:65], v[244:245], v[244:245] op_sel_hi:[1,0,0]
  v_pk_fma_f32 v[66:67], v[66:67], v[244:245], v[244:245] op_sel_hi:[1,0,0]
  v_pk_fma_f32 v[68:69], v[68:69], v[244:245], v[244:245] op_sel_hi:[1,0,0]
  v_pk_fma_f32 v[70:71], v[70:71], v[244:245], v[244:245] op_sel_hi:[1,0,0]
  v_mfma_f32_16x16x32_bf16 v[88:91], a[112:115], a[216:219], v[88:91]
  ds_read_b128 a[208:211], v192 offset:12288
  ds_read_b128 a[212:215], v193 offset:12288
  v_mfma_f32_16x16x32_bf16 v[88:91], a[128:131], a[220:223], v[88:91]
  buffer_load_dwordx4 v204, s[20:23], s81 offen offset:1024 lds
  v_rcp_f32 v64, v64
  v_mfma_f32_16x16x32_bf16 v[88:91], a[176:179], a[224:227], v[88:91]
  v_rcp_f32 v65, v65
  v_mfma_f32_16x16x32_bf16 v[88:91], a[192:195], a[228:231], v[88:91]
  ds_read_b64_tr_b16 a[48:49], v217 offset:32768
  ds_read_b64_tr_b16 a[50:51], v217 offset:34816
  v_rcp_f32 v66, v66
  v_mfma_f32_16x16x32_bf16 v[92:95], a[196:199], a[228:231], v[92:95]
  s_mul_i32 s80, s40, 73728
  ds_read_b64_tr_b16 a[52:53], v218 offset:32768
  ds_read_b64_tr_b16 a[54:55], v218 offset:34816
  v_rcp_f32 v67, v67
  v_mfma_f32_16x16x32_bf16 v[92:95], a[180:183], a[224:227], v[92:95]
  s_add_u32 s80, s80, s85
  buffer_load_dwordx4 v205, s[20:23], s81 offen offset:2048 lds
  ds_read_b64_tr_b16 a[56:57], v219 offset:32768
  v_rcp_f32 v68, v68
  v_mfma_f32_16x16x32_bf16 v[92:95], a[132:135], a[220:223], v[92:95]
  ds_read_b64_tr_b16 a[58:59], v219 offset:34816
  ds_read_b64_tr_b16 a[60:61], v220 offset:32768
  ds_read_b64_tr_b16 a[62:63], v220 offset:34816
  v_rcp_f32 v69, v69
  v_mfma_f32_16x16x32_bf16 v[92:95], a[116:119], a[216:219], v[92:95]
  s_waitcnt lgkmcnt(8)
  v_rcp_f32 v70, v70
  v_rcp_f32 v71, v71
  v_pk_mul_f32 v[64:65], v[64:65], v[72:73]
  v_pk_mul_f32 v[66:67], v[66:67], v[74:75]
  v_pk_mul_f32 v[68:69], v[68:69], v[76:77]
  v_pk_mul_f32 v[70:71], v[70:71], v[78:79]
  v_mfma_f32_16x16x32_bf16 v[96:99], a[104:107], a[200:203], v[96:99]
  ds_read_b128 a[216:219], v190 offset:14336
  buffer_load_dwordx4 v206, s[20:23], s81 offen offset:3072 lds
  v_cvt_pk_bf16_f32 v72, v64, v65
  v_cvt_pk_bf16_f32 v73, v66, v67
  v_cvt_pk_bf16_f32 v74, v68, v69
  v_cvt_pk_bf16_f32 v75, v70, v71
  buffer_store_dwordx4 v[72:75], v209, s[16:19], s80 offen sc1
  v_pk_mul_f32 v[80:81], v[80:81], s[86:87]
  v_pk_mul_f32 v[82:83], v[82:83], s[86:87]
  v_pk_mul_f32 v[84:85], v[84:85], s[86:87]
  v_pk_mul_f32 v[86:87], v[86:87], s[86:87]
  v_mfma_f32_16x16x32_bf16 v[96:99], a[120:123], a[204:207], v[96:99]
  s_add_u32 s81, s83, 65536
  s_add_u32 m0, s84, 16384
  v_exp_f32 v80, v80
  v_mfma_f32_16x16x32_bf16 v[96:99], a[168:171], a[208:211], v[96:99]
  buffer_load_dwordx4 v212, s[20:23], s81 offen offset:0 lds
  v_exp_f32 v81, v81
  v_mfma_f32_16x16x32_bf16 v[96:99], a[184:187], a[212:215], v[96:99]
  s_waitcnt vmcnt(14)
  s_lshl_b32 s3, s38, 10
  buffer_atomic_add v211, v210, s[60:63], s3 offen sc1
  v_exp_f32 v82, v82
  v_mfma_f32_16x16x32_bf16 v[100:103], a[188:191], a[212:215], v[100:103]
  v_exp_f32 v83, v83
  v_mfma_f32_16x16x32_bf16 v[100:103], a[172:175], a[208:211], v[100:103]
  buffer_load_dwordx4 v204, s[20:23], s81 offen offset:1024 lds
  v_exp_f32 v84, v84
  v_mfma_f32_16x16x32_bf16 v[100:103], a[124:127], a[204:207], v[100:103]
  v_exp_f32 v85, v85
  v_mfma_f32_16x16x32_bf16 v[100:103], a[108:111], a[200:203], v[100:103]
  ds_read_b128 a[220:223], v191 offset:14336
  v_exp_f32 v86, v86
  v_exp_f32 v87, v87
  v_pk_fma_f32 v[80:81], v[80:81], v[244:245], v[244:245] op_sel:[0,1,1] op_sel_hi:[1,1,1]
  v_pk_fma_f32 v[82:83], v[82:83], v[244:245], v[244:245] op_sel:[0,1,1] op_sel_hi:[1,1,1]
  v_pk_fma_f32 v[84:85], v[84:85], v[244:245], v[244:245] op_sel:[0,1,1] op_sel_hi:[1,1,1]
  v_pk_fma_f32 v[86:87], v[86:87], v[244:245], v[244:245] op_sel:[0,1,1] op_sel_hi:[1,1,1]
  v_mfma_f32_16x16x32_bf16 v[104:107], a[112:115], a[200:203], v[104:107]
  ds_read_b128 a[224:227], v192 offset:14336
  ds_read_b128 a[228:231], v193 offset:14336
  v_mfma_f32_16x16x32_bf16 v[104:107], a[128:131], a[204:207], v[104:107]
  buffer_load_dwordx4 v205, s[20:23], s81 offen offset:2048 lds
  v_rcp_f32 v80, v80
  v_mfma_f32_16x16x32_bf16 v[104:107], a[176:179], a[208:211], v[104:107]
  ds_read_b64_tr_b16 a[64:65], v217 offset:49152
  ds_read_b64_tr_b16 a[66:67], v217 offset:51200
  v_rcp_f32 v81, v81
  v_mfma_f32_16x16x32_bf16 v[104:107], a[192:195], a[212:215], v[104:107]
  ds_read_b64_tr_b16 a[68:69], v218 offset:49152
  ds_read_b64_tr_b16 a[70:71], v218 offset:51200
  ds_read_b64_tr_b16 a[72:73], v219 offset:49152
  v_rcp_f32 v82, v82
  v_mfma_f32_16x16x32_bf16 v[108:111], a[196:199], a[212:215], v[108:111]
  s_mul_i32 s80, s41, 73728
  ds_read_b64_tr_b16 a[74:75], v219 offset:51200
  ds_read_b64_tr_b16 a[76:77], v220 offset:49152
  v_rcp_f32 v83, v83
  v_mfma_f32_16x16x32_bf16 v[108:111], a[180:183], a[208:211], v[108:111]
  s_add_u32 s80, s80, s85
  buffer_load_dwordx4 v206, s[20:23], s81 offen offset:3072 lds
  ds_read_b64_tr_b16 a[78:79], v220 offset:51200
  v_rcp_f32 v84, v84
  v_mfma_f32_16x16x32_bf16 v[108:111], a[132:135], a[204:207], v[108:111]
  v_rcp_f32 v85, v85
  v_mfma_f32_16x16x32_bf16 v[108:111], a[116:119], a[200:203], v[108:111]
  s_waitcnt lgkmcnt(8)
  s_add_u32 s81, s83, 98304
  v_rcp_f32 v86, v86
  v_rcp_f32 v87, v87
  v_pk_mul_f32 v[80:81], v[80:81], v[88:89]
  v_pk_mul_f32 v[82:83], v[82:83], v[90:91]
  v_pk_mul_f32 v[84:85], v[84:85], v[92:93]
  v_pk_mul_f32 v[86:87], v[86:87], v[94:95]
  v_mfma_f32_16x16x32_bf16 v[112:115], a[104:107], a[216:219], v[112:115]
  ds_read_b128 a[200:203], v190 offset:16384
  s_add_u32 m0, s84, 32768
  v_cvt_pk_bf16_f32 v88, v80, v81
  v_cvt_pk_bf16_f32 v89, v82, v83
  v_cvt_pk_bf16_f32 v90, v84, v85
  v_cvt_pk_bf16_f32 v91, v86, v87
  buffer_store_dwordx4 v[88:91], v209, s[16:19], s80 offen sc1
  v_pk_mul_f32 v[96:97], v[96:97], s[86:87]
  v_pk_mul_f32 v[98:99], v[98:99], s[86:87]
  v_pk_mul_f32 v[100:101], v[100:101], s[86:87]
  v_pk_mul_f32 v[102:103], v[102:103], s[86:87]
  v_mfma_f32_16x16x32_bf16 v[112:115], a[120:123], a[220:223], v[112:115]
  buffer_load_dwordx4 v212, s[20:23], s81 offen offset:0 lds
  v_exp_f32 v96, v96
  v_mfma_f32_16x16x32_bf16 v[112:115], a[168:171], a[224:227], v[112:115]
  v_mov_b32 v215, 0
  s_mov_b64 exec, 15
  buffer_atomic_add v215, v214, s[60:63], 0 offen sc0 sc1
  s_mov_b64 exec, -1
  v_exp_f32 v97, v97
  v_mfma_f32_16x16x32_bf16 v[112:115], a[184:187], a[228:231], v[112:115]
  s_waitcnt vmcnt(15)
  s_lshl_b32 s3, s39, 10
  buffer_atomic_add v211, v210, s[60:63], s3 offen sc1
  v_exp_f32 v98, v98
  v_mfma_f32_16x16x32_bf16 v[116:119], a[188:191], a[228:231], v[116:119]
  buffer_load_dwordx4 v204, s[20:23], s81 offen offset:1024 lds
  v_exp_f32 v99, v99
  v_mfma_f32_16x16x32_bf16 v[116:119], a[172:175], a[224:227], v[116:119]
  v_exp_f32 v100, v100
  v_mfma_f32_16x16x32_bf16 v[116:119], a[124:127], a[220:223], v[116:119]
  v_exp_f32 v101, v101
  v_mfma_f32_16x16x32_bf16 v[116:119], a[108:111], a[216:219], v[116:119]
  ds_read_b128 a[204:207], v191 offset:16384
  v_exp_f32 v102, v102
  v_exp_f32 v103, v103
  v_pk_fma_f32 v[96:97], v[96:97], v[246:247], v[246:247] op_sel_hi:[1,0,0]
  v_pk_fma_f32 v[98:99], v[98:99], v[246:247], v[246:247] op_sel_hi:[1,0,0]
  v_pk_fma_f32 v[100:101], v[100:101], v[246:247], v[246:247] op_sel_hi:[1,0,0]
  v_pk_fma_f32 v[102:103], v[102:103], v[246:247], v[246:247] op_sel_hi:[1,0,0]
  v_mfma_f32_16x16x32_bf16 v[120:123], a[112:115], a[216:219], v[120:123]
  ds_read_b128 a[208:211], v192 offset:16384
  ds_read_b128 a[212:215], v193 offset:16384
  v_mfma_f32_16x16x32_bf16 v[120:123], a[128:131], a[220:223], v[120:123]
  buffer_load_dwordx4 v205, s[20:23], s81 offen offset:2048 lds
  v_rcp_f32 v96, v96
  v_mfma_f32_16x16x32_bf16 v[120:123], a[176:179], a[224:227], v[120:123]
  v_rcp_f32 v97, v97
  v_mfma_f32_16x16x32_bf16 v[120:123], a[192:195], a[228:231], v[120:123]
  v_rcp_f32 v98, v98
  v_mfma_f32_16x16x32_bf16 v[124:127], a[196:199], a[228:231], v[124:127]
  s_mul_i32 s80, s42, 73728
  v_rcp_f32 v99, v99
  v_mfma_f32_16x16x32_bf16 v[124:127], a[180:183], a[224:227], v[124:127]
  s_add_u32 s80, s80, s85
  buffer_load_dwordx4 v206, s[20:23], s81 offen offset:3072 lds
  v_rcp_f32 v100, v100
  v_mfma_f32_16x16x32_bf16 v[124:127], a[132:135], a[220:223], v[124:127]
  v_rcp_f32 v101, v101
  v_mfma_f32_16x16x32_bf16 v[124:127], a[116:119], a[216:219], v[124:127]
  s_waitcnt lgkmcnt(0)
  v_rcp_f32 v102, v102
  v_rcp_f32 v103, v103
  v_pk_mul_f32 v[96:97], v[96:97], v[104:105]
  v_pk_mul_f32 v[98:99], v[98:99], v[106:107]
  v_pk_mul_f32 v[100:101], v[100:101], v[108:109]
  v_pk_mul_f32 v[102:103], v[102:103], v[110:111]
  v_mfma_f32_16x16x32_bf16 v[128:131], a[104:107], a[200:203], v[128:131]
  ds_read_b128 a[216:219], v190 offset:18432
  v_cvt_pk_bf16_f32 v104, v96, v97
  v_cvt_pk_bf16_f32 v105, v98, v99
  v_cvt_pk_bf16_f32 v106, v100, v101
  v_cvt_pk_bf16_f32 v107, v102, v103
  buffer_store_dwordx4 v[104:107], v209, s[16:19], s80 offen sc1
  v_pk_mul_f32 v[112:113], v[112:113], s[86:87]
  v_pk_mul_f32 v[114:115], v[114:115], s[86:87]
  v_pk_mul_f32 v[116:117], v[116:117], s[86:87]
  v_pk_mul_f32 v[118:119], v[118:119], s[86:87]
  v_mfma_f32_16x16x32_bf16 v[128:131], a[120:123], a[204:207], v[128:131]
  v_exp_f32 v112, v112
  v_mfma_f32_16x16x32_bf16 v[128:131], a[168:171], a[208:211], v[128:131]
  v_exp_f32 v113, v113
  v_mfma_f32_16x16x32_bf16 v[128:131], a[184:187], a[212:215], v[128:131]
  s_waitcnt vmcnt(13)
  s_lshl_b32 s3, s40, 10
  buffer_atomic_add v211, v210, s[60:63], s3 offen sc1
  v_exp_f32 v114, v114
  v_mfma_f32_16x16x32_bf16 v[132:135], a[188:191], a[212:215], v[132:135]
  v_exp_f32 v115, v115
  v_mfma_f32_16x16x32_bf16 v[132:135], a[172:175], a[208:211], v[132:135]
  v_exp_f32 v116, v116
  v_mfma_f32_16x16x32_bf16 v[132:135], a[124:127], a[204:207], v[132:135]
  v_exp_f32 v117, v117
  v_mfma_f32_16x16x32_bf16 v[132:135], a[108:111], a[200:203], v[132:135]
  ds_read_b128 a[220:223], v191 offset:18432
  v_exp_f32 v118, v118
  v_exp_f32 v119, v119
  v_pk_fma_f32 v[112:113], v[112:113], v[246:247], v[246:247] op_sel:[0,1,1] op_sel_hi:[1,1,1]
  v_pk_fma_f32 v[114:115], v[114:115], v[246:247], v[246:247] op_sel:[0,1,1] op_sel_hi:[1,1,1]
  v_pk_fma_f32 v[116:117], v[116:117], v[246:247], v[246:247] op_sel:[0,1,1] op_sel_hi:[1,1,1]
  v_pk_fma_f32 v[118:119], v[118:119], v[246:247], v[246:247] op_sel:[0,1,1] op_sel_hi:[1,1,1]
  v_mfma_f32_16x16x32_bf16 v[136:139], a[112:115], a[200:203], v[136:139]
  ds_read_b128 a[224:227], v192 offset:18432
  ds_read_b128 a[228:231], v193 offset:18432
  v_mfma_f32_16x16x32_bf16 v[136:139], a[128:131], a[204:207], v[136:139]
  v_rcp_f32 v112, v112
  v_mfma_f32_16x16x32_bf16 v[136:139], a[176:179], a[208:211], v[136:139]
  v_rcp_f32 v113, v113
  v_mfma_f32_16x16x32_bf16 v[136:139], a[192:195], a[212:215], v[136:139]
  v_rcp_f32 v114, v114
  v_mfma_f32_16x16x32_bf16 v[140:143], a[196:199], a[212:215], v[140:143]
  s_mul_i32 s80, s43, 73728
  v_rcp_f32 v115, v115
  v_mfma_f32_16x16x32_bf16 v[140:143], a[180:183], a[208:211], v[140:143]
  s_add_u32 s80, s80, s85
  v_rcp_f32 v116, v116
  v_mfma_f32_16x16x32_bf16 v[140:143], a[132:135], a[204:207], v[140:143]
  v_rcp_f32 v117, v117
  v_mfma_f32_16x16x32_bf16 v[140:143], a[116:119], a[200:203], v[140:143]
  s_waitcnt lgkmcnt(0)
  v_rcp_f32 v118, v118
  v_rcp_f32 v119, v119
  v_pk_mul_f32 v[112:113], v[112:113], v[120:121]
  v_pk_mul_f32 v[114:115], v[114:115], v[122:123]
  v_pk_mul_f32 v[116:117], v[116:117], v[124:125]
  v_pk_mul_f32 v[118:119], v[118:119], v[126:127]
  v_mfma_f32_16x16x32_bf16 v[144:147], a[104:107], a[216:219], v[144:147]
  ds_read_b128 a[200:203], v190 offset:20480
  v_cvt_pk_bf16_f32 v120, v112, v113
  v_cvt_pk_bf16_f32 v121, v114, v115
  v_cvt_pk_bf16_f32 v122, v116, v117
  v_cvt_pk_bf16_f32 v123, v118, v119
  buffer_store_dwordx4 v[120:123], v209, s[16:19], s80 offen sc1
  v_pk_mul_f32 v[128:129], v[128:129], s[86:87]
  v_pk_mul_f32 v[130:131], v[130:131], s[86:87]
  v_pk_mul_f32 v[132:133], v[132:133], s[86:87]
  v_pk_mul_f32 v[134:135], v[134:135], s[86:87]
  v_mfma_f32_16x16x32_bf16 v[144:147], a[120:123], a[220:223], v[144:147]
  s_waitcnt vmcnt(7)
  v_cmp_gt_u32 vcc, v207, v215
  s_and_b32 s54, vcc_lo, 0xff
  s_and_b32 s51, s54, 3
  s_cselect_b32 s51, 1073741824, 0
  v_exp_f32 v128, v128
  v_mfma_f32_16x16x32_bf16 v[144:147], a[168:171], a[224:227], v[144:147]
  v_readlane_b32 s56, v216, 0
  s_mul_i32 s56, s56, 73728
  v_exp_f32 v129, v129
  v_mfma_f32_16x16x32_bf16 v[144:147], a[184:187], a[228:231], v[144:147]
  s_add_u32 s56, s56, s55
  s_add_u32 s56, s56, s51
  v_exp_f32 v130, v130
  v_mfma_f32_16x16x32_bf16 v[148:151], a[188:191], a[228:231], v[148:151]
  v_readlane_b32 s57, v216, 1
  s_mul_i32 s57, s57, 73728
  v_exp_f32 v131, v131
  v_mfma_f32_16x16x32_bf16 v[148:151], a[172:175], a[224:227], v[148:151]
  s_add_u32 s57, s57, s55
  s_add_u32 s57, s57, s51
  v_exp_f32 v132, v132
  v_mfma_f32_16x16x32_bf16 v[148:151], a[124:127], a[220:223], v[148:151]
  s_add_u32 s47, s56, 0
  v_exp_f32 v133, v133
  v_mfma_f32_16x16x32_bf16 v[148:151], a[108:111], a[216:219], v[148:151]
  ds_read_b128 a[204:207], v191 offset:20480
  buffer_load_dwordx4 v[0:3], v209, s[16:19], s47 offen offset:0 sc1
  v_exp_f32 v134, v134
  v_exp_f32 v135, v135
  v_pk_fma_f32 v[128:129], v[128:129], v[248:249], v[248:249] op_sel_hi:[1,0,0]
  v_pk_fma_f32 v[130:131], v[130:131], v[248:249], v[248:249] op_sel_hi:[1,0,0]
  v_pk_fma_f32 v[132:133], v[132:133], v[248:249], v[248:249] op_sel_hi:[1,0,0]
  v_pk_fma_f32 v[134:135], v[134:135], v[248:249], v[248:249] op_sel_hi:[1,0,0]
  v_mfma_f32_16x16x32_bf16 v[152:155], a[112:115], a[216:219], v[152:155]
  ds_read_b128 a[208:211], v192 offset:20480
  ds_read_b128 a[212:215], v193 offset:20480
  v_mfma_f32_16x16x32_bf16 v[152:155], a[128:131], a[220:223], v[152:155]
  v_rcp_f32 v128, v128
  v_mfma_f32_16x16x32_bf16 v[152:155], a[176:179], a[224:227], v[152:155]
  v_rcp_f32 v129, v129
  v_mfma_f32_16x16x32_bf16 v[152:155], a[192:195], a[228:231], v[152:155]
  buffer_load_dwordx4 v[4:7], v209, s[16:19], s47 offen offset:1024 sc1
  v_rcp_f32 v130, v130
  v_mfma_f32_16x16x32_bf16 v[156:159], a[196:199], a[228:231], v[156:159]
  s_mul_i32 s80, s44, 73728
  s_lshl_b32 s3, s41, 10
  buffer_atomic_add v211, v210, s[60:63], s3 offen sc1
  v_rcp_f32 v131, v131
  v_mfma_f32_16x16x32_bf16 v[156:159], a[180:183], a[224:227], v[156:159]
  s_add_u32 s80, s80, s85
  v_rcp_f32 v132, v132
  v_mfma_f32_16x16x32_bf16 v[156:159], a[132:135], a[220:223], v[156:159]
  v_rcp_f32 v133, v133
  v_mfma_f32_16x16x32_bf16 v[156:159], a[116:119], a[216:219], v[156:159]
  s_waitcnt lgkmcnt(0)
  buffer_load_dwordx4 v[8:11], v209, s[16:19], s47 offen offset:2048 sc1
  v_rcp_f32 v134, v134
  v_rcp_f32 v135, v135
  v_pk_mul_f32 v[128:129], v[128:129], v[136:137]
  v_pk_mul_f32 v[130:131], v[130:131], v[138:139]
  v_pk_mul_f32 v[132:133], v[132:133], v[140:141]
  v_pk_mul_f32 v[134:135], v[134:135], v[142:143]
  v_mfma_f32_16x16x32_bf16 v[160:163], a[104:107], a[200:203], v[160:163]
  s_xor_b32 s74, s51, 1073741824
  v_mov_b32 v213, 0
  buffer_atomic_add v213, v214, s[60:63], s74 offen sc0 sc1
  v_cvt_pk_bf16_f32 v136, v128, v129
  v_cvt_pk_bf16_f32 v137, v130, v131
  v_cvt_pk_bf16_f32 v138, v132, v133
  v_cvt_pk_bf16_f32 v139, v134, v135
  buffer_store_dwordx4 v[136:139], v209, s[16:19], s80 offen sc1
  v_pk_mul_f32 v[144:145], v[144:145], s[86:87]
  v_pk_mul_f32 v[146:147], v[146:147], s[86:87]
  v_pk_mul_f32 v[148:149], v[148:149], s[86:87]
  v_pk_mul_f32 v[150:151], v[150:151], s[86:87]
  v_mfma_f32_16x16x32_bf16 v[160:163], a[120:123], a[204:207], v[160:163]
  v_exp_f32 v144, v144
  v_mfma_f32_16x16x32_bf16 v[160:163], a[168:171], a[208:211], v[160:163]
  v_exp_f32 v145, v145
  v_mfma_f32_16x16x32_bf16 v[160:163], a[184:187], a[212:215], v[160:163]
  buffer_load_dwordx4 v[12:15], v209, s[16:19], s47 offen offset:3072 sc1
  v_exp_f32 v146, v146
  v_mfma_f32_16x16x32_bf16 v[164:167], a[188:191], a[212:215], v[164:167]
  v_exp_f32 v147, v147
  v_mfma_f32_16x16x32_bf16 v[164:167], a[172:175], a[208:211], v[164:167]
  v_exp_f32 v148, v148
  v_mfma_f32_16x16x32_bf16 v[164:167], a[124:127], a[204:207], v[164:167]
  s_add_u32 s47, s56, 4096
  v_exp_f32 v149, v149
  v_mfma_f32_16x16x32_bf16 v[164:167], a[108:111], a[200:203], v[164:167]
  buffer_load_dwordx4 v[16:19], v209, s[16:19], s47 offen offset:0 sc1
  v_exp_f32 v150, v150
  v_exp_f32 v151, v151
  v_pk_fma_f32 v[144:145], v[144:145], v[248:249], v[248:249] op_sel:[0,1,1] op_sel_hi:[1,1,1]
  v_pk_fma_f32 v[146:147], v[146:147], v[248:249], v[248:249] op_sel:[0,1,1] op_sel_hi:[1,1,1]
  v_pk_fma_f32 v[148:149], v[148:149], v[248:249], v[248:249] op_sel:[0,1,1] op_sel_hi:[1,1,1]
  v_pk_fma_f32 v[150:151], v[150:151], v[248:249], v[248:249] op_sel:[0,1,1] op_sel_hi:[1,1,1]
  v_mfma_f32_16x16x32_bf16 v[168:171], a[112:115], a[200:203], v[168:171]
  v_mfma_f32_16x16x32_bf16 v[168:171], a[128:131], a[204:207], v[168:171]
  v_rcp_f32 v144, v144
  v_mfma_f32_16x16x32_bf16 v[168:171], a[176:179], a[208:211], v[168:171]
  v_rcp_f32 v145, v145
  v_mfma_f32_16x16x32_bf16 v[168:171], a[192:195], a[212:215], v[168:171]
  buffer_load_dwordx4 v[20:23], v209, s[16:19], s47 offen offset:1024 sc1
  v_rcp_f32 v146, v146
  v_mfma_f32_16x16x32_bf16 v[172:175], a[196:199], a[212:215], v[172:175]
  s_mul_i32 s80, s45, 73728
  s_waitcnt vmcnt(11)
  s_lshl_b32 s3, s42, 10
  buffer_atomic_add v211, v210, s[60:63], s3 offen sc1
  v_rcp_f32 v147, v147
  v_mfma_f32_16x16x32_bf16 v[172:175], a[180:183], a[208:211], v[172:175]
  s_add_u32 s80, s80, s85
  v_rcp_f32 v148, v148
  v_mfma_f32_16x16x32_bf16 v[172:175], a[132:135], a[204:207], v[172:175]
  v_rcp_f32 v149, v149
  v_mfma_f32_16x16x32_bf16 v[172:175], a[116:119], a[200:203], v[172:175]
  buffer_load_dwordx4 v[24:27], v209, s[16:19], s47 offen offset:2048 sc1
  v_rcp_f32 v150, v150
  v_rcp_f32 v151, v151
  v_pk_mul_f32 v[144:145], v[144:145], v[152:153]
  v_pk_mul_f32 v[146:147], v[146:147], v[154:155]
  v_pk_mul_f32 v[148:149], v[148:149], v[156:157]
  v_pk_mul_f32 v[150:151], v[150:151], v[158:159]
  v_cvt_pk_bf16_f32 v152, v144, v145
  v_cvt_pk_bf16_f32 v153, v146, v147
  v_cvt_pk_bf16_f32 v154, v148, v149
  v_cvt_pk_bf16_f32 v155, v150, v151
  buffer_store_dwordx4 v[152:155], v209, s[16:19], s80 offen sc1
  v_pk_mul_f32 v[160:161], v[160:161], s[86:87]
  v_pk_mul_f32 v[162:163], v[162:163], s[86:87]
  v_pk_mul_f32 v[164:165], v[164:165], s[86:87]
  v_pk_mul_f32 v[166:167], v[166:167], s[86:87]
  buffer_load_dwordx4 v[28:31], v209, s[16:19], s47 offen offset:3072 sc1
  v_exp_f32 v160, v160
  v_exp_f32 v161, v161
  v_exp_f32 v162, v162
  s_add_u32 s47, s56, 8192
  v_exp_f32 v163, v163
  buffer_load_dwordx4 v[32:35], v209, s[16:19], s47 offen offset:0 sc1
  v_exp_f32 v164, v164
  v_exp_f32 v165, v165
  v_exp_f32 v166, v166
  s_add_u32 s47, s57, 0
  v_exp_f32 v167, v167
  buffer_load_dwordx4 v[36:39], v209, s[16:19], s47 offen offset:0 sc1
  v_pk_fma_f32 v[160:161], v[160:161], v[250:251], v[250:251] op_sel_hi:[1,0,0]
  v_pk_fma_f32 v[162:163], v[162:163], v[250:251], v[250:251] op_sel_hi:[1,0,0]
  v_pk_fma_f32 v[164:165], v[164:165], v[250:251], v[250:251] op_sel_hi:[1,0,0]
  v_pk_fma_f32 v[166:167], v[166:167], v[250:251], v[250:251] op_sel_hi:[1,0,0]
  buffer_load_dwordx4 v[40:43], v209, s[16:19], s47 offen offset:1024 sc1
  v_rcp_f32 v160, v160
  v_rcp_f32 v161, v161
  v_rcp_f32 v162, v162
  v_rcp_f32 v163, v163
  buffer_load_dwordx4 v[44:47], v209, s[16:19], s47 offen offset:2048 sc1
  v_rcp_f32 v164, v164
  v_rcp_f32 v165, v165
  v_rcp_f32 v166, v166
  v_rcp_f32 v167, v167
  buffer_load_dwordx4 v[48:51], v209, s[16:19], s47 offen offset:3072 sc1
  v_pk_mul_f32 v[160:161], v[160:161], v[168:169]
  s_and_b32 s74, s54, 15
  s_cselect_b32 s74, 0, 1073741824
  v_mov_b32 v215, 0
  s_mov_b64 exec, 15
  buffer_atomic_add v215, v214, s[60:63], s74 offen sc0 sc1
  s_mov_b64 exec, -1
  v_pk_mul_f32 v[162:163], v[162:163], v[170:171]
  v_pk_mul_f32 v[164:165], v[164:165], v[172:173]
  v_pk_mul_f32 v[166:167], v[166:167], v[174:175]
  v_cvt_pk_bf16_f32 v168, v160, v161
  v_cvt_pk_bf16_f32 v169, v162, v163
  v_cvt_pk_bf16_f32 v170, v164, v165
  v_cvt_pk_bf16_f32 v171, v166, v167
  s_mul_i32 s80, s46, 73728
  s_add_u32 s80, s80, s85
  buffer_store_dwordx4 v[168:171], v209, s[16:19], s80 offen sc1
  s_cmp_lg_u32 s51, 0
  s_cbranch_scc1 L_thif
L_thif_ret:
  s_waitcnt vmcnt(19)
  v_mfma_f32_16x16x32_bf16 v[80:83], a[0:3], v[0:3], 0
  v_mfma_f32_16x16x32_bf16 v[84:87], a[4:7], v[0:3], 0
  ds_read_b64_tr_b16 a[80:81], v200 offset:0
  v_mfma_f32_16x16x32_bf16 v[88:91], a[8:11], v[0:3], 0
  s_lshl_b32 s3, s43, 10
  buffer_atomic_add v211, v210, s[60:63], s3 offen sc1
  ds_read_b64_tr_b16 a[82:83], v200 offset:2048
  ds_read_b64_tr_b16 a[84:85], v201 offset:0
  v_mfma_f32_16x16x32_bf16 v[92:95], a[12:15], v[0:3], 0
  s_waitcnt vmcnt(19)
  s_add_u32 s47, s57, 4096
  ds_read_b64_tr_b16 a[86:87], v201 offset:2048
  ds_read_b64_tr_b16 a[88:89], v202 offset:0
  v_mfma_f32_16x16x32_bf16 v[80:83], a[16:19], v[4:7], v[80:83]
  buffer_load_dwordx4 v[0:3], v209, s[16:19], s47 offen offset:0 sc1
  ds_read_b64_tr_b16 a[90:91], v202 offset:2048
  ds_read_b64_tr_b16 a[92:93], v203 offset:0
  v_mfma_f32_16x16x32_bf16 v[84:87], a[20:23], v[4:7], v[84:87]
  ds_read_b64_tr_b16 a[94:95], v203 offset:2048
  v_mfma_f32_16x16x32_bf16 v[88:91], a[24:27], v[4:7], v[88:91]
  ds_read_b64_tr_b16 a[96:97], v200 offset:16384
  v_mfma_f32_16x16x32_bf16 v[92:95], a[28:31], v[4:7], v[92:95]
  s_waitcnt vmcnt(18)
  ds_read_b64_tr_b16 a[98:99], v200 offset:18432
  ds_read_b64_tr_b16 a[100:101], v201 offset:16384
  v_mfma_f32_16x16x32_bf16 v[80:83], a[32:35], v[8:11], v[80:83]
  buffer_load_dwordx4 v[4:7], v209, s[16:19], s47 offen offset:1024 sc1
  ds_read_b64_tr_b16 a[102:103], v201 offset:18432
  ds_read_b64_tr_b16 a[104:105], v202 offset:16384
  v_mfma_f32_16x16x32_bf16 v[84:87], a[36:39], v[8:11], v[84:87]
  ds_read_b64_tr_b16 a[106:107], v202 offset:18432
  ds_read_b64_tr_b16 a[108:109], v203 offset:16384
  v_mfma_f32_16x16x32_bf16 v[88:91], a[40:43], v[8:11], v[88:91]
  ds_read_b64_tr_b16 a[110:111], v203 offset:18432
  v_mfma_f32_16x16x32_bf16 v[92:95], a[44:47], v[8:11], v[92:95]
  s_waitcnt vmcnt(16)
  ds_read_b64_tr_b16 a[112:113], v217 offset:16384
  v_mfma_f32_16x16x32_bf16 v[80:83], a[48:51], v[12:15], v[80:83]
  buffer_load_dwordx4 v[8:11], v209, s[16:19], s47 offen offset:2048 sc1
  ds_read_b64_tr_b16 a[114:115], v217 offset:18432
  ds_read_b64_tr_b16 a[116:117], v218 offset:16384
  v_mfma_f32_16x16x32_bf16 v[84:87], a[52:55], v[12:15], v[84:87]
  ds_read_b64_tr_b16 a[118:119], v218 offset:18432
  ds_read_b64_tr_b16 a[120:121], v219 offset:16384
  v_mfma_f32_16x16x32_bf16 v[88:91], a[56:59], v[12:15], v[88:91]
  ds_read_b64_tr_b16 a[122:123], v219 offset:18432
  ds_read_b64_tr_b16 a[124:125], v220 offset:16384
  v_mfma_f32_16x16x32_bf16 v[92:95], a[60:63], v[12:15], v[92:95]
  s_waitcnt vmcnt(16)
  ds_read_b64_tr_b16 a[126:127], v220 offset:18432
  v_mfma_f32_16x16x32_bf16 v[80:83], a[64:67], v[16:19], v[80:83]
  buffer_load_dwordx4 v[12:15], v209, s[16:19], s47 offen offset:3072 sc1
  ds_read_b64_tr_b16 v[224:225], v217 offset:32768
  v_mfma_f32_16x16x32_bf16 v[84:87], a[68:71], v[16:19], v[84:87]
  ds_read_b64_tr_b16 v[226:227], v217 offset:34816
  ds_read_b64_tr_b16 v[228:229], v218 offset:32768
  v_mfma_f32_16x16x32_bf16 v[88:91], a[72:75], v[16:19], v[88:91]
  ds_read_b64_tr_b16 v[230:231], v218 offset:34816
  ds_read_b64_tr_b16 v[232:233], v219 offset:32768
  v_mfma_f32_16x16x32_bf16 v[92:95], a[76:79], v[16:19], v[92:95]
  s_waitcnt lgkmcnt(15)
  s_waitcnt vmcnt(16)
  s_add_u32 s47, s57, 8192
  ds_read_b64_tr_b16 v[234:235], v219 offset:34816
  ds_read_b64_tr_b16 v[236:237], v220 offset:32768
  v_mfma_f32_16x16x32_bf16 v[80:83], a[80:83], v[20:23], v[80:83]
  buffer_load_dwordx4 v[16:19], v209, s[16:19], s47 offen offset:0 sc1
  ds_read_b64_tr_b16 v[238:239], v220 offset:34816
  v_and_b32 v160, 15, v208
  v_mfma_f32_16x16x32_bf16 v[84:87], a[84:87], v[20:23], v[84:87]
  s_waitcnt vmcnt(7)
  v_cmp_gt_u32 vcc, v207, v215
  s_and_b32 s54, s54, vcc_lo
  s_and_b32 s73, s54, 12
  s_cbranch_scc1 L_ckf1
L_ckf1_ret:
  v_readlane_b32 s56, v216, 2
  v_lshrrev_b32 v161, 4, v208
  v_mfma_f32_16x16x32_bf16 v[88:91], a[88:91], v[20:23], v[88:91]
  s_mul_i32 s56, s56, 73728
  s_add_u32 s56, s56, s55
  v_and_b32 v162, 7, v208
  v_mfma_f32_16x16x32_bf16 v[92:95], a[92:95], v[20:23], v[92:95]
  s_waitcnt lgkmcnt(15)
  s_lshl_b32 s3, s44, 10
  buffer_atomic_add v211, v210, s[60:63], s3 offen sc1
  s_add_u32 s47, s56, 0
  v_xor_b32 v161, v162, v161
  v_mfma_f32_16x16x32_bf16 v[80:83], a[96:99], v[24:27], v[80:83]
  buffer_load_dwordx4 v[20:23], v209, s[16:19], s47 offen offset:0 sc1
  v_lshlrev_b32 v161, 4, v161
  v_mfma_f32_16x16x32_bf16 v[84:87], a[100:103], v[24:27], v[84:87]
  v_lshl_add_u32 v161, v160, 8, v161
  v_mfma_f32_16x16x32_bf16 v[88:91], a[104:107], v[24:27], v[88:91]
  v_add_u32 v152, s84, v161
  v_mfma_f32_16x16x32_bf16 v[92:95], a[108:111], v[24:27], v[92:95]
  s_waitcnt lgkmcnt(8)
  v_xor_b32 v153, 64, v152
  v_mfma_f32_16x16x32_bf16 v[80:83], a[112:115], v[28:31], v[80:83]
  buffer_load_dwordx4 v[24:27], v209, s[16:19], s47 offen offset:1024 sc1
  v_xor_b32 v154, 128, v152
  v_mfma_f32_16x16x32_bf16 v[84:87], a[116:119], v[28:31], v[84:87]
  v_xor_b32 v155, 192, v152
  v_mfma_f32_16x16x32_bf16 v[88:91], a[120:123], v[28:31], v[88:91]
  v_lshrrev_b32 v161, 3, v208
  v_mfma_f32_16x16x32_bf16 v[92:95], a[124:127], v[28:31], v[92:95]
  s_waitcnt lgkmcnt(0)
  v_lshlrev_b32 v156, 1, v162
  v_mfma_f32_16x16x32_bf16 v[80:83], v[224:227], v[32:35], v[80:83]
  buffer_load_dwordx4 v[28:31], v209, s[16:19], s47 offen offset:2048 sc1
  v_xor_b32 v156, v156, v161
  v_mfma_f32_16x16x32_bf16 v[84:87], v[228:231], v[32:35], v[84:87]
  v_lshlrev_b32 v156, 4, v156
  v_mfma_f32_16x16x32_bf16 v[88:91], v[232:235], v[32:35], v[88:91]
  v_lshl_add_u32 v156, v161, 8, v156
  v_mfma_f32_16x16x32_bf16 v[92:95], v[236:239], v[32:35], v[92:95]
  v_lshlrev_b32 v158, 4, v162
  v_mfma_f32_16x16x32_bf16 v[96:99], a[0:3], v[36:39], 0
  buffer_load_dwordx4 v[32:35], v209, s[16:19], s47 offen offset:3072 sc1
  v_lshl_add_u32 v158, v161, 10, v158
  v_mfma_f32_16x16x32_bf16 v[100:103], a[4:7], v[36:39], 0
  v_add_u32 v158, s71, v158
  v_mfma_f32_16x16x32_bf16 v[104:107], a[8:11], v[36:39], 0
  v_mfma_f32_16x16x32_bf16 v[108:111], a[12:15], v[36:39], 0
  s_add_u32 s47, s56, 4096
  v_mfma_f32_16x16x32_bf16 v[96:99], a[16:19], v[40:43], v[96:99]
  buffer_load_dwordx4 v[36:39], v209, s[16:19], s47 offen offset:0 sc1
  v_mfma_f32_16x16x32_bf16 v[100:103], a[20:23], v[40:43], v[100:103]
  ds_write_b128 v152, v[80:83] offset:16384
  v_mfma_f32_16x16x32_bf16 v[104:107], a[24:27], v[40:43], v[104:107]
  ds_write_b128 v153, v[84:87] offset:16384
  v_mfma_f32_16x16x32_bf16 v[108:111], a[28:31], v[40:43], v[108:111]
  ds_write_b128 v154, v[88:91] offset:16384
  v_mfma_f32_16x16x32_bf16 v[96:99], a[32:35], v[44:47], v[96:99]
  buffer_load_dwordx4 v[40:43], v209, s[16:19], s47 offen offset:1024 sc1
  ds_write_b128 v155, v[92:95] offset:16384
  v_mfma_f32_16x16x32_bf16 v[100:103], a[36:39], v[44:47], v[100:103]
  v_mfma_f32_16x16x32_bf16 v[104:107], a[40:43], v[44:47], v[104:107]
  s_lshl_b32 s3, s45, 10
  buffer_atomic_add v211, v210, s[60:63], s3 offen sc1
  v_mfma_f32_16x16x32_bf16 v[108:111], a[44:47], v[44:47], v[108:111]
  v_mfma_f32_16x16x32_bf16 v[96:99], a[48:51], v[48:51], v[96:99]
  buffer_load_dwordx4 v[44:47], v209, s[16:19], s47 offen offset:2048 sc1
  v_mfma_f32_16x16x32_bf16 v[100:103], a[52:55], v[48:51], v[100:103]
  v_mfma_f32_16x16x32_bf16 v[104:107], a[56:59], v[48:51], v[104:107]
  v_mfma_f32_16x16x32_bf16 v[108:111], a[60:63], v[48:51], v[108:111]
  s_waitcnt vmcnt(13)
  v_mfma_f32_16x16x32_bf16 v[96:99], a[64:67], v[0:3], v[96:99]
  buffer_load_dwordx4 v[48:51], v209, s[16:19], s47 offen offset:3072 sc1
  v_mfma_f32_16x16x32_bf16 v[100:103], a[68:71], v[0:3], v[100:103]
  v_mfma_f32_16x16x32_bf16 v[104:107], a[72:75], v[0:3], v[104:107]
  v_mfma_f32_16x16x32_bf16 v[108:111], a[76:79], v[0:3], v[108:111]
  s_waitcnt vmcnt(13)
  s_add_u32 s47, s56, 8192
  v_mfma_f32_16x16x32_bf16 v[96:99], a[80:83], v[4:7], v[96:99]
  buffer_load_dwordx4 v[0:3], v209, s[16:19], s47 offen offset:0 sc1
  v_mfma_f32_16x16x32_bf16 v[100:103], a[84:87], v[4:7], v[100:103]
  v_readlane_b32 s57, v216, 3
  s_and_b32 s74, s54, 48
  s_cselect_b32 s74, 0, 1073741824
  v_mov_b32 v172, 0
  s_mov_b64 exec, 48
  buffer_atomic_add v172, v214, s[60:63], s74 offen sc0 sc1
  s_mov_b64 exec, -1
  v_mfma_f32_16x16x32_bf16 v[104:107], a[88:91], v[4:7], v[104:107]
  s_lshl_b32 s3, s46, 10
  buffer_atomic_add v211, v210, s[60:63], s3 offen sc1
  s_mul_i32 s57, s57, 73728
  s_add_u32 s57, s57, s55
  v_mfma_f32_16x16x32_bf16 v[108:111], a[92:95], v[4:7], v[108:111]
  s_waitcnt vmcnt(15)
  s_add_u32 s47, s57, 0
  v_mfma_f32_16x16x32_bf16 v[96:99], a[96:99], v[8:11], v[96:99]
  buffer_load_dwordx4 v[4:7], v209, s[16:19], s47 offen offset:0 sc1
  v_mfma_f32_16x16x32_bf16 v[100:103], a[100:103], v[8:11], v[100:103]
  v_mfma_f32_16x16x32_bf16 v[104:107], a[104:107], v[8:11], v[104:107]
  v_mfma_f32_16x16x32_bf16 v[108:111], a[108:111], v[8:11], v[108:111]
  s_waitcnt vmcnt(15)
  v_mfma_f32_16x16x32_bf16 v[96:99], a[112:115], v[12:15], v[96:99]
  buffer_load_dwordx4 v[8:11], v209, s[16:19], s47 offen offset:1024 sc1
  v_mfma_f32_16x16x32_bf16 v[100:103], a[116:119], v[12:15], v[100:103]
  v_mfma_f32_16x16x32_bf16 v[104:107], a[120:123], v[12:15], v[104:107]
  v_mfma_f32_16x16x32_bf16 v[108:111], a[124:127], v[12:15], v[108:111]
  s_waitcnt vmcnt(15)
  v_mfma_f32_16x16x32_bf16 v[96:99], v[224:227], v[16:19], v[96:99]
  buffer_load_dwordx4 v[12:15], v209, s[16:19], s47 offen offset:2048 sc1
  v_mfma_f32_16x16x32_bf16 v[100:103], v[228:231], v[16:19], v[100:103]
  v_mfma_f32_16x16x32_bf16 v[104:107], v[232:235], v[16:19], v[104:107]
  v_mfma_f32_16x16x32_bf16 v[108:111], v[236:239], v[16:19], v[108:111]
  s_waitcnt vmcnt(14)
  v_mfma_f32_16x16x32_bf16 v[80:83], a[0:3], v[20:23], 0
  buffer_load_dwordx4 v[16:19], v209, s[16:19], s47 offen offset:3072 sc1
  v_mfma_f32_16x16x32_bf16 v[84:87], a[4:7], v[20:23], 0
  v_mfma_f32_16x16x32_bf16 v[88:91], a[8:11], v[20:23], 0
  v_mfma_f32_16x16x32_bf16 v[92:95], a[12:15], v[20:23], 0
  s_waitcnt vmcnt(14)
  s_add_u32 s47, s57, 4096
  v_mfma_f32_16x16x32_bf16 v[80:83], a[16:19], v[24:27], v[80:83]
  buffer_load_dwordx4 v[20:23], v209, s[16:19], s47 offen offset:0 sc1
  v_mfma_f32_16x16x32_bf16 v[84:87], a[20:23], v[24:27], v[84:87]
  ds_write_b128 v152, v[96:99] offset:32768
  v_mfma_f32_16x16x32_bf16 v[88:91], a[24:27], v[24:27], v[88:91]
  ds_write_b128 v153, v[100:103] offset:32768
  v_mfma_f32_16x16x32_bf16 v[92:95], a[28:31], v[24:27], v[92:95]
  s_waitcnt vmcnt(14)
  ds_write_b128 v154, v[104:107] offset:32768
  v_mfma_f32_16x16x32_bf16 v[80:83], a[32:35], v[28:31], v[80:83]
  buffer_load_dwordx4 v[24:27], v209, s[16:19], s47 offen offset:1024 sc1
  ds_write_b128 v155, v[108:111] offset:32768
  v_mfma_f32_16x16x32_bf16 v[84:87], a[36:39], v[28:31], v[84:87]
  v_mfma_f32_16x16x32_bf16 v[88:91], a[40:43], v[28:31], v[88:91]
  v_mfma_f32_16x16x32_bf16 v[92:95], a[44:47], v[28:31], v[92:95]
  s_waitcnt vmcnt(14)
  v_mfma_f32_16x16x32_bf16 v[80:83], a[48:51], v[32:35], v[80:83]
  buffer_load_dwordx4 v[28:31], v209, s[16:19], s47 offen offset:2048 sc1
  v_mfma_f32_16x16x32_bf16 v[84:87], a[52:55], v[32:35], v[84:87]
  v_mfma_f32_16x16x32_bf16 v[88:91], a[56:59], v[32:35], v[88:91]
  v_mfma_f32_16x16x32_bf16 v[92:95], a[60:63], v[32:35], v[92:95]
  s_waitcnt vmcnt(14)
  v_mfma_f32_16x16x32_bf16 v[80:83], a[64:67], v[36:39], v[80:83]
  v_mfma_f32_16x16x32_bf16 v[84:87], a[68:71], v[36:39], v[84:87]
  v_mfma_f32_16x16x32_bf16 v[88:91], a[72:75], v[36:39], v[88:91]
  v_mfma_f32_16x16x32_bf16 v[92:95], a[76:79], v[36:39], v[92:95]
  s_waitcnt vmcnt(13)
  v_mfma_f32_16x16x32_bf16 v[80:83], a[80:83], v[40:43], v[80:83]
  buffer_load_dwordx4 v[32:35], v209, s[16:19], s47 offen offset:3072 sc1
  v_mfma_f32_16x16x32_bf16 v[84:87], a[84:87], v[40:43], v[84:87]
  v_mfma_f32_16x16x32_bf16 v[88:91], a[88:91], v[40:43], v[88:91]
  v_mfma_f32_16x16x32_bf16 v[92:95], a[92:95], v[40:43], v[92:95]
  s_waitcnt vmcnt(12)
  s_add_u32 s47, s57, 8192
  v_mfma_f32_16x16x32_bf16 v[80:83], a[96:99], v[44:47], v[80:83]
  buffer_load_dwordx4 v[36:39], v209, s[16:19], s47 offen offset:0 sc1
  v_mfma_f32_16x16x32_bf16 v[84:87], a[100:103], v[44:47], v[84:87]
  s_waitcnt vmcnt(10)
  v_cmp_gt_u32 vcc, v207, v172
  s_and_b32 s54, s54, vcc_lo
  s_and_b32 s73, s54, 48
  s_cbranch_scc1 L_ckf2
L_ckf2_ret:
  v_readlane_b32 s56, v216, 4
  v_mfma_f32_16x16x32_bf16 v[88:91], a[104:107], v[44:47], v[88:91]
  s_mul_i32 s56, s56, 73728
  s_add_u32 s56, s56, s55
  v_mfma_f32_16x16x32_bf16 v[92:95], a[108:111], v[44:47], v[92:95]
  s_add_u32 s47, s56, 0
  v_mfma_f32_16x16x32_bf16 v[80:83], a[112:115], v[48:51], v[80:83]
  buffer_load_dwordx4 v[40:43], v209, s[16:19], s47 offen offset:0 sc1
  s_mov_b32 s75, 16384
  v_mfma_f32_16x16x32_bf16 v[84:87], a[116:119], v[48:51], v[84:87]
  v_mfma_f32_16x16x32_bf16 v[88:91], a[120:123], v[48:51], v[88:91]
  s_cmp_eq_u32 s68, 1
  s_cselect_b32 s75, 32768, s75
  v_mfma_f32_16x16x32_bf16 v[92:95], a[124:127], v[48:51], v[92:95]
  v_mfma_f32_16x16x32_bf16 v[80:83], v[224:227], v[0:3], v[80:83]
  buffer_load_dwordx4 v[44:47], v209, s[16:19], s47 offen offset:1024 sc1
  s_cmp_eq_u32 s68, 2
  s_cselect_b32 s75, 131072, s75
  v_mfma_f32_16x16x32_bf16 v[84:87], v[228:231], v[0:3], v[84:87]
  v_mfma_f32_16x16x32_bf16 v[88:91], v[232:235], v[0:3], v[88:91]
  s_cmp_eq_u32 s68, 3
  s_cselect_b32 s75, 147456, s75
  v_mfma_f32_16x16x32_bf16 v[92:95], v[236:239], v[0:3], v[92:95]
  s_waitcnt vmcnt(10)
  v_mfma_f32_16x16x32_bf16 v[96:99], a[0:3], v[4:7], 0
  buffer_load_dwordx4 v[48:51], v209, s[16:19], s47 offen offset:2048 sc1
  v_add_u32 v160, s75, v156
  v_mfma_f32_16x16x32_bf16 v[100:103], a[4:7], v[4:7], 0
  v_mfma_f32_16x16x32_bf16 v[104:107], a[8:11], v[4:7], 0
  v_xor_b32 v161, 16, v160
  v_mfma_f32_16x16x32_bf16 v[108:111], a[12:15], v[4:7], 0
  s_waitcnt vmcnt(10)
  v_mfma_f32_16x16x32_bf16 v[96:99], a[16:19], v[8:11], v[96:99]
  buffer_load_dwordx4 v[0:3], v209, s[16:19], s47 offen offset:3072 sc1
  v_mfma_f32_16x16x32_bf16 v[100:103], a[20:23], v[8:11], v[100:103]
  v_add_u32 v152, 131072, v152
  v_mfma_f32_16x16x32_bf16 v[104:107], a[24:27], v[8:11], v[104:107]
  ds_write_b128 v152, v[80:83] offset:0
  v_mfma_f32_16x16x32_bf16 v[108:111], a[28:31], v[8:11], v[108:111]
  s_waitcnt vmcnt(10)
  s_add_u32 s47, s56, 4096
  v_add_u32 v153, 131072, v153
  v_mfma_f32_16x16x32_bf16 v[96:99], a[32:35], v[12:15], v[96:99]
  buffer_load_dwordx4 v[4:7], v209, s[16:19], s47 offen offset:0 sc1
  ds_write_b128 v153, v[84:87] offset:0
  v_mfma_f32_16x16x32_bf16 v[100:103], a[36:39], v[12:15], v[100:103]
  v_add_u32 v154, 131072, v154
  v_mfma_f32_16x16x32_bf16 v[104:107], a[40:43], v[12:15], v[104:107]
  ds_write_b128 v154, v[88:91] offset:0
  v_mfma_f32_16x16x32_bf16 v[108:111], a[44:47], v[12:15], v[108:111]
  s_waitcnt vmcnt(10)
  v_add_u32 v155, 131072, v155
  v_mfma_f32_16x16x32_bf16 v[96:99], a[48:51], v[16:19], v[96:99]
  buffer_load_dwordx4 v[8:11], v209, s[16:19], s47 offen offset:1024 sc1
  ds_write_b128 v155, v[92:95] offset:0
  v_mfma_f32_16x16x32_bf16 v[100:103], a[52:55], v[16:19], v[100:103]
  v_mfma_f32_16x16x32_bf16 v[104:107], a[56:59], v[16:19], v[104:107]
  v_mfma_f32_16x16x32_bf16 v[108:111], a[60:63], v[16:19], v[108:111]
  s_waitcnt vmcnt(10)
  v_mfma_f32_16x16x32_bf16 v[96:99], a[64:67], v[20:23], v[96:99]
  buffer_load_dwordx4 v[12:15], v209, s[16:19], s47 offen offset:2048 sc1
  v_mfma_f32_16x16x32_bf16 v[100:103], a[68:71], v[20:23], v[100:103]
  v_mfma_f32_16x16x32_bf16 v[104:107], a[72:75], v[20:23], v[104:107]
  v_mfma_f32_16x16x32_bf16 v[108:111], a[76:79], v[20:23], v[108:111]
  s_waitcnt vmcnt(10)
  v_mfma_f32_16x16x32_bf16 v[96:99], a[80:83], v[24:27], v[96:99]
  buffer_load_dwordx4 v[16:19], v209, s[16:19], s47 offen offset:3072 sc1
  v_mfma_f32_16x16x32_bf16 v[100:103], a[84:87], v[24:27], v[100:103]
  v_mfma_f32_16x16x32_bf16 v[104:107], a[88:91], v[24:27], v[104:107]
  v_mfma_f32_16x16x32_bf16 v[108:111], a[92:95], v[24:27], v[108:111]
  s_waitcnt vmcnt(10)
  s_add_u32 s47, s56, 8192
  v_mfma_f32_16x16x32_bf16 v[96:99], a[96:99], v[28:31], v[96:99]
  buffer_load_dwordx4 v[20:23], v209, s[16:19], s47 offen offset:0 sc1
  v_mfma_f32_16x16x32_bf16 v[100:103], a[100:103], v[28:31], v[100:103]
  v_readlane_b32 s57, v216, 5
  s_and_b32 s74, s54, 192
  s_cselect_b32 s74, 0, 1073741824
  v_mov_b32 v173, 0
  s_mov_b64 exec, 192
  buffer_atomic_add v173, v214, s[60:63], s74 offen sc0 sc1
  s_mov_b64 exec, -1
  v_mfma_f32_16x16x32_bf16 v[104:107], a[104:107], v[28:31], v[104:107]
  s_mul_i32 s57, s57, 73728
  s_add_u32 s57, s57, s55
  v_mfma_f32_16x16x32_bf16 v[108:111], a[108:111], v[28:31], v[108:111]
  s_waitcnt vmcnt(11)
  s_add_u32 s47, s57, 0
  v_mfma_f32_16x16x32_bf16 v[96:99], a[112:115], v[32:35], v[96:99]
  buffer_load_dwordx4 v[24:27], v209, s[16:19], s47 offen offset:0 sc1
  v_mfma_f32_16x16x32_bf16 v[100:103], a[116:119], v[32:35], v[100:103]
  v_mfma_f32_16x16x32_bf16 v[104:107], a[120:123], v[32:35], v[104:107]
  v_mfma_f32_16x16x32_bf16 v[108:111], a[124:127], v[32:35], v[108:111]
  s_waitcnt vmcnt(11)
  v_mfma_f32_16x16x32_bf16 v[96:99], v[224:227], v[36:39], v[96:99]
  buffer_load_dwordx4 v[28:31], v209, s[16:19], s47 offen offset:1024 sc1
  v_mfma_f32_16x16x32_bf16 v[100:103], v[228:231], v[36:39], v[100:103]
  v_mfma_f32_16x16x32_bf16 v[104:107], v[232:235], v[36:39], v[104:107]
  v_mfma_f32_16x16x32_bf16 v[108:111], v[236:239], v[36:39], v[108:111]
  s_waitcnt vmcnt(11)
  v_mfma_f32_16x16x32_bf16 v[80:83], a[0:3], v[40:43], 0
  buffer_load_dwordx4 v[32:35], v209, s[16:19], s47 offen offset:2048 sc1
  v_mfma_f32_16x16x32_bf16 v[84:87], a[4:7], v[40:43], 0
  v_mfma_f32_16x16x32_bf16 v[88:91], a[8:11], v[40:43], 0
  v_mfma_f32_16x16x32_bf16 v[92:95], a[12:15], v[40:43], 0
  s_waitcnt vmcnt(11)
  v_mfma_f32_16x16x32_bf16 v[80:83], a[16:19], v[44:47], v[80:83]
  buffer_load_dwordx4 v[36:39], v209, s[16:19], s47 offen offset:3072 sc1
  v_mfma_f32_16x16x32_bf16 v[84:87], a[20:23], v[44:47], v[84:87]
  ds_write_b128 v152, v[96:99] offset:16384
  v_mfma_f32_16x16x32_bf16 v[88:91], a[24:27], v[44:47], v[88:91]
  ds_write_b128 v153, v[100:103] offset:16384
  v_mfma_f32_16x16x32_bf16 v[92:95], a[28:31], v[44:47], v[92:95]
  s_waitcnt vmcnt(11)
  s_add_u32 s47, s57, 4096
  ds_write_b128 v154, v[104:107] offset:16384
  v_mfma_f32_16x16x32_bf16 v[80:83], a[32:35], v[48:51], v[80:83]
  buffer_load_dwordx4 v[40:43], v209, s[16:19], s47 offen offset:0 sc1
  ds_write_b128 v155, v[108:111] offset:16384
  v_mfma_f32_16x16x32_bf16 v[84:87], a[36:39], v[48:51], v[84:87]
  v_mfma_f32_16x16x32_bf16 v[88:91], a[40:43], v[48:51], v[88:91]
  v_mfma_f32_16x16x32_bf16 v[92:95], a[44:47], v[48:51], v[92:95]
  s_waitcnt vmcnt(11)
  v_mfma_f32_16x16x32_bf16 v[80:83], a[48:51], v[0:3], v[80:83]
  buffer_load_dwordx4 v[44:47], v209, s[16:19], s47 offen offset:1024 sc1
  v_mfma_f32_16x16x32_bf16 v[84:87], a[52:55], v[0:3], v[84:87]
  s_waitcnt lgkmcnt(0)
  s_barrier
  v_mfma_f32_16x16x32_bf16 v[88:91], a[56:59], v[0:3], v[88:91]
  ds_read_b128 v[176:179], v160 offset:0
  v_mfma_f32_16x16x32_bf16 v[92:95], a[60:63], v[0:3], v[92:95]
  s_waitcnt vmcnt(11)
  ds_read_b128 v[180:183], v161 offset:0
  v_mfma_f32_16x16x32_bf16 v[80:83], a[64:67], v[4:7], v[80:83]
  buffer_load_dwordx4 v[48:51], v209, s[16:19], s47 offen offset:2048 sc1
  ds_read_b128 v[184:187], v160 offset:4096
  v_mfma_f32_16x16x32_bf16 v[84:87], a[68:71], v[4:7], v[84:87]
  ds_read_b128 v[188:191], v161 offset:4096
  v_mfma_f32_16x16x32_bf16 v[88:91], a[72:75], v[4:7], v[88:91]
  ds_read_b128 v[240:243], v160 offset:8192
  v_mfma_f32_16x16x32_bf16 v[92:95], a[76:79], v[4:7], v[92:95]
  s_waitcnt vmcnt(11)
  ds_read_b128 v[244:247], v161 offset:8192
  v_mfma_f32_16x16x32_bf16 v[80:83], a[80:83], v[8:11], v[80:83]
  buffer_load_dwordx4 v[0:3], v209, s[16:19], s47 offen offset:3072 sc1
  ds_read_b128 v[248:251], v160 offset:12288
  v_mfma_f32_16x16x32_bf16 v[84:87], a[84:87], v[8:11], v[84:87]
  ds_read_b128 v[252:255], v161 offset:12288
  v_mfma_f32_16x16x32_bf16 v[88:91], a[88:91], v[8:11], v[88:91]
  v_mfma_f32_16x16x32_bf16 v[92:95], a[92:95], v[8:11], v[92:95]
  s_waitcnt vmcnt(11)
  s_add_u32 s47, s57, 8192
  v_mfma_f32_16x16x32_bf16 v[80:83], a[96:99], v[12:15], v[80:83]
  buffer_load_dwordx4 v[4:7], v209, s[16:19], s47 offen offset:0 sc1
  v_mfma_f32_16x16x32_bf16 v[84:87], a[100:103], v[12:15], v[84:87]
  v_mfma_f32_16x16x32_bf16 v[88:91], a[104:107], v[12:15], v[88:91]
  s_waitcnt lgkmcnt(0)
  v_add_f32 v176, v176, v184
  v_mfma_f32_16x16x32_bf16 v[92:95], a[108:111], v[12:15], v[92:95]
  s_waitcnt vmcnt(11)
  v_add_f32 v177, v177, v185
  v_mfma_f32_16x16x32_bf16 v[80:83], a[112:115], v[16:19], v[80:83]
  v_add_f32 v178, v178, v186
  v_mfma_f32_16x16x32_bf16 v[84:87], a[116:119], v[16:19], v[84:87]
  s_waitcnt vmcnt(9)
  v_cmp_gt_u32 vcc, v207, v173
  s_and_b32 s54, s54, vcc_lo
  s_and_b32 s73, s54, 192
  s_cbranch_scc1 L_ckf3
L_ckf3_ret:
  v_readlane_b32 s56, v216, 6
  v_add_f32 v179, v179, v187
  v_add_f32 v180, v180, v188
  v_mfma_f32_16x16x32_bf16 v[88:91], a[120:123], v[16:19], v[88:91]
  s_mul_i32 s56, s56, 73728
  s_add_u32 s56, s56, s55
  v_add_f32 v181, v181, v189
  v_mfma_f32_16x16x32_bf16 v[92:95], a[124:127], v[16:19], v[92:95]
  s_add_u32 s47, s56, 0
  v_add_f32 v182, v182, v190
  v_mfma_f32_16x16x32_bf16 v[80:83], v[224:227], v[20:23], v[80:83]
  buffer_load_dwordx4 v[8:11], v209, s[16:19], s47 offen offset:0 sc1
  v_add_f32 v183, v183, v191
  v_add_f32 v240, v240, v248
  v_mfma_f32_16x16x32_bf16 v[84:87], v[228:231], v[20:23], v[84:87]
  v_add_f32 v241, v241, v249
  v_mfma_f32_16x16x32_bf16 v[88:91], v[232:235], v[20:23], v[88:91]
  v_add_f32 v242, v242, v250
  v_mfma_f32_16x16x32_bf16 v[92:95], v[236:239], v[20:23], v[92:95]
  s_waitcnt vmcnt(9)
  v_add_f32 v243, v243, v251
  v_add_f32 v244, v244, v252
  v_mfma_f32_16x16x32_bf16 v[96:99], a[0:3], v[24:27], 0
  buffer_load_dwordx4 v[12:15], v209, s[16:19], s47 offen offset:1024 sc1
  v_add_f32 v245, v245, v253
  v_mfma_f32_16x16x32_bf16 v[100:103], a[4:7], v[24:27], 0
  v_add_f32 v246, v246, v254
  v_mfma_f32_16x16x32_bf16 v[104:107], a[8:11], v[24:27], 0
  v_add_f32 v247, v247, v255
  v_add_f32 v176, v176, v240
  v_mfma_f32_16x16x32_bf16 v[108:111], a[12:15], v[24:27], 0
  s_waitcnt vmcnt(9)
  v_add_f32 v177, v177, v241
  v_mfma_f32_16x16x32_bf16 v[96:99], a[16:19], v[28:31], v[96:99]
  buffer_load_dwordx4 v[16:19], v209, s[16:19], s47 offen offset:2048 sc1
  v_add_f32 v178, v178, v242
  v_mfma_f32_16x16x32_bf16 v[100:103], a[20:23], v[28:31], v[100:103]
  v_add_u32 v152, 4294836224, v152
  v_add_f32 v179, v179, v243
  v_add_f32 v180, v180, v244
  v_mfma_f32_16x16x32_bf16 v[104:107], a[24:27], v[28:31], v[104:107]
  ds_write_b128 v152, v[80:83] offset:0
  v_add_f32 v181, v181, v245
  v_mfma_f32_16x16x32_bf16 v[108:111], a[28:31], v[28:31], v[108:111]
  s_waitcnt vmcnt(9)
  v_add_u32 v153, 4294836224, v153
  v_add_f32 v182, v182, v246
  v_mfma_f32_16x16x32_bf16 v[96:99], a[32:35], v[32:35], v[96:99]
  buffer_load_dwordx4 v[20:23], v209, s[16:19], s47 offen offset:3072 sc1
  ds_write_b128 v153, v[84:87] offset:0
  v_add_f32 v183, v183, v247
  v_cvt_pk_bf16_f32 v164, v176, v177
  v_mfma_f32_16x16x32_bf16 v[100:103], a[36:39], v[32:35], v[100:103]
  v_add_u32 v154, 4294836224, v154
  v_cvt_pk_bf16_f32 v165, v178, v179
  v_mfma_f32_16x16x32_bf16 v[104:107], a[40:43], v[32:35], v[104:107]
  ds_write_b128 v154, v[88:91] offset:0
  v_cvt_pk_bf16_f32 v166, v180, v181
  v_mfma_f32_16x16x32_bf16 v[108:111], a[44:47], v[32:35], v[108:111]
  s_waitcnt vmcnt(9)
  s_add_u32 s47, s56, 4096
  v_add_u32 v155, 4294836224, v155
  v_cvt_pk_bf16_f32 v167, v182, v183
  v_min_u32 v164, -2, v164
  v_mfma_f32_16x16x32_bf16 v[96:99], a[48:51], v[36:39], v[96:99]
  buffer_load_dwordx4 v[24:27], v209, s[16:19], s47 offen offset:0 sc1
  ds_write_b128 v155, v[92:95] offset:0
  v_min_u32 v165, -2, v165
  v_mfma_f32_16x16x32_bf16 v[100:103], a[52:55], v[36:39], v[100:103]
  v_min_u32 v166, -2, v166
  v_mfma_f32_16x16x32_bf16 v[104:107], a[56:59], v[36:39], v[104:107]
  v_min_u32 v167, -2, v167
  buffer_store_dwordx4 v[164:167], v209, s[12:15], s50 offen offset:0 sc1
  v_mfma_f32_16x16x32_bf16 v[108:111], a[60:63], v[36:39], v[108:111]
  s_waitcnt vmcnt(10)
  v_mfma_f32_16x16x32_bf16 v[96:99], a[64:67], v[40:43], v[96:99]
  buffer_load_dwordx4 v[28:31], v209, s[16:19], s47 offen offset:1024 sc1
  v_mfma_f32_16x16x32_bf16 v[100:103], a[68:71], v[40:43], v[100:103]
  ds_read_b128 v[176:179], v160 offset:2048
  v_mfma_f32_16x16x32_bf16 v[104:107], a[72:75], v[40:43], v[104:107]
  ds_read_b128 v[180:183], v161 offset:2048
  v_mfma_f32_16x16x32_bf16 v[108:111], a[76:79], v[40:43], v[108:111]
  s_waitcnt vmcnt(10)
  ds_read_b128 v[184:187], v160 offset:6144
  v_mfma_f32_16x16x32_bf16 v[96:99], a[80:83], v[44:47], v[96:99]
  buffer_load_dwordx4 v[32:35], v209, s[16:19], s47 offen offset:2048 sc1
  ds_read_b128 v[188:191], v161 offset:6144
  v_mfma_f32_16x16x32_bf16 v[100:103], a[84:87], v[44:47], v[100:103]
  ds_read_b128 v[240:243], v160 offset:10240
  v_mfma_f32_16x16x32_bf16 v[104:107], a[88:91], v[44:47], v[104:107]
  ds_read_b128 v[244:247], v161 offset:10240
  v_mfma_f32_16x16x32_bf16 v[108:111], a[92:95], v[44:47], v[108:111]
  s_waitcnt vmcnt(10)
  ds_read_b128 v[248:251], v160 offset:14336
  v_mfma_f32_16x16x32_bf16 v[96:99], a[96:99], v[48:51], v[96:99]
  buffer_load_dwordx4 v[36:39], v209, s[16:19], s47 offen offset:3072 sc1
  ds_read_b128 v[252:255], v161 offset:14336
  v_mfma_f32_16x16x32_bf16 v[100:103], a[100:103], v[48:51], v[100:103]
  v_mfma_f32_16x16x32_bf16 v[104:107], a[104:107], v[48:51], v[104:107]
  v_mfma_f32_16x16x32_bf16 v[108:111], a[108:111], v[48:51], v[108:111]
  s_waitcnt vmcnt(10)
  s_add_u32 s47, s56, 8192
  v_mfma_f32_16x16x32_bf16 v[96:99], a[112:115], v[0:3], v[96:99]
  buffer_load_dwordx4 v[40:43], v209, s[16:19], s47 offen offset:0 sc1
  v_mfma_f32_16x16x32_bf16 v[100:103], a[116:119], v[0:3], v[100:103]
  v_readlane_b32 s57, v216, 7
  s_waitcnt lgkmcnt(0)
  v_add_f32 v176, v176, v184
  v_mfma_f32_16x16x32_bf16 v[104:107], a[120:123], v[0:3], v[104:107]
  s_mul_i32 s57, s57, 73728
  s_add_u32 s57, s57, s55
  v_add_f32 v177, v177, v185
  v_mfma_f32_16x16x32_bf16 v[108:111], a[124:127], v[0:3], v[108:111]
  s_waitcnt vmcnt(10)
  s_add_u32 s47, s57, 0
  v_add_f32 v178, v178, v186
  v_mfma_f32_16x16x32_bf16 v[96:99], v[224:227], v[4:7], v[96:99]
  buffer_load_dwordx4 v[44:47], v209, s[16:19], s47 offen offset:0 sc1
  v_add_f32 v179, v179, v187
  v_add_f32 v180, v180, v188
  v_mfma_f32_16x16x32_bf16 v[100:103], v[228:231], v[4:7], v[100:103]
  v_add_f32 v181, v181, v189
  v_mfma_f32_16x16x32_bf16 v[104:107], v[232:235], v[4:7], v[104:107]
  v_add_f32 v182, v182, v190
  v_mfma_f32_16x16x32_bf16 v[108:111], v[236:239], v[4:7], v[108:111]
  s_waitcnt vmcnt(10)
  v_add_f32 v183, v183, v191
  v_add_f32 v240, v240, v248
  v_mfma_f32_16x16x32_bf16 v[80:83], a[0:3], v[8:11], 0
  buffer_load_dwordx4 v[48:51], v209, s[16:19], s47 offen offset:1024 sc1
  v_add_f32 v241, v241, v249
  v_mfma_f32_16x16x32_bf16 v[84:87], a[4:7], v[8:11], 0
  v_add_f32 v242, v242, v250
  v_mfma_f32_16x16x32_bf16 v[88:91], a[8:11], v[8:11], 0
  v_add_f32 v243, v243, v251
  v_add_f32 v244, v244, v252
  v_mfma_f32_16x16x32_bf16 v[92:95], a[12:15], v[8:11], 0
  s_waitcnt vmcnt(10)
  v_add_f32 v245, v245, v253
  v_mfma_f32_16x16x32_bf16 v[80:83], a[16:19], v[12:15], v[80:83]
  buffer_load_dwordx4 v[0:3], v209, s[16:19], s47 offen offset:2048 sc1
  v_add_f32 v246, v246, v254
  v_mfma_f32_16x16x32_bf16 v[84:87], a[20:23], v[12:15], v[84:87]
  ds_write_b128 v152, v[96:99] offset:49152
  v_add_f32 v247, v247, v255
  v_add_f32 v176, v176, v240
  v_mfma_f32_16x16x32_bf16 v[88:91], a[24:27], v[12:15], v[88:91]
  ds_write_b128 v153, v[100:103] offset:49152
  v_add_f32 v177, v177, v241
  v_mfma_f32_16x16x32_bf16 v[92:95], a[28:31], v[12:15], v[92:95]
  s_waitcnt vmcnt(10)
  ds_write_b128 v154, v[104:107] offset:49152
  v_add_f32 v178, v178, v242
  v_mfma_f32_16x16x32_bf16 v[80:83], a[32:35], v[16:19], v[80:83]
  buffer_load_dwordx4 v[4:7], v209, s[16:19], s47 offen offset:3072 sc1
  ds_write_b128 v155, v[108:111] offset:49152
  v_add_f32 v179, v179, v243
  v_add_f32 v180, v180, v244
  v_mfma_f32_16x16x32_bf16 v[84:87], a[36:39], v[16:19], v[84:87]
  v_add_f32 v181, v181, v245
  v_mfma_f32_16x16x32_bf16 v[88:91], a[40:43], v[16:19], v[88:91]
  v_add_f32 v182, v182, v246
  v_mfma_f32_16x16x32_bf16 v[92:95], a[44:47], v[16:19], v[92:95]
  s_waitcnt vmcnt(10)
  s_add_u32 s47, s57, 4096
  v_add_f32 v183, v183, v247
  v_cvt_pk_bf16_f32 v168, v176, v177
  v_mfma_f32_16x16x32_bf16 v[80:83], a[48:51], v[20:23], v[80:83]
  buffer_load_dwordx4 v[8:11], v209, s[16:19], s47 offen offset:0 sc1
  v_cvt_pk_bf16_f32 v169, v178, v179
  v_mfma_f32_16x16x32_bf16 v[84:87], a[52:55], v[20:23], v[84:87]
  v_cvt_pk_bf16_f32 v170, v180, v181
  v_mfma_f32_16x16x32_bf16 v[88:91], a[56:59], v[20:23], v[88:91]
  v_cvt_pk_bf16_f32 v171, v182, v183
  v_min_u32 v168, -2, v168
  v_mfma_f32_16x16x32_bf16 v[92:95], a[60:63], v[20:23], v[92:95]
  s_waitcnt vmcnt(10)
  v_min_u32 v169, -2, v169
  v_mfma_f32_16x16x32_bf16 v[80:83], a[64:67], v[24:27], v[80:83]
  buffer_load_dwordx4 v[12:15], v209, s[16:19], s47 offen offset:1024 sc1
  v_min_u32 v170, -2, v170
  v_mfma_f32_16x16x32_bf16 v[84:87], a[68:71], v[24:27], v[84:87]
  v_min_u32 v171, -2, v171
  buffer_store_dwordx4 v[168:171], v209, s[12:15], s50 offen offset:1024 sc1
  v_mfma_f32_16x16x32_bf16 v[88:91], a[72:75], v[24:27], v[88:91]
  v_mfma_f32_16x16x32_bf16 v[92:95], a[76:79], v[24:27], v[92:95]
  s_waitcnt vmcnt(10)
  v_mfma_f32_16x16x32_bf16 v[80:83], a[80:83], v[28:31], v[80:83]
  buffer_load_dwordx4 v[16:19], v209, s[16:19], s47 offen offset:2048 sc1
  v_mfma_f32_16x16x32_bf16 v[84:87], a[84:87], v[28:31], v[84:87]
  v_mfma_f32_16x16x32_bf16 v[88:91], a[88:91], v[28:31], v[88:91]
  v_mfma_f32_16x16x32_bf16 v[92:95], a[92:95], v[28:31], v[92:95]
  s_waitcnt vmcnt(10)
  v_mfma_f32_16x16x32_bf16 v[80:83], a[96:99], v[32:35], v[80:83]
  buffer_load_dwordx4 v[20:23], v209, s[16:19], s47 offen offset:3072 sc1
  v_mfma_f32_16x16x32_bf16 v[84:87], a[100:103], v[32:35], v[84:87]
  v_mfma_f32_16x16x32_bf16 v[88:91], a[104:107], v[32:35], v[88:91]
  v_mfma_f32_16x16x32_bf16 v[92:95], a[108:111], v[32:35], v[92:95]
  s_waitcnt vmcnt(10)
  s_add_u32 s47, s57, 8192
  v_mfma_f32_16x16x32_bf16 v[80:83], a[112:115], v[36:39], v[80:83]
  buffer_load_dwordx4 v[24:27], v209, s[16:19], s47 offen offset:0 sc1
  v_mfma_f32_16x16x32_bf16 v[84:87], a[116:119], v[36:39], v[84:87]
  v_mfma_f32_16x16x32_bf16 v[88:91], a[120:123], v[36:39], v[88:91]
  v_mfma_f32_16x16x32_bf16 v[92:95], a[124:127], v[36:39], v[92:95]
  s_waitcnt vmcnt(10)
  v_mfma_f32_16x16x32_bf16 v[80:83], v[224:227], v[40:43], v[80:83]
  v_mfma_f32_16x16x32_bf16 v[84:87], v[228:231], v[40:43], v[84:87]
  v_mfma_f32_16x16x32_bf16 v[88:91], v[232:235], v[40:43], v[88:91]
  s_mov_b32 s75, 0
  v_mfma_f32_16x16x32_bf16 v[92:95], v[236:239], v[40:43], v[92:95]
  s_waitcnt vmcnt(9)
  v_mfma_f32_16x16x32_bf16 v[96:99], a[0:3], v[44:47], 0
  s_cmp_eq_u32 s68, 1
  s_cselect_b32 s75, 49152, s75
  v_mfma_f32_16x16x32_bf16 v[100:103], a[4:7], v[44:47], 0
  v_mfma_f32_16x16x32_bf16 v[104:107], a[8:11], v[44:47], 0
  s_cmp_eq_u32 s68, 2
  s_cselect_b32 s75, 81920, s75
  v_mfma_f32_16x16x32_bf16 v[108:111], a[12:15], v[44:47], 0
  s_waitcnt vmcnt(8)
  v_mfma_f32_16x16x32_bf16 v[96:99], a[16:19], v[48:51], v[96:99]
  s_cmp_eq_u32 s68, 3
  s_cselect_b32 s75, 98304, s75
  v_mfma_f32_16x16x32_bf16 v[100:103], a[20:23], v[48:51], v[100:103]
  v_add_u32 v152, 81920, v152
  v_mfma_f32_16x16x32_bf16 v[104:107], a[24:27], v[48:51], v[104:107]
  v_add_u32 v156, s75, v156
  ds_write_b128 v152, v[80:83] offset:0
  v_mfma_f32_16x16x32_bf16 v[108:111], a[28:31], v[48:51], v[108:111]
  s_waitcnt vmcnt(7)
  v_add_u32 v153, 81920, v153
  v_mfma_f32_16x16x32_bf16 v[96:99], a[32:35], v[0:3], v[96:99]
  v_xor_b32 v157, 16, v156
  ds_write_b128 v153, v[84:87] offset:0
  v_mfma_f32_16x16x32_bf16 v[100:103], a[36:39], v[0:3], v[100:103]
  v_add_u32 v154, 81920, v154
  v_mfma_f32_16x16x32_bf16 v[104:107], a[40:43], v[0:3], v[104:107]
  s_add_u32 s74, s68, 4
  ds_write_b128 v154, v[88:91] offset:0
  v_mfma_f32_16x16x32_bf16 v[108:111], a[44:47], v[0:3], v[108:111]
  s_waitcnt vmcnt(6)
  v_add_u32 v155, 81920, v155
  v_mfma_f32_16x16x32_bf16 v[96:99], a[48:51], v[4:7], v[96:99]
  v_readlane_b32 s82, v216, s74
  ds_write_b128 v155, v[92:95] offset:0
  v_mfma_f32_16x16x32_bf16 v[100:103], a[52:55], v[4:7], v[100:103]
  v_mfma_f32_16x16x32_bf16 v[104:107], a[56:59], v[4:7], v[104:107]
  s_lshl_b32 s82, s82, 14
  v_mfma_f32_16x16x32_bf16 v[108:111], a[60:63], v[4:7], v[108:111]
  s_waitcnt vmcnt(5)
  v_mfma_f32_16x16x32_bf16 v[96:99], a[64:67], v[8:11], v[96:99]
  s_add_u32 s83, s82, 8192
  v_mfma_f32_16x16x32_bf16 v[100:103], a[68:71], v[8:11], v[100:103]
  v_mfma_f32_16x16x32_bf16 v[104:107], a[72:75], v[8:11], v[104:107]
  buffer_load_dwordx4 v[164:167], v209, s[12:15], s49 offen offset:0 sc1
  v_mfma_f32_16x16x32_bf16 v[108:111], a[76:79], v[8:11], v[108:111]
  s_waitcnt vmcnt(5)
  buffer_load_dwordx4 v[168:171], v209, s[12:15], s49 offen offset:1024 sc1
  v_mfma_f32_16x16x32_bf16 v[96:99], a[80:83], v[12:15], v[96:99]
  v_mfma_f32_16x16x32_bf16 v[100:103], a[84:87], v[12:15], v[100:103]
  v_mfma_f32_16x16x32_bf16 v[104:107], a[88:91], v[12:15], v[104:107]
  v_mfma_f32_16x16x32_bf16 v[108:111], a[92:95], v[12:15], v[108:111]
  s_waitcnt vmcnt(4)
  v_mfma_f32_16x16x32_bf16 v[96:99], a[96:99], v[16:19], v[96:99]
  v_mfma_f32_16x16x32_bf16 v[100:103], a[100:103], v[16:19], v[100:103]
  v_mfma_f32_16x16x32_bf16 v[104:107], a[104:107], v[16:19], v[104:107]
  v_mfma_f32_16x16x32_bf16 v[108:111], a[108:111], v[16:19], v[108:111]
  s_waitcnt vmcnt(3)
  v_mfma_f32_16x16x32_bf16 v[96:99], a[112:115], v[20:23], v[96:99]
  v_mfma_f32_16x16x32_bf16 v[100:103], a[116:119], v[20:23], v[100:103]
  v_mfma_f32_16x16x32_bf16 v[104:107], a[120:123], v[20:23], v[104:107]
  v_mfma_f32_16x16x32_bf16 v[108:111], a[124:127], v[20:23], v[108:111]
  s_waitcnt vmcnt(2)
  v_mfma_f32_16x16x32_bf16 v[96:99], v[224:227], v[24:27], v[96:99]
  v_mfma_f32_16x16x32_bf16 v[100:103], v[228:231], v[24:27], v[100:103]
  v_mfma_f32_16x16x32_bf16 v[104:107], v[232:235], v[24:27], v[104:107]
  v_mfma_f32_16x16x32_bf16 v[108:111], v[236:239], v[24:27], v[108:111]
  s_nop 4
  ds_write_b128 v152, v[96:99] offset:16384
  ds_write_b128 v153, v[100:103] offset:16384
  ds_write_b128 v154, v[104:107] offset:16384
  ds_write_b128 v155, v[108:111] offset:16384
  s_waitcnt lgkmcnt(0)
  s_barrier
  ds_read_b128 v[0:3], v156 offset:0
  ds_read_b128 v[4:7], v157 offset:0
  ds_read_b128 v[8:11], v156 offset:4096
  ds_read_b128 v[12:15], v157 offset:4096
  ds_read_b128 v[16:19], v156 offset:8192
  ds_read_b128 v[20:23], v157 offset:8192
  ds_read_b128 v[24:27], v156 offset:12288
  ds_read_b128 v[28:31], v157 offset:12288
  ds_read_b128 v[32:35], v156 offset:2048
  ds_read_b128 v[36:39], v157 offset:2048
  ds_read_b128 v[40:43], v156 offset:6144
  ds_read_b128 v[44:47], v157 offset:6144
  ds_read_b128 v[48:51], v156 offset:10240
  ds_read_b128 v[52:55], v157 offset:10240
  ds_read_b128 v[56:59], v156 offset:14336
  ds_read_b128 v[60:63], v157 offset:14336
  s_waitcnt vmcnt(0)
  v_max3_u32 v160, v164, v165, v166
  v_max3_u32 v160, v167, v168, v160
  v_max3_u32 v160, v169, v170, v160
  v_max_u32 v160, v171, v160
  v_cmp_eq_u32 vcc, -1, v160
  s_cbranch_vccnz L_inf
L_inf_ret:
  v_lshlrev_b32 v176, 16, v164
  v_and_b32 v177, 0xffff0000, v164
  v_lshlrev_b32 v178, 16, v165
  v_and_b32 v179, 0xffff0000, v165
  v_lshlrev_b32 v180, 16, v166
  v_and_b32 v181, 0xffff0000, v166
  v_lshlrev_b32 v182, 16, v167
  v_and_b32 v183, 0xffff0000, v167
  v_lshlrev_b32 v184, 16, v168
  v_and_b32 v185, 0xffff0000, v168
  v_lshlrev_b32 v186, 16, v169
  v_and_b32 v187, 0xffff0000, v169
  v_lshlrev_b32 v188, 16, v170
  v_and_b32 v189, 0xffff0000, v170
  v_lshlrev_b32 v190, 16, v171
  v_and_b32 v191, 0xffff0000, v171
  s_waitcnt lgkmcnt(8)
  v_pk_add_f32 v[0:1], v[0:1], v[8:9]
  v_pk_add_f32 v[2:3], v[2:3], v[10:11]
  v_pk_add_f32 v[4:5], v[4:5], v[12:13]
  v_pk_add_f32 v[6:7], v[6:7], v[14:15]
  v_pk_add_f32 v[16:17], v[16:17], v[24:25]
  v_pk_add_f32 v[18:19], v[18:19], v[26:27]
  v_pk_add_f32 v[20:21], v[20:21], v[28:29]
  v_pk_add_f32 v[22:23], v[22:23], v[30:31]
  v_pk_add_f32 v[0:1], v[0:1], v[176:177]
  v_pk_add_f32 v[2:3], v[2:3], v[178:179]
  v_pk_add_f32 v[4:5], v[4:5], v[180:181]
  v_pk_add_f32 v[6:7], v[6:7], v[182:183]
  v_pk_add_f32 v[0:1], v[0:1], v[16:17]
  v_pk_add_f32 v[2:3], v[2:3], v[18:19]
  v_pk_add_f32 v[4:5], v[4:5], v[20:21]
  v_pk_add_f32 v[6:7], v[6:7], v[22:23]
  v_cvt_pk_bf16_f32 v8, v0, v1
  v_cvt_pk_bf16_f32 v9, v2, v3
  v_cvt_pk_bf16_f32 v10, v4, v5
  v_cvt_pk_bf16_f32 v11, v6, v7
  buffer_store_dwordx4 v[8:11], v158, s[28:31], s82 offen sc1
  s_waitcnt lgkmcnt(0)
  v_pk_add_f32 v[32:33], v[32:33], v[40:41]
  v_pk_add_f32 v[34:35], v[34:35], v[42:43]
  v_pk_add_f32 v[36:37], v[36:37], v[44:45]
  v_pk_add_f32 v[38:39], v[38:39], v[46:47]
  v_pk_add_f32 v[48:49], v[48:49], v[56:57]
  v_pk_add_f32 v[50:51], v[50:51], v[58:59]
  v_pk_add_f32 v[52:53], v[52:53], v[60:61]
  v_pk_add_f32 v[54:55], v[54:55], v[62:63]
  v_pk_add_f32 v[32:33], v[32:33], v[184:185]
  v_pk_add_f32 v[34:35], v[34:35], v[186:187]
  v_pk_add_f32 v[36:37], v[36:37], v[188:189]
  v_pk_add_f32 v[38:39], v[38:39], v[190:191]
  v_pk_add_f32 v[32:33], v[32:33], v[48:49]
  v_pk_add_f32 v[34:35], v[34:35], v[50:51]
  v_pk_add_f32 v[36:37], v[36:37], v[52:53]
  v_pk_add_f32 v[38:39], v[38:39], v[54:55]
  v_cvt_pk_bf16_f32 v40, v32, v33
  v_cvt_pk_bf16_f32 v41, v34, v35
  v_cvt_pk_bf16_f32 v42, v36, v37
  v_cvt_pk_bf16_f32 v43, v38, v39
  buffer_store_dwordx4 v[40:43], v158, s[28:31], s83 offen sc1
  s_endpgm
L_qkv:
  s_and_b32 s72, s69, 1
  s_mul_i32 s72, s72, 11
  s_add_u32 s72, s72, s70
  s_sub_u32 s72, s72, 21
  s_lshr_b32 s78, s72, 1
  s_and_b32 s72, s72, 1
  s_and_b32 s79, s69, 6
  s_add_u32 s79, s79, s72
  s_xor_b32 s72, s72, s78
  s_and_b32 s90, s72, 3
  s_and_b32 s95, s72, 1
  s_mul_i32 s76, s68, 3072
  s_and_b32 s74, s68, 1
  s_lshl_b32 s75, s74, 2
  v_lshrrev_b32 v248, 4, v208
  v_and_b32 v249, 1, v248
  v_lshl_or_b32 v249, v249, 1, s75
  v_and_b32 v250, 7, v208
  v_xor_b32 v250, v250, v249
  v_lshlrev_b32 v250, 4, v250
  v_lshrrev_b32 v251, 3, v208
  v_lshl_add_u32 v251, s68, 3, v251
  v_mul_u32_u24 v251, 3072, v251
  s_lshl_b32 s72, s79, 7
  v_add3_u32 v176, v251, v250, s72
  s_xor_b32 s80, s95, 0
  s_mul_i32 s80, s80, 98304
  s_add_u32 m0, s76, 0
  s_waitcnt lgkmcnt(0)
  buffer_load_dwordx4 v176, s[8:11], s80 offen offset:0 lds
  buffer_load_dwordx4 v176, s[8:11], s80 offen offset:1024 lds
  buffer_load_dwordx4 v176, s[8:11], s80 offen offset:2048 lds
  s_lshr_b32 s91, s90, 1
  s_lshl_b32 s91, s91, 7
  s_and_b32 s93, s90, 1
  s_lshl_b32 s93, s93, 6
  s_lshl_b32 s77, s68, 10
  v_or_b32 v249, s75, v248
  v_and_b32 v250, 7, v208
  v_xor_b32 v250, v250, v249
  v_lshlrev_b32 v250, 4, v250
  v_lshrrev_b32 v251, 3, v208
  s_mul_i32 s72, s78, 192
  s_lshl_b32 s73, s68, 3
  s_add_u32 s72, s72, s73
  s_sub_u32 s72, s72, 16
  v_add_u32 v251, s72, v251
  v_lshl_add_u32 v178, v251, 10, v250
  s_and_b32 s83, s90, 1
  s_mul_i32 s72, s83, 16384
  s_sub_u32 s94, s77, s72
  s_lshl_b32 s72, s72, 3
  v_subrev_u32 v182, s72, v178
  s_mul_i32 s72, s83, 12288
  s_add_u32 s77, s77, s72
  s_lshl_b32 s72, s72, 3
  v_add_u32 v178, s72, v178
  v_add_u32 v184, 196608, v182
  v_add_u32 v183, 163840, v182
  v_add_u32 v182, 131072, v182
  v_add_u32 v179, 32768, v178
  v_add_u32 v180, 65536, v178
  v_add_u32 v181, 98304, v178
  s_cmp_ge_u32 s68, 2
  s_cselect_b32 s72, 1073741824, 0
  s_cmp_lg_u32 s83, 0
  s_cselect_b32 s82, s72, 0
  s_cselect_b32 s72, 0, s72
  v_or_b32 v184, s72, v184
  v_or_b32 v181, s82, v181
  s_mov_b32 s92, 0
  s_add_u32 m0, s77, 61440
  s_nop 0
  buffer_load_dwordx4 v178, s[4:7], s92 offen lds
  s_add_u32 m0, s77, 65536
  s_nop 0
  buffer_load_dwordx4 v179, s[4:7], s92 offen lds
  s_add_u32 m0, s77, 69632
  s_nop 0
  buffer_load_dwordx4 v180, s[4:7], s92 offen lds
  s_add_u32 m0, s77, 73728
  s_nop 0
  buffer_load_dwordx4 v181, s[4:7], s92 offen lds
  s_add_u32 m0, s94, 77824
  s_nop 0
  buffer_load_dwordx4 v182, s[4:7], s92 offen lds
  s_add_u32 m0, s94, 81920
  s_nop 0
  buffer_load_dwordx4 v183, s[4:7], s92 offen lds
  s_add_u32 m0, s94, 86016
  s_nop 0
  buffer_load_dwordx4 v184, s[4:7], s92 offen lds
  s_mov_b32 s64, s54
  s_mov_b32 s65, s55
  s_mov_b32 s66, 192
  s_mov_b32 s67, 0x20000
  s_add_u32 s32, s56, 9437184
  s_addc_u32 s33, s57, 0
  s_mov_b32 s34, 147456
  s_mov_b32 s35, 0x20000
  s_sub_u32 s73, s2, 208
  s_lshl_b32 s74, s68, 8
  s_add_u32 s74, s74, s73
  s_mul_i32 s72, s73, 3072
  s_lshl_b32 s73, s73, 2
  s_cmp_lt_u32 s74, 48
  s_cselect_b32 s72, s72, 1073741824
  s_cselect_b32 s45, s73, 1073741824
  v_mov_b32 v252, 0
  v_mov_b32 v253, 0
  v_mov_b32 v254, 0
  v_mov_b32 v255, 0
  buffer_store_dwordx4 v[252:255], v209, s[32:35], s72 offen offset:0 sc1
  buffer_store_dwordx4 v[252:255], v209, s[32:35], s72 offen offset:1024 sc1
  buffer_store_dwordx4 v[252:255], v209, s[32:35], s72 offen offset:2048 sc1
  v_mov_b32 v244, 0
  global_load_dword v245, v244, s[48:49]
  global_load_dword v245, v244, s[40:41]
  s_and_b32 s74, s68, 1
  v_lshrrev_b32 v249, 2, v208
  v_and_b32 v249, 3, v249
  v_and_b32 v250, 1, v248
  v_lshlrev_b32 v250, 1, v250
  v_lshrrev_b32 v251, 1, v249
  v_or_b32 v250, v250, v251
  s_lshl_b32 s72, s74, 1
  v_xor_b32 v250, s72, v250
  v_lshlrev_b32 v250, 5, v250
  v_mul_u32_u24 v251, 3072, v248
  v_add_u32 v250, v250, v251
  v_lshl_add_u32 v250, v249, 7, v250
  v_and_b32 v251, 3, v208
  v_lshl_add_u32 v186, v251, 3, v250
  v_xor_b32 v187, 32, v186
  v_and_b32 v249, 15, v208
  v_lshrrev_b32 v250, 1, v249
  v_xor_b32 v250, v250, v248
  v_lshlrev_b32 v250, 4, v250
  v_lshl_add_u32 v250, v249, 7, v250
  s_lshr_b32 s72, s68, 1
  s_mul_i32 s73, s72, 12288
  v_add_u32 v250, s73, v250
  v_xor_b32 v250, s93, v250
  v_xor_b32 v251, 64, v250
  v_add_u32 v190, 61440, v250
  v_add_u32 v191, 61440, v251
  v_add_u32 v192, 90112, v250
  v_add_u32 v193, 90112, v251
  v_add_u32 v194, 118784, v250
  v_add_u32 v195, 118784, v251
  s_and_b32 s72, s69, 6
  s_cmp_lg_u32 s72, 2
  s_cbranch_scc1 L_h3qkv
  s_lshl_b32 s72, s70, 2
  s_add_u32 s72, s72, s68
  s_mul_i32 s72, s72, 12288
  v_min_u32 v243, 11, v208
  v_lshlrev_b32 v243, 10, v243
  v_add_u32 v243, s72, v243
  global_load_dword v242, v243, s[38:39] offset:384
L_h3qkv:
  s_xor_b32 s80, s95, 1
  s_mul_i32 s80, s80, 98304
  s_add_u32 m0, s76, 12288
  s_nop 0
  buffer_load_dwordx4 v176, s[8:11], s80 offen offset:0 lds
  buffer_load_dwordx4 v176, s[8:11], s80 offen offset:1024 lds
  buffer_load_dwordx4 v176, s[8:11], s80 offen offset:2048 lds
  s_xor_b32 s92, s91, 0
  s_add_u32 s92, s92, 128
  s_add_u32 m0, s77, 90112
  s_nop 0
  buffer_load_dwordx4 v178, s[4:7], s92 offen lds
  s_add_u32 m0, s77, 94208
  s_nop 0
  buffer_load_dwordx4 v179, s[4:7], s92 offen lds
  s_add_u32 m0, s77, 98304
  s_nop 0
  buffer_load_dwordx4 v180, s[4:7], s92 offen lds
  s_add_u32 m0, s77, 102400
  s_nop 0
  buffer_load_dwordx4 v181, s[4:7], s92 offen lds
  s_add_u32 m0, s94, 106496
  s_nop 0
  buffer_load_dwordx4 v182, s[4:7], s92 offen lds
  s_add_u32 m0, s94, 110592
  s_nop 0
  buffer_load_dwordx4 v183, s[4:7], s92 offen lds
  s_add_u32 m0, s94, 114688
  s_nop 0
  buffer_load_dwordx4 v184, s[4:7], s92 offen lds
  s_xor_b32 s80, s90, 0
  s_add_u32 s80, s80, 2
  s_mul_i32 s80, s80, 98304
  s_add_u32 m0, s76, 24576
  s_nop 0
  buffer_load_dwordx4 v176, s[8:11], s80 offen offset:0 lds
  buffer_load_dwordx4 v176, s[8:11], s80 offen offset:1024 lds
  buffer_load_dwordx4 v176, s[8:11], s80 offen offset:2048 lds
  s_waitcnt vmcnt(18)
  s_barrier
  ds_read_b64_tr_b16 a[104:105], v186 offset:0
  ds_read_b64_tr_b16 a[106:107], v186 offset:512
  ds_read_b64_tr_b16 a[108:109], v187 offset:0
  ds_read_b64_tr_b16 a[110:111], v187 offset:512
  ds_read_b64_tr_b16 a[112:113], v186 offset:1024
  ds_read_b64_tr_b16 a[114:115], v186 offset:1536
  ds_read_b64_tr_b16 a[116:117], v187 offset:1024
  ds_read_b64_tr_b16 a[118:119], v187 offset:1536
  ds_read_b64_tr_b16 a[120:121], v186 offset:2048
  ds_read_b64_tr_b16 a[122:123], v186 offset:2560
  ds_read_b64_tr_b16 a[124:125], v187 offset:2048
  ds_read_b64_tr_b16 a[126:127], v187 offset:2560
  ds_read_b128 a[200:203], v190 offset:0
  ds_read_b128 a[204:207], v191 offset:0
  ds_read_b128 a[208:211], v190 offset:2048
  ds_read_b128 a[212:215], v191 offset:2048
  ds_read_b128 a[216:219], v190 offset:4096
  ds_read_b128 a[220:223], v191 offset:4096
  ds_read_b128 a[224:227], v190 offset:6144
  ds_read_b128 a[228:231], v191 offset:6144
  ds_read_b128 a[232:235], v190 offset:8192
  ds_read_b128 a[236:239], v191 offset:8192
  ds_read_b128 a[240:243], v190 offset:10240
  ds_read_b128 a[244:247], v191 offset:10240
  ds_read_b128 a[248:251], v190 offset:12288
  ds_read_b128 a[252:255], v191 offset:12288
  s_waitcnt vmcnt(10)
  s_barrier
  ds_read_b64_tr_b16 a[128:129], v186 offset:12288
  ds_read_b64_tr_b16 a[130:131], v186 offset:12800
  ds_read_b64_tr_b16 a[132:133], v187 offset:12288
  ds_read_b64_tr_b16 a[134:135], v187 offset:12800
  ds_read_b64_tr_b16 a[136:137], v186 offset:13312
  ds_read_b64_tr_b16 a[138:139], v186 offset:13824
  ds_read_b64_tr_b16 a[140:141], v187 offset:13312
  ds_read_b64_tr_b16 a[142:143], v187 offset:13824
  ds_read_b64_tr_b16 a[144:145], v186 offset:14336
  ds_read_b64_tr_b16 a[146:147], v186 offset:14848
  ds_read_b64_tr_b16 a[148:149], v187 offset:14336
  ds_read_b64_tr_b16 a[150:151], v187 offset:14848
  s_waitcnt lgkmcnt(0)
  v_mfma_f32_16x16x32_bf16 v[0:3], a[112:115], a[200:203], 0
  s_lshl_b32 s72, s2, 13
  s_lshl_b32 s73, s68, 11
  s_add_u32 s72, s72, s73
  v_mfma_f32_16x16x32_bf16 v[0:3], a[136:139], a[204:207], v[0:3]
  buffer_load_dwordx4 v[224:227], v209, s[4:7], s72 offen
  v_mfma_f32_16x16x32_bf16 v[4:7], a[140:143], a[204:207], 0
  v_mfma_f32_16x16x32_bf16 v[4:7], a[116:119], a[200:203], v[4:7]
  v_mfma_f32_16x16x32_bf16 v[8:11], a[200:203], a[120:123], 0
  v_mfma_f32_16x16x32_bf16 v[8:11], a[204:207], a[144:147], v[8:11]
  buffer_load_dwordx4 v[228:231], v209, s[4:7], s72 offen offset:1024
  v_mfma_f32_16x16x32_bf16 v[12:15], a[204:207], a[148:151], 0
  v_mfma_f32_16x16x32_bf16 v[12:15], a[200:203], a[124:127], v[12:15]
  v_mfma_f32_16x16x32_bf16 v[36:39], a[208:211], a[124:127], 0
  v_mfma_f32_16x16x32_bf16 v[36:39], a[212:215], a[148:151], v[36:39]
  v_mfma_f32_16x16x32_bf16 v[32:35], a[212:215], a[144:147], 0
  global_load_dwordx4 v[232:235], v209, s[50:51]
  s_lshr_b32 s3, s72, 7
  v_mfma_f32_16x16x32_bf16 v[32:35], a[208:211], a[120:123], v[32:35]
  v_mfma_f32_16x16x32_bf16 v[28:31], a[116:119], a[208:211], 0
  v_mfma_f32_16x16x32_bf16 v[28:31], a[140:143], a[212:215], v[28:31]
  v_mfma_f32_16x16x32_bf16 v[24:27], a[136:139], a[212:215], 0
  v_mfma_f32_16x16x32_bf16 v[24:27], a[112:115], a[208:211], v[24:27]
  v_mfma_f32_16x16x32_bf16 v[20:23], a[108:111], a[208:211], 0
  v_mfma_f32_16x16x32_bf16 v[20:23], a[132:135], a[212:215], v[20:23]
  v_mfma_f32_16x16x32_bf16 v[16:19], a[128:131], a[212:215], 0
  v_mfma_f32_16x16x32_bf16 v[16:19], a[104:107], a[208:211], v[16:19]
  v_mfma_f32_16x16x32_bf16 v[40:43], a[104:107], a[216:219], 0
  v_mfma_f32_16x16x32_bf16 v[40:43], a[128:131], a[220:223], v[40:43]
  v_mfma_f32_16x16x32_bf16 v[44:47], a[132:135], a[220:223], 0
  v_mfma_f32_16x16x32_bf16 v[44:47], a[108:111], a[216:219], v[44:47]
  v_mfma_f32_16x16x32_bf16 v[48:51], a[112:115], a[216:219], 0
  v_mfma_f32_16x16x32_bf16 v[48:51], a[136:139], a[220:223], v[48:51]
  v_mfma_f32_16x16x32_bf16 v[52:55], a[140:143], a[220:223], 0
  v_mfma_f32_16x16x32_bf16 v[52:55], a[116:119], a[216:219], v[52:55]
  v_mfma_f32_16x16x32_bf16 v[56:59], a[216:219], a[120:123], 0
  v_mfma_f32_16x16x32_bf16 v[56:59], a[220:223], a[144:147], v[56:59]
  v_mfma_f32_16x16x32_bf16 v[60:63], a[220:223], a[148:151], 0
  v_mfma_f32_16x16x32_bf16 v[60:63], a[216:219], a[124:127], v[60:63]
  s_xor_b32 s80, s90, 1
  s_add_u32 s80, s80, 2
  s_mul_i32 s80, s80, 98304
  s_add_u32 m0, s76, 36864
  v_mfma_f32_16x16x32_bf16 v[84:87], a[224:227], a[124:127], 0
  buffer_load_dwordx4 v176, s[8:11], s80 offen offset:0 lds
  v_mfma_f32_16x16x32_bf16 v[84:87], a[228:231], a[148:151], v[84:87]
  v_mfma_f32_16x16x32_bf16 v[80:83], a[228:231], a[144:147], 0
  buffer_load_dwordx4 v176, s[8:11], s80 offen offset:1024 lds
  v_mfma_f32_16x16x32_bf16 v[80:83], a[224:227], a[120:123], v[80:83]
  v_mfma_f32_16x16x32_bf16 v[76:79], a[116:119], a[224:227], 0
  buffer_load_dwordx4 v176, s[8:11], s80 offen offset:2048 lds
  v_mfma_f32_16x16x32_bf16 v[76:79], a[140:143], a[228:231], v[76:79]
  v_mfma_f32_16x16x32_bf16 v[72:75], a[136:139], a[228:231], 0
  s_waitcnt vmcnt(6)
  s_barrier
  v_mfma_f32_16x16x32_bf16 v[72:75], a[112:115], a[224:227], v[72:75]
  ds_read_b64_tr_b16 a[152:153], v186 offset:24576
  v_mfma_f32_16x16x32_bf16 v[68:71], a[108:111], a[224:227], 0
  s_xor_b32 s92, s91, 128
  s_add_u32 s92, s92, 128
  s_add_u32 m0, s77, 118784
  v_mfma_f32_16x16x32_bf16 v[68:71], a[132:135], a[228:231], v[68:71]
  buffer_load_dwordx4 v178, s[4:7], s92 offen lds
  ds_read_b64_tr_b16 a[154:155], v186 offset:25088
  v_mfma_f32_16x16x32_bf16 v[64:67], a[128:131], a[228:231], 0
  s_add_u32 m0, s77, 122880
  ds_read_b64_tr_b16 a[156:157], v187 offset:24576
  ds_read_b64_tr_b16 a[158:159], v187 offset:25088
  v_mfma_f32_16x16x32_bf16 v[64:67], a[104:107], a[224:227], v[64:67]
  buffer_load_dwordx4 v179, s[4:7], s92 offen lds
  ds_read_b64_tr_b16 a[160:161], v186 offset:25600
  v_mfma_f32_16x16x32_bf16 v[88:91], a[104:107], a[232:235], 0
  ds_read_b64_tr_b16 a[162:163], v186 offset:26112
  ds_read_b128 a[200:203], v192 offset:0
  v_mfma_f32_16x16x32_bf16 v[88:91], a[128:131], a[236:239], v[88:91]
  s_add_u32 m0, s77, 126976
  ds_read_b64_tr_b16 a[164:165], v187 offset:25600
  ds_read_b128 a[204:207], v193 offset:0
  v_mfma_f32_16x16x32_bf16 v[92:95], a[132:135], a[236:239], 0
  buffer_load_dwordx4 v180, s[4:7], s92 offen lds
  ds_read_b64_tr_b16 a[166:167], v187 offset:26112
  v_mfma_f32_16x16x32_bf16 v[92:95], a[108:111], a[232:235], v[92:95]
  ds_read_b64_tr_b16 a[168:169], v186 offset:26624
  ds_read_b128 a[208:211], v192 offset:2048
  v_mfma_f32_16x16x32_bf16 v[96:99], a[112:115], a[232:235], 0
  s_add_u32 m0, s77, 131072
  ds_read_b64_tr_b16 a[170:171], v186 offset:27136
  ds_read_b128 a[212:215], v193 offset:2048
  v_mfma_f32_16x16x32_bf16 v[96:99], a[136:139], a[236:239], v[96:99]
  buffer_load_dwordx4 v181, s[4:7], s92 offen lds
  ds_read_b64_tr_b16 a[172:173], v187 offset:26624
  v_mfma_f32_16x16x32_bf16 v[100:103], a[140:143], a[236:239], 0
  ds_read_b64_tr_b16 a[174:175], v187 offset:27136
  ds_read_b128 a[216:219], v192 offset:4096
  v_mfma_f32_16x16x32_bf16 v[100:103], a[116:119], a[232:235], v[100:103]
  s_add_u32 m0, s94, 135168
  ds_read_b128 a[220:223], v193 offset:4096
  v_mfma_f32_16x16x32_bf16 v[104:107], a[232:235], a[120:123], 0
  buffer_load_dwordx4 v182, s[4:7], s92 offen lds
  ds_read_b128 a[224:227], v192 offset:6144
  v_mfma_f32_16x16x32_bf16 v[104:107], a[236:239], a[144:147], v[104:107]
  ds_read_b128 a[228:231], v193 offset:6144
  v_mfma_f32_16x16x32_bf16 v[108:111], a[236:239], a[148:151], 0
  s_add_u32 m0, s94, 139264
  v_mfma_f32_16x16x32_bf16 v[108:111], a[232:235], a[124:127], v[108:111]
  buffer_load_dwordx4 v183, s[4:7], s92 offen lds
  v_mfma_f32_16x16x32_bf16 v[132:135], a[240:243], a[124:127], 0
  ds_read_b128 a[232:235], v192 offset:8192
  v_mfma_f32_16x16x32_bf16 v[132:135], a[244:247], a[148:151], v[132:135]
  s_add_u32 m0, s94, 143360
  ds_read_b128 a[236:239], v193 offset:8192
  v_mfma_f32_16x16x32_bf16 v[128:131], a[244:247], a[144:147], 0
  buffer_load_dwordx4 v184, s[4:7], s92 offen lds
  s_xor_b32 s80, s90, 2
  s_add_u32 s80, s80, 2
  v_mfma_f32_16x16x32_bf16 v[128:131], a[240:243], a[120:123], v[128:131]
  s_mul_i32 s80, s80, 98304
  v_mfma_f32_16x16x32_bf16 v[124:127], a[116:119], a[240:243], 0
  s_add_u32 m0, s76, 49152
  v_mfma_f32_16x16x32_bf16 v[124:127], a[140:143], a[244:247], v[124:127]
  buffer_load_dwordx4 v176, s[8:11], s80 offen offset:0 lds
  v_mfma_f32_16x16x32_bf16 v[120:123], a[136:139], a[244:247], 0
  v_mfma_f32_16x16x32_bf16 v[120:123], a[112:115], a[240:243], v[120:123]
  v_mfma_f32_16x16x32_bf16 v[116:119], a[108:111], a[240:243], 0
  buffer_load_dwordx4 v176, s[8:11], s80 offen offset:1024 lds
  v_mfma_f32_16x16x32_bf16 v[116:119], a[132:135], a[244:247], v[116:119]
  s_waitcnt vmcnt(9) lgkmcnt(6)
  s_barrier
  v_mfma_f32_16x16x32_bf16 v[112:115], a[128:131], a[244:247], 0
  ds_read_b64_tr_b16 a[176:177], v186 offset:36864
  ds_read_b64_tr_b16 a[178:179], v186 offset:37376
  v_mfma_f32_16x16x32_bf16 v[112:115], a[104:107], a[240:243], v[112:115]
  buffer_load_dwordx4 v176, s[8:11], s80 offen offset:2048 lds
  s_xor_b32 s80, s90, 3
  s_add_u32 s80, s80, 2
  v_mfma_f32_16x16x32_bf16 v[136:139], a[104:107], a[248:251], 0
  s_mul_i32 s80, s80, 98304
  ds_read_b64_tr_b16 a[180:181], v187 offset:36864
  ds_read_b64_tr_b16 a[182:183], v187 offset:37376
  v_mfma_f32_16x16x32_bf16 v[136:139], a[128:131], a[252:255], v[136:139]
  s_add_u32 m0, s76, 0
  ds_read_b64_tr_b16 a[184:185], v186 offset:37888
  ds_read_b64_tr_b16 a[186:187], v186 offset:38400
  v_mfma_f32_16x16x32_bf16 v[140:143], a[132:135], a[252:255], 0
  buffer_load_dwordx4 v176, s[8:11], s80 offen offset:0 lds
  ds_read_b64_tr_b16 a[188:189], v187 offset:37888
  v_mfma_f32_16x16x32_bf16 v[140:143], a[108:111], a[248:251], v[140:143]
  ds_read_b64_tr_b16 a[190:191], v187 offset:38400
  ds_read_b64_tr_b16 a[192:193], v186 offset:38912
  v_mfma_f32_16x16x32_bf16 v[144:147], a[112:115], a[248:251], 0
  ds_read_b64_tr_b16 a[194:195], v186 offset:39424
  ds_read_b64_tr_b16 a[196:197], v187 offset:38912
  v_mfma_f32_16x16x32_bf16 v[144:147], a[136:139], a[252:255], v[144:147]
  buffer_load_dwordx4 v176, s[8:11], s80 offen offset:1024 lds
  ds_read_b64_tr_b16 a[198:199], v187 offset:39424
  v_mfma_f32_16x16x32_bf16 v[148:151], a[140:143], a[252:255], 0
  ds_read_b128 a[240:243], v192 offset:10240
  v_mfma_f32_16x16x32_bf16 v[148:151], a[116:119], a[248:251], v[148:151]
  ds_read_b128 a[244:247], v193 offset:10240
  v_mfma_f32_16x16x32_bf16 v[152:155], a[248:251], a[120:123], 0
  buffer_load_dwordx4 v176, s[8:11], s80 offen offset:2048 lds
  v_mfma_f32_16x16x32_bf16 v[152:155], a[252:255], a[144:147], v[152:155]
  v_mfma_f32_16x16x32_bf16 v[156:159], a[252:255], a[148:151], 0
  v_mfma_f32_16x16x32_bf16 v[156:159], a[248:251], a[124:127], v[156:159]
  s_waitcnt lgkmcnt(2)
  v_mfma_f32_16x16x32_bf16 v[0:3], a[160:163], a[200:203], v[0:3]
  s_xor_b32 s92, s91, 256
  s_add_u32 s92, s92, 128
  s_add_u32 m0, s77, 61440
  v_mfma_f32_16x16x32_bf16 v[0:3], a[184:187], a[204:207], v[0:3]
  buffer_load_dwordx4 v178, s[4:7], s92 offen lds
  ds_read_b128 a[248:251], v192 offset:12288
  v_mfma_f32_16x16x32_bf16 v[4:7], a[188:191], a[204:207], v[4:7]
  s_add_u32 m0, s77, 65536
  ds_read_b128 a[252:255], v193 offset:12288
  v_mfma_f32_16x16x32_bf16 v[4:7], a[164:167], a[200:203], v[4:7]
  buffer_load_dwordx4 v179, s[4:7], s92 offen lds
  v_mfma_f32_16x16x32_bf16 v[8:11], a[200:203], a[168:171], v[8:11]
  v_lshlrev_b32 v247, 20, v208
  v_mfma_f32_16x16x32_bf16 v[8:11], a[204:207], a[192:195], v[8:11]
  s_add_u32 m0, s77, 69632
  v_mfma_f32_16x16x32_bf16 v[12:15], a[204:207], a[196:199], v[12:15]
  buffer_load_dwordx4 v180, s[4:7], s92 offen lds
  v_mov_b32 v252, 1
  v_mfma_f32_16x16x32_bf16 v[12:15], a[200:203], a[172:175], v[12:15]
  buffer_store_dword v252, v247, s[64:67], s45 offen sc1
  v_mfma_f32_16x16x32_bf16 v[36:39], a[208:211], a[172:175], v[36:39]
  s_add_u32 m0, s77, 73728
  s_mov_b32 s89, 0x3f803f80
  v_mfma_f32_16x16x32_bf16 v[36:39], a[212:215], a[196:199], v[36:39]
  buffer_load_dwordx4 v181, s[4:7], s92 offen lds
  v_mfma_f32_16x16x32_bf16 v[32:35], a[212:215], a[192:195], v[32:35]
  s_add_u32 m0, s94, 77824
  v_lshlrev_b32 v240, 16, v232
  v_mfma_f32_16x16x32_bf16 v[32:35], a[208:211], a[168:171], v[32:35]
  buffer_load_dwordx4 v182, s[4:7], s92 offen lds
  v_mfma_f32_16x16x32_bf16 v[28:31], a[164:167], a[208:211], v[28:31]
  s_mov_b32 s16, s56
  s_mov_b32 s17, s57
  v_mfma_f32_16x16x32_bf16 v[28:31], a[188:191], a[212:215], v[28:31]
  s_add_u32 m0, s94, 81920
  s_mov_b32 s18, 9437184
  s_mov_b32 s19, 0x20000
  v_mfma_f32_16x16x32_bf16 v[24:27], a[184:187], a[212:215], v[24:27]
  buffer_load_dwordx4 v183, s[4:7], s92 offen lds
  v_and_b32 v232, 0xffff0000, v232
  v_mfma_f32_16x16x32_bf16 v[24:27], a[160:163], a[208:211], v[24:27]
  s_add_u32 s32, s56, 9437184
  s_addc_u32 s33, s57, 0
  v_mfma_f32_16x16x32_bf16 v[20:23], a[156:159], a[208:211], v[20:23]
  s_add_u32 m0, s94, 86016
  s_mov_b32 s34, 16384
  s_mov_b32 s35, 0x20000
  v_mfma_f32_16x16x32_bf16 v[20:23], a[180:183], a[212:215], v[20:23]
  buffer_load_dwordx4 v184, s[4:7], s92 offen lds
  s_xor_b32 s80, s90, 4
  s_add_u32 s80, s80, 2
  s_mul_i32 s80, s80, 98304
  v_mfma_f32_16x16x32_bf16 v[16:19], a[176:179], a[212:215], v[16:19]
  s_add_u32 m0, s76, 12288
  v_lshlrev_b32 v241, 16, v224
  v_and_b32 v224, 0xffff0000, v224
  v_mfma_f32_16x16x32_bf16 v[16:19], a[152:155], a[208:211], v[16:19]
  buffer_load_dwordx4 v176, s[8:11], s80 offen offset:0 lds
  v_mul_f32 v241, v241, v240
  v_mfma_f32_16x16x32_bf16 v[40:43], a[152:155], a[216:219], v[40:43]
  s_add_u32 s60, s56, 9453568
  s_addc_u32 s61, s57, 0
  v_mfma_f32_16x16x32_bf16 v[40:43], a[176:179], a[220:223], v[40:43]
  s_mov_b32 s62, 131072
  s_mov_b32 s63, 0x20000
  v_mul_f32 v224, v224, v232
  v_mfma_f32_16x16x32_bf16 v[44:47], a[180:183], a[220:223], v[44:47]
  buffer_load_dwordx4 v176, s[8:11], s80 offen offset:1024 lds
  v_cvt_pk_bf16_f32 v224, v241, v224
  v_mfma_f32_16x16x32_bf16 v[44:47], a[156:159], a[216:219], v[44:47]
  s_mov_b32 s64, s54
  s_mov_b32 s65, s55
  v_mfma_f32_16x16x32_bf16 v[48:51], a[160:163], a[216:219], v[48:51]
  v_dot2_f32_bf16 v222, v224, s89, 0
  v_mfma_f32_16x16x32_bf16 v[48:51], a[184:187], a[220:223], v[48:51]
  buffer_load_dwordx4 v176, s[8:11], s80 offen offset:2048 lds
  s_mov_b32 s66, 192
  v_mfma_f32_16x16x32_bf16 v[52:55], a[188:191], a[220:223], v[52:55]
  v_lshlrev_b32 v241, 16, v228
  v_mfma_f32_16x16x32_bf16 v[52:55], a[164:167], a[216:219], v[52:55]
  s_mov_b32 s67, 0x20000
  v_mfma_f32_16x16x32_bf16 v[56:59], a[216:219], a[168:171], v[56:59]
  v_mfma_f32_16x16x32_bf16 v[56:59], a[220:223], a[192:195], v[56:59]
  v_and_b32 v228, 0xffff0000, v228
  v_mfma_f32_16x16x32_bf16 v[60:63], a[220:223], a[196:199], v[60:63]
  v_mfma_f32_16x16x32_bf16 v[60:63], a[216:219], a[172:175], v[60:63]
  v_mul_f32 v241, v241, v240
  v_mfma_f32_16x16x32_bf16 v[84:87], a[224:227], a[172:175], v[84:87]
  v_mfma_f32_16x16x32_bf16 v[84:87], a[228:231], a[196:199], v[84:87]
  v_mul_f32 v228, v228, v232
  v_mfma_f32_16x16x32_bf16 v[80:83], a[228:231], a[192:195], v[80:83]
  v_mfma_f32_16x16x32_bf16 v[80:83], a[224:227], a[168:171], v[80:83]
  v_cvt_pk_bf16_f32 v228, v241, v228
  v_mfma_f32_16x16x32_bf16 v[76:79], a[164:167], a[224:227], v[76:79]
  v_mfma_f32_16x16x32_bf16 v[76:79], a[188:191], a[228:231], v[76:79]
  v_dot2_f32_bf16 v223, v228, s89, 0
  v_mfma_f32_16x16x32_bf16 v[72:75], a[184:187], a[228:231], v[72:75]
  s_waitcnt vmcnt(14) lgkmcnt(0)
  s_barrier
  v_mfma_f32_16x16x32_bf16 v[72:75], a[160:163], a[224:227], v[72:75]
  ds_read_b64_tr_b16 a[104:105], v186 offset:49152
  v_lshlrev_b32 v240, 16, v233
  v_mfma_f32_16x16x32_bf16 v[68:71], a[156:159], a[224:227], v[68:71]
  ds_read_b64_tr_b16 a[106:107], v186 offset:49664
  v_mfma_f32_16x16x32_bf16 v[68:71], a[180:183], a[228:231], v[68:71]
  ds_read_b64_tr_b16 a[108:109], v187 offset:49152
  ds_read_b128 a[200:203], v194 offset:0
  v_mfma_f32_16x16x32_bf16 v[64:67], a[176:179], a[228:231], v[64:67]
  ds_read_b64_tr_b16 a[110:111], v187 offset:49664
  ds_read_b128 a[204:207], v195 offset:0
  v_mfma_f32_16x16x32_bf16 v[64:67], a[152:155], a[224:227], v[64:67]
  ds_read_b64_tr_b16 a[112:113], v186 offset:50176
  ds_read_b128 a[208:211], v194 offset:2048
  v_mfma_f32_16x16x32_bf16 v[88:91], a[152:155], a[232:235], v[88:91]
  ds_read_b64_tr_b16 a[114:115], v186 offset:50688
  ds_read_b128 a[212:215], v195 offset:2048
  v_mfma_f32_16x16x32_bf16 v[88:91], a[176:179], a[236:239], v[88:91]
  ds_read_b64_tr_b16 a[116:117], v187 offset:50176
  ds_read_b128 a[216:219], v194 offset:4096
  v_mfma_f32_16x16x32_bf16 v[92:95], a[180:183], a[236:239], v[92:95]
  ds_read_b64_tr_b16 a[118:119], v187 offset:50688
  ds_read_b128 a[220:223], v195 offset:4096
  v_mfma_f32_16x16x32_bf16 v[92:95], a[156:159], a[232:235], v[92:95]
  ds_read_b64_tr_b16 a[120:121], v186 offset:51200
  ds_read_b128 a[224:227], v194 offset:6144
  v_mfma_f32_16x16x32_bf16 v[96:99], a[160:163], a[232:235], v[96:99]
  ds_read_b64_tr_b16 a[122:123], v186 offset:51712
  ds_read_b128 a[228:231], v195 offset:6144
  v_mfma_f32_16x16x32_bf16 v[96:99], a[184:187], a[236:239], v[96:99]
  ds_read_b64_tr_b16 a[124:125], v187 offset:51200
  v_and_b32 v233, 0xffff0000, v233
  v_mfma_f32_16x16x32_bf16 v[100:103], a[188:191], a[236:239], v[100:103]
  ds_read_b64_tr_b16 a[126:127], v187 offset:51712
  v_lshlrev_b32 v241, 16, v225
  v_mfma_f32_16x16x32_bf16 v[100:103], a[164:167], a[232:235], v[100:103]
  v_and_b32 v225, 0xffff0000, v225
  v_mul_f32 v241, v241, v240
  v_mfma_f32_16x16x32_bf16 v[104:107], a[232:235], a[168:171], v[104:107]
  v_mul_f32 v225, v225, v233
  v_cvt_pk_bf16_f32 v225, v241, v225
  v_mfma_f32_16x16x32_bf16 v[104:107], a[236:239], a[192:195], v[104:107]
  s_mov_b32 s24, s48
  s_mov_b32 s25, s49
  v_mfma_f32_16x16x32_bf16 v[108:111], a[236:239], a[196:199], v[108:111]
  v_dot2_f32_bf16 v222, v225, s89, v222
  s_mov_b32 s26, 1835008
  v_mfma_f32_16x16x32_bf16 v[108:111], a[232:235], a[172:175], v[108:111]
  s_mov_b32 s27, 0x20000
  v_mfma_f32_16x16x32_bf16 v[132:135], a[240:243], a[172:175], v[132:135]
  ds_read_b128 a[232:235], v194 offset:8192
  v_lshlrev_b32 v241, 16, v229
  v_mfma_f32_16x16x32_bf16 v[132:135], a[244:247], a[196:199], v[132:135]
  ds_read_b128 a[236:239], v195 offset:8192
  v_mfma_f32_16x16x32_bf16 v[128:131], a[244:247], a[192:195], v[128:131]
  v_and_b32 v229, 0xffff0000, v229
  v_mfma_f32_16x16x32_bf16 v[128:131], a[240:243], a[168:171], v[128:131]
  s_mov_b32 s28, s52
  s_mov_b32 s29, s53
  v_mfma_f32_16x16x32_bf16 v[124:127], a[164:167], a[240:243], v[124:127]
  v_mul_f32 v241, v241, v240
  s_mov_b32 s30, 2097152
  v_mfma_f32_16x16x32_bf16 v[124:127], a[188:191], a[244:247], v[124:127]
  s_mov_b32 s31, 0x20000
  s_mov_b32 s22, 1835008
  v_mfma_f32_16x16x32_bf16 v[120:123], a[184:187], a[244:247], v[120:123]
  v_mul_f32 v229, v229, v233
  v_mfma_f32_16x16x32_bf16 v[120:123], a[160:163], a[240:243], v[120:123]
  s_cmp_lt_u32 s69, 4
  s_cselect_b32 s20, s40, s48
  s_cselect_b32 s21, s41, s49
  s_cselect_b32 s22, 524288, s22
  v_mfma_f32_16x16x32_bf16 v[116:119], a[156:159], a[240:243], v[116:119]
  v_cvt_pk_bf16_f32 v229, v241, v229
  s_mov_b32 s23, 0x20000
  v_mfma_f32_16x16x32_bf16 v[116:119], a[180:183], a[244:247], v[116:119]
  s_waitcnt vmcnt(11) lgkmcnt(2)
  s_barrier
  s_mov_b32 s86, 3216550459
  v_mfma_f32_16x16x32_bf16 v[112:115], a[176:179], a[244:247], v[112:115]
  ds_read_b64_tr_b16 a[128:129], v186 offset:0
  ds_read_b64_tr_b16 a[130:131], v186 offset:512
  v_mfma_f32_16x16x32_bf16 v[112:115], a[152:155], a[240:243], v[112:115]
  ds_read_b64_tr_b16 a[132:133], v187 offset:0
  v_dot2_f32_bf16 v223, v229, s89, v223
  v_mfma_f32_16x16x32_bf16 v[136:139], a[152:155], a[248:251], v[136:139]
  ds_read_b64_tr_b16 a[134:135], v187 offset:512
  ds_read_b64_tr_b16 a[136:137], v186 offset:1024
  v_mfma_f32_16x16x32_bf16 v[136:139], a[176:179], a[252:255], v[136:139]
  s_xor_b32 s80, s90, 5
  s_add_u32 s80, s80, 2
  s_mul_i32 s80, s80, 98304
  s_add_u32 m0, s76, 24576
  v_mfma_f32_16x16x32_bf16 v[140:143], a[180:183], a[252:255], v[140:143]
  buffer_load_dwordx4 v176, s[8:11], s80 offen offset:0 lds
  ds_read_b64_tr_b16 a[138:139], v186 offset:1536
  v_mfma_f32_16x16x32_bf16 v[140:143], a[156:159], a[248:251], v[140:143]
  ds_read_b64_tr_b16 a[140:141], v187 offset:1024
  ds_read_b64_tr_b16 a[142:143], v187 offset:1536
  v_mfma_f32_16x16x32_bf16 v[144:147], a[160:163], a[248:251], v[144:147]
  ds_read_b64_tr_b16 a[144:145], v186 offset:2048
  ds_read_b64_tr_b16 a[146:147], v186 offset:2560
  v_mfma_f32_16x16x32_bf16 v[144:147], a[184:187], a[252:255], v[144:147]
  buffer_load_dwordx4 v176, s[8:11], s80 offen offset:1024 lds
  ds_read_b64_tr_b16 a[148:149], v187 offset:2048
  v_mfma_f32_16x16x32_bf16 v[148:151], a[188:191], a[252:255], v[148:151]
  ds_read_b64_tr_b16 a[150:151], v187 offset:2560
  ds_read_b128 a[240:243], v194 offset:10240
  v_mfma_f32_16x16x32_bf16 v[148:151], a[164:167], a[248:251], v[148:151]
  ds_read_b128 a[244:247], v195 offset:10240
  v_lshlrev_b32 v240, 16, v234
  v_mfma_f32_16x16x32_bf16 v[152:155], a[248:251], a[168:171], v[152:155]
  buffer_load_dwordx4 v176, s[8:11], s80 offen offset:2048 lds
  v_and_b32 v234, 0xffff0000, v234
  v_mfma_f32_16x16x32_bf16 v[152:155], a[252:255], a[192:195], v[152:155]
  v_lshlrev_b32 v241, 16, v226
  v_and_b32 v226, 0xffff0000, v226
  v_mfma_f32_16x16x32_bf16 v[156:159], a[252:255], a[196:199], v[156:159]
  v_mul_f32 v241, v241, v240
  s_mov_b32 s87, 3216550459
  v_mfma_f32_16x16x32_bf16 v[156:159], a[248:251], a[172:175], v[156:159]
  s_waitcnt lgkmcnt(2)
  v_mul_f32 v226, v226, v234
  v_mfma_f32_16x16x32_bf16 v[0:3], a[112:115], a[200:203], v[0:3]
  s_xor_b32 s92, s91, 384
  s_add_u32 s92, s92, 128
  s_add_u32 m0, s77, 90112
  v_mfma_f32_16x16x32_bf16 v[0:3], a[136:139], a[204:207], v[0:3]
  buffer_load_dwordx4 v178, s[4:7], s92 offen lds
  ds_read_b128 a[248:251], v194 offset:12288
  v_mfma_f32_16x16x32_bf16 v[4:7], a[140:143], a[204:207], v[4:7]
  ds_read_b128 a[252:255], v195 offset:12288
  v_cvt_pk_bf16_f32 v226, v241, v226
  v_mfma_f32_16x16x32_bf16 v[4:7], a[116:119], a[200:203], v[4:7]
  s_add_u32 m0, s77, 94208
  v_dot2_f32_bf16 v222, v226, s89, v222
  v_lshlrev_b32 v213, 2, v208
  v_mfma_f32_16x16x32_bf16 v[8:11], a[200:203], a[120:123], v[8:11]
  buffer_load_dwordx4 v179, s[4:7], s92 offen lds
  buffer_load_dword v213, v213, s[64:67], 0 offen sc1
  v_mfma_f32_16x16x32_bf16 v[8:11], a[204:207], a[144:147], v[8:11]
  v_lshlrev_b32 v241, 16, v230
  s_lshr_b32 s48, s69, 2
  v_mfma_f32_16x16x32_bf16 v[12:15], a[204:207], a[148:151], v[12:15]
  s_lshr_b32 s71, s70, 2
  s_xor_b32 s71, s71, 4
  s_lshl_b32 s71, s71, 7
  v_mfma_f32_16x16x32_bf16 v[12:15], a[200:203], a[124:127], v[12:15]
  s_add_u32 m0, s77, 98304
  v_and_b32 v230, 0xffff0000, v230
  v_mfma_f32_16x16x32_bf16 v[36:39], a[208:211], a[124:127], v[36:39]
  buffer_load_dwordx4 v180, s[4:7], s92 offen lds
  s_lshl_b32 s84, s68, 12
  v_mfma_f32_16x16x32_bf16 v[36:39], a[212:215], a[148:151], v[36:39]
  v_mul_f32 v241, v241, v240
  s_mul_i32 s82, s68, 163840
  v_mfma_f32_16x16x32_bf16 v[32:35], a[212:215], a[144:147], v[32:35]
  s_mul_i32 s83, s68, 131072
  s_mul_i32 s72, s68, 294912
  s_add_u32 s72, s72, 655360
  v_mfma_f32_16x16x32_bf16 v[32:35], a[208:211], a[120:123], v[32:35]
  s_add_u32 m0, s77, 102400
  v_mul_f32 v230, v230, v234
  s_add_u32 s73, s72, 163840
  v_mfma_f32_16x16x32_bf16 v[28:31], a[116:119], a[208:211], v[28:31]
  buffer_load_dwordx4 v181, s[4:7], s92 offen lds
  v_mfma_f32_16x16x32_bf16 v[28:31], a[140:143], a[212:215], v[28:31]
  s_cmp_eq_u32 s48, 0
  s_cselect_b32 s82, s82, s72
  s_cselect_b32 s83, s83, s73
  v_mfma_f32_16x16x32_bf16 v[24:27], a[136:139], a[212:215], v[24:27]
  v_cvt_pk_bf16_f32 v230, v241, v230
  v_lshrrev_b32 v236, 4, v208
  v_mfma_f32_16x16x32_bf16 v[24:27], a[112:115], a[208:211], v[24:27]
  s_add_u32 m0, s94, 106496
  v_lshlrev_b32 v236, 1, v236
  v_and_b32 v237, 7, v208
  v_mfma_f32_16x16x32_bf16 v[20:23], a[108:111], a[208:211], v[20:23]
  buffer_load_dwordx4 v182, s[4:7], s92 offen lds
  v_dot2_f32_bf16 v223, v230, s89, v223
  v_mfma_f32_16x16x32_bf16 v[20:23], a[132:135], a[212:215], v[20:23]
  v_xor_b32 v237, v237, v236
  v_lshlrev_b32 v237, 4, v237
  v_mfma_f32_16x16x32_bf16 v[16:19], a[128:131], a[212:215], v[16:19]
  v_lshlrev_b32 v240, 16, v235
  v_lshrrev_b32 v238, 3, v208
  v_mfma_f32_16x16x32_bf16 v[16:19], a[104:107], a[208:211], v[16:19]
  s_add_u32 m0, s94, 110592
  v_lshl_add_u32 v237, v238, 10, v237
  v_mfma_f32_16x16x32_bf16 v[40:43], a[104:107], a[216:219], v[40:43]
  buffer_load_dwordx4 v183, s[4:7], s92 offen lds
  v_and_b32 v235, 0xffff0000, v235
  v_mfma_f32_16x16x32_bf16 v[40:43], a[128:131], a[220:223], v[40:43]
  v_add_u32 v212, s71, v237
  v_add_u32 v204, 7168, v212
  v_mfma_f32_16x16x32_bf16 v[44:47], a[132:135], a[220:223], v[44:47]
  v_lshlrev_b32 v241, 16, v227
  v_add_u32 v205, 14336, v212
  v_mfma_f32_16x16x32_bf16 v[44:47], a[108:111], a[216:219], v[44:47]
  s_add_u32 m0, s94, 114688
  v_add_u32 v206, 21504, v212
  v_lshlrev_b32 v214, 20, v238
  v_mfma_f32_16x16x32_bf16 v[48:51], a[112:115], a[216:219], v[48:51]
  buffer_load_dwordx4 v184, s[4:7], s92 offen lds
  s_xor_b32 s80, s90, 6
  v_mfma_f32_16x16x32_bf16 v[48:51], a[136:139], a[220:223], v[48:51]
  s_add_u32 s80, s80, 2
  v_and_b32 v227, 0xffff0000, v227
  v_lshrrev_b32 v236, 2, v208
  v_mfma_f32_16x16x32_bf16 v[52:55], a[140:143], a[220:223], v[52:55]
  s_mul_i32 s80, s80, 98304
  v_mul_f32 v241, v241, v240
  v_and_b32 v237, 3, v238
  v_mfma_f32_16x16x32_bf16 v[52:55], a[116:119], a[216:219], v[52:55]
  s_add_u32 m0, s76, 36864
  v_lshlrev_b32 v237, 5, v237
  v_lshl_add_u32 v237, v236, 7, v237
  v_mfma_f32_16x16x32_bf16 v[56:59], a[216:219], a[120:123], v[56:59]
  buffer_load_dwordx4 v176, s[8:11], s80 offen offset:0 lds
  v_mul_f32 v227, v227, v235
  v_mfma_f32_16x16x32_bf16 v[56:59], a[220:223], a[144:147], v[56:59]
  v_and_b32 v238, 3, v208
  v_lshl_add_u32 v237, v238, 3, v237
  v_mfma_f32_16x16x32_bf16 v[60:63], a[220:223], a[148:151], v[60:63]
  v_cvt_pk_bf16_f32 v227, v241, v227
  v_add_u32 v217, s84, v237
  v_mfma_f32_16x16x32_bf16 v[60:63], a[216:219], a[124:127], v[60:63]
  v_xor_b32 v218, 32, v217
  v_mfma_f32_16x16x32_bf16 v[84:87], a[224:227], a[124:127], v[84:87]
  buffer_load_dwordx4 v176, s[8:11], s80 offen offset:1024 lds
  v_dot2_f32_bf16 v222, v227, s89, v222
  v_mfma_f32_16x16x32_bf16 v[84:87], a[228:231], a[148:151], v[84:87]
  v_xor_b32 v219, 64, v217
  v_mfma_f32_16x16x32_bf16 v[80:83], a[228:231], a[144:147], v[80:83]
  v_lshlrev_b32 v241, 16, v231
  v_mfma_f32_16x16x32_bf16 v[80:83], a[224:227], a[120:123], v[80:83]
  v_xor_b32 v220, 96, v217
  v_mfma_f32_16x16x32_bf16 v[76:79], a[116:119], a[224:227], v[76:79]
  buffer_load_dwordx4 v176, s[8:11], s80 offen offset:2048 lds
  v_add_u32 v200, 131072, v217
  v_mfma_f32_16x16x32_bf16 v[76:79], a[140:143], a[228:231], v[76:79]
  v_and_b32 v231, 0xffff0000, v231
  v_mfma_f32_16x16x32_bf16 v[72:75], a[136:139], a[228:231], v[72:75]
  s_waitcnt vmcnt(14) lgkmcnt(0)
  s_barrier
  v_add_u32 v201, 131072, v218
  v_mfma_f32_16x16x32_bf16 v[72:75], a[112:115], a[224:227], v[72:75]
  ds_read_b64_tr_b16 a[152:153], v186 offset:12288
  v_mul_f32 v241, v241, v240
  v_mfma_f32_16x16x32_bf16 v[68:71], a[108:111], a[224:227], v[68:71]
  s_xor_b32 s80, s90, 7
  s_add_u32 s80, s80, 2
  s_mul_i32 s80, s80, 98304
  s_add_u32 m0, s76, 49152
  v_mfma_f32_16x16x32_bf16 v[68:71], a[132:135], a[228:231], v[68:71]
  buffer_load_dwordx4 v176, s[8:11], s80 offen offset:0 lds
  ds_read_b64_tr_b16 a[154:155], v186 offset:12800
  v_mfma_f32_16x16x32_bf16 v[64:67], a[128:131], a[228:231], v[64:67]
  ds_read_b64_tr_b16 a[156:157], v187 offset:12288
  ds_read_b64_tr_b16 a[158:159], v187 offset:12800
  v_mfma_f32_16x16x32_bf16 v[64:67], a[104:107], a[224:227], v[64:67]
  ds_read_b64_tr_b16 a[160:161], v186 offset:13312
  ds_read_b128 a[200:203], v190 offset:0
  v_mfma_f32_16x16x32_bf16 v[88:91], a[104:107], a[232:235], v[88:91]
  ds_read_b64_tr_b16 a[162:163], v186 offset:13824
  ds_read_b128 a[204:207], v191 offset:0
  v_mfma_f32_16x16x32_bf16 v[88:91], a[128:131], a[236:239], v[88:91]
  buffer_load_dwordx4 v176, s[8:11], s80 offen offset:1024 lds
  ds_read_b64_tr_b16 a[164:165], v187 offset:13312
  v_mfma_f32_16x16x32_bf16 v[92:95], a[132:135], a[236:239], v[92:95]
  ds_read_b64_tr_b16 a[166:167], v187 offset:13824
  ds_read_b128 a[208:211], v190 offset:2048
  v_mfma_f32_16x16x32_bf16 v[92:95], a[108:111], a[232:235], v[92:95]
  ds_read_b64_tr_b16 a[168:169], v186 offset:14336
  ds_read_b128 a[212:215], v191 offset:2048
  v_mfma_f32_16x16x32_bf16 v[96:99], a[112:115], a[232:235], v[96:99]
  ds_read_b64_tr_b16 a[170:171], v186 offset:14848
  ds_read_b128 a[216:219], v190 offset:4096
  v_mfma_f32_16x16x32_bf16 v[96:99], a[136:139], a[236:239], v[96:99]
  ds_read_b64_tr_b16 a[172:173], v187 offset:14336
  ds_read_b128 a[220:223], v191 offset:4096
  v_mfma_f32_16x16x32_bf16 v[100:103], a[140:143], a[236:239], v[100:103]
  buffer_load_dwordx4 v176, s[8:11], s80 offen offset:2048 lds
  ds_read_b64_tr_b16 a[174:175], v187 offset:14848
  v_mfma_f32_16x16x32_bf16 v[100:103], a[116:119], a[232:235], v[100:103]
  ds_read_b128 a[224:227], v190 offset:6144
  v_mul_f32 v231, v231, v235
  v_mfma_f32_16x16x32_bf16 v[104:107], a[232:235], a[120:123], v[104:107]
  s_xor_b32 s92, s91, 512
  s_add_u32 s92, s92, 128
  s_add_u32 m0, s77, 118784
  v_mfma_f32_16x16x32_bf16 v[104:107], a[236:239], a[144:147], v[104:107]
  buffer_load_dwordx4 v178, s[4:7], s92 offen lds
  ds_read_b128 a[228:231], v191 offset:6144
  v_mfma_f32_16x16x32_bf16 v[108:111], a[236:239], a[148:151], v[108:111]
  v_cvt_pk_bf16_f32 v231, v241, v231
  v_dot2_f32_bf16 v223, v231, s89, v223
  v_mfma_f32_16x16x32_bf16 v[108:111], a[232:235], a[124:127], v[108:111]
  s_add_u32 m0, s77, 122880
  v_add_u32 v202, 131072, v219
  v_mfma_f32_16x16x32_bf16 v[132:135], a[240:243], a[124:127], v[132:135]
  buffer_load_dwordx4 v179, s[4:7], s92 offen lds
  ds_read_b128 a[232:235], v190 offset:8192
  v_mfma_f32_16x16x32_bf16 v[132:135], a[244:247], a[148:151], v[132:135]
  ds_read_b128 a[236:239], v191 offset:8192
  v_add_u32 v203, 131072, v220
  v_mfma_f32_16x16x32_bf16 v[128:131], a[244:247], a[144:147], v[128:131]
  v_permlane32_swap_b32 v222, v223
  v_mfma_f32_16x16x32_bf16 v[128:131], a[240:243], a[120:123], v[128:131]
  s_add_u32 m0, s77, 126976
  v_add_f32 v223, v222, v223
  v_mov_b32 v222, v223
  v_mfma_f32_16x16x32_bf16 v[124:127], a[116:119], a[240:243], v[124:127]
  buffer_load_dwordx4 v180, s[4:7], s92 offen lds
  v_and_b32 v239, 31, v208
  v_mfma_f32_16x16x32_bf16 v[124:127], a[140:143], a[244:247], v[124:127]
  v_lshlrev_b32 v239, 20, v239
  v_mov_b32 v211, 1
  v_mfma_f32_16x16x32_bf16 v[120:123], a[136:139], a[244:247], v[120:123]
  v_permlane16_swap_b32 v222, v223
  v_mfma_f32_16x16x32_bf16 v[120:123], a[112:115], a[240:243], v[120:123]
  s_add_u32 m0, s77, 131072
  v_add_f32 v223, v222, v223
  s_lshl_b32 s73, s68, 11
  v_mfma_f32_16x16x32_bf16 v[116:119], a[108:111], a[240:243], v[116:119]
  buffer_load_dwordx4 v181, s[4:7], s92 offen lds
  s_lshl_b32 s49, s2, 13
  v_mfma_f32_16x16x32_bf16 v[116:119], a[132:135], a[244:247], v[116:119]
  s_waitcnt vmcnt(18) lgkmcnt(4)
  s_barrier
  v_add_f32_dpp v223, v223, v223 row_ror:8 row_mask:0xf bank_mask:0xf
  v_mfma_f32_16x16x32_bf16 v[112:115], a[128:131], a[244:247], v[112:115]
  ds_read_b64_tr_b16 a[176:177], v186 offset:24576
  ds_read_b64_tr_b16 a[178:179], v186 offset:25088
  v_mfma_f32_16x16x32_bf16 v[112:115], a[104:107], a[240:243], v[112:115]
  s_add_u32 m0, s94, 135168
  ds_read_b64_tr_b16 a[180:181], v187 offset:24576
  v_mfma_f32_16x16x32_bf16 v[136:139], a[104:107], a[248:251], v[136:139]
  buffer_load_dwordx4 v182, s[4:7], s92 offen lds
  ds_read_b64_tr_b16 a[182:183], v187 offset:25088
  v_mfma_f32_16x16x32_bf16 v[136:139], a[128:131], a[252:255], v[136:139]
  ds_read_b64_tr_b16 a[184:185], v186 offset:25600
  ds_read_b64_tr_b16 a[186:187], v186 offset:26112
  v_mfma_f32_16x16x32_bf16 v[140:143], a[132:135], a[252:255], v[140:143]
  ds_read_b64_tr_b16 a[188:189], v187 offset:25600
  ds_read_b64_tr_b16 a[190:191], v187 offset:26112
  v_mfma_f32_16x16x32_bf16 v[140:143], a[108:111], a[248:251], v[140:143]
  s_add_u32 m0, s94, 139264
  ds_read_b64_tr_b16 a[192:193], v186 offset:26624
  ds_read_b128 a[240:243], v190 offset:10240
  v_mfma_f32_16x16x32_bf16 v[144:147], a[112:115], a[248:251], v[144:147]
  buffer_load_dwordx4 v183, s[4:7], s92 offen lds
  ds_read_b64_tr_b16 a[194:195], v186 offset:27136
  v_mfma_f32_16x16x32_bf16 v[144:147], a[136:139], a[252:255], v[144:147]
  ds_read_b64_tr_b16 a[196:197], v187 offset:26624
  ds_read_b64_tr_b16 a[198:199], v187 offset:27136
  v_mfma_f32_16x16x32_bf16 v[148:151], a[140:143], a[252:255], v[148:151]
  ds_read_b128 a[244:247], v191 offset:10240
  v_add_f32_dpp v223, v223, v223 row_ror:4 row_mask:0xf bank_mask:0xf
  v_mfma_f32_16x16x32_bf16 v[148:151], a[116:119], a[248:251], v[148:151]
  s_add_u32 m0, s94, 143360
  s_add_u32 s49, s49, s73
  s_and_b32 s72, s69, 3
  v_mfma_f32_16x16x32_bf16 v[152:155], a[248:251], a[120:123], v[152:155]
  buffer_load_dwordx4 v184, s[4:7], s92 offen lds
  v_add_f32_dpp v223, v223, v223 row_ror:2 row_mask:0xf bank_mask:0xf
  v_mfma_f32_16x16x32_bf16 v[152:155], a[252:255], a[144:147], v[152:155]
  s_lshl_b32 s72, s72, 2
  s_and_b32 s73, s70, 3
  s_add_u32 s72, s72, s73
  v_mfma_f32_16x16x32_bf16 v[156:159], a[252:255], a[148:151], v[156:159]
  v_add_f32_dpp v223, v223, v223 row_ror:1 row_mask:0xf bank_mask:0xf
  v_cvt_pk_bf16_f32 v223, v223, v223
  v_mfma_f32_16x16x32_bf16 v[156:159], a[248:251], a[124:127], v[156:159]
  s_waitcnt lgkmcnt(1)
  v_and_b32 v223, 0xffff0000, v223
  v_mfma_f32_16x16x32_bf16 v[0:3], a[160:163], a[200:203], v[0:3]
  s_xor_b32 s80, s90, 8
  s_add_u32 s80, s80, 2
  s_mul_i32 s80, s80, 98304
  s_add_u32 m0, s76, 0
  v_mfma_f32_16x16x32_bf16 v[0:3], a[184:187], a[204:207], v[0:3]
  buffer_load_dwordx4 v176, s[8:11], s80 offen offset:0 lds
  ds_read_b128 a[248:251], v190 offset:12288
  v_mfma_f32_16x16x32_bf16 v[4:7], a[188:191], a[204:207], v[4:7]
  ds_read_b128 a[252:255], v191 offset:12288
  v_mul_f32 v223, 3216550459, v223
  v_mfma_f32_16x16x32_bf16 v[4:7], a[164:167], a[200:203], v[4:7]
  v_exp_f32 v223, v223
  v_mfma_f32_16x16x32_bf16 v[8:11], a[200:203], a[168:171], v[8:11]
  v_lshrrev_b32 v222, 5, v208
  v_add_f32 v223, 1.0, v223
  v_mfma_f32_16x16x32_bf16 v[8:11], a[204:207], a[192:195], v[8:11]
  buffer_load_dwordx4 v176, s[8:11], s80 offen offset:1024 lds
  s_lshl_b32 s72, s72, 1
  v_mfma_f32_16x16x32_bf16 v[12:15], a[204:207], a[196:199], v[12:15]
  v_rcp_f32 v223, v223
  v_mfma_f32_16x16x32_bf16 v[12:15], a[200:203], a[172:175], v[12:15]
  v_lshl_add_u32 v239, v222, 3, v239
  v_cvt_pk_bf16_f32 v223, v223, v223
  v_mfma_f32_16x16x32_bf16 v[36:39], a[208:211], a[172:175], v[36:39]
  s_lshl_b32 s73, s48, 1
  v_lshrrev_b32 v236, 1, v208
  v_and_b32 v237, 1, v208
  v_mfma_f32_16x16x32_bf16 v[36:39], a[212:215], a[196:199], v[36:39]
  buffer_load_dwordx4 v176, s[8:11], s80 offen offset:2048 lds
  v_and_b32 v223, 0xffff0000, v223
  v_mfma_f32_16x16x32_bf16 v[32:35], a[212:215], a[192:195], v[32:35]
  v_add_u32 v236, s73, v236
  v_and_b32 v236, 3, v236
  v_mfma_f32_16x16x32_bf16 v[32:35], a[208:211], a[168:171], v[32:35]
  v_sub_f32 v222, 1.0, v223
  v_lshl_add_u32 v236, v236, 5, v237
  v_mfma_f32_16x16x32_bf16 v[28:31], a[164:167], a[208:211], v[28:31]
  v_add_u32 v236, s72, v236
  v_mov_b32 v237, v236
  v_mfma_f32_16x16x32_bf16 v[28:31], a[188:191], a[212:215], v[28:31]
  v_cvt_pk_bf16_f32 v222, v222, v222
  v_cmp_lt_u32 vcc, 64, v236
  v_mfma_f32_16x16x32_bf16 v[24:27], a[184:187], a[212:215], v[24:27]
  v_mfma_f32_16x16x32_bf16 v[24:27], a[160:163], a[208:211], v[24:27]
  v_and_b32 v222, 0xffff0000, v222
  v_addc_co_u32 v237, vcc, 0, v237, vcc
  v_mfma_f32_16x16x32_bf16 v[20:23], a[156:159], a[208:211], v[20:23]
  v_cmp_lt_u32 vcc, 85, v236
  v_mfma_f32_16x16x32_bf16 v[20:23], a[180:183], a[212:215], v[20:23]
  v_rcp_f32 v222, v222
  v_mfma_f32_16x16x32_bf16 v[16:19], a[176:179], a[212:215], v[16:19]
  v_addc_co_u32 v237, vcc, 0, v237, vcc
  v_cmp_lt_u32 vcc, 106, v236
  v_mfma_f32_16x16x32_bf16 v[16:19], a[152:155], a[208:211], v[16:19]
  v_min_f32 v222, 1900671690, v222
  v_mfma_f32_16x16x32_bf16 v[40:43], a[152:155], a[216:219], v[40:43]
  v_addc_co_u32 v237, vcc, 0, v237, vcc
  v_and_b32 v236, 1, v237
  v_mfma_f32_16x16x32_bf16 v[40:43], a[176:179], a[220:223], v[40:43]
  v_mul_u32_u24 v236, 66, v236
  v_lshrrev_b32 v237, 1, v237
  v_mfma_f32_16x16x32_bf16 v[44:47], a[180:183], a[220:223], v[44:47]
  v_mul_u32_u24 v238, 5958, v237
  v_lshrrev_b32 v238, 16, v238
  v_mfma_f32_16x16x32_bf16 v[44:47], a[156:159], a[216:219], v[44:47]
  v_mul_u32_u24 v216, 6, v237
  v_mul_u32_u24 v238, 65, v238
  v_mfma_f32_16x16x32_bf16 v[48:51], a[160:163], a[216:219], v[48:51]
  s_waitcnt vmcnt(21)
  v_cmp_eq_u32 s[100:101], 0, v213
  s_and_b32 s101, s101, 0xffff
  s_or_b32 s88, s100, s101
  s_cbranch_scc1 L_rdyq
L_rdyq_ret:
  v_mfma_f32_16x16x32_bf16 v[48:51], a[184:187], a[220:223], v[48:51]
  buffer_store_dwordx2 v[222:223], v239, s[32:35], s3 offen sc1
  v_sub_u32 v216, v216, v238
  v_mfma_f32_16x16x32_bf16 v[52:55], a[188:191], a[220:223], v[52:55]
  v_add_u32 v216, v236, v216
  s_xor_b32 s72, s48, 1
  v_mfma_f32_16x16x32_bf16 v[52:55], a[164:167], a[216:219], v[52:55]
  s_lshl_b32 s72, s72, 2
  s_add_u32 s72, s72, s68
  s_lshl_b32 s72, s72, 7
  v_mfma_f32_16x16x32_bf16 v[56:59], a[216:219], a[168:171], v[56:59]
  v_xor_b32 v221, 3, v208
  v_lshlrev_b32 v221, 20, v221
  v_mfma_f32_16x16x32_bf16 v[56:59], a[220:223], a[192:195], v[56:59]
  v_mfma_f32_16x16x32_bf16 v[60:63], a[220:223], a[196:199], v[60:63]
  v_lshl_add_u32 v221, v216, 10, v221
  v_mfma_f32_16x16x32_bf16 v[60:63], a[216:219], a[172:175], v[60:63]
  v_add_u32 v221, s72, v221
  v_mfma_f32_16x16x32_bf16 v[84:87], a[224:227], a[172:175], v[84:87]
  v_mfma_f32_16x16x32_bf16 v[84:87], a[228:231], a[196:199], v[84:87]
  v_cmp_le_u32 vcc, 7, v208
  v_mfma_f32_16x16x32_bf16 v[80:83], a[228:231], a[192:195], v[80:83]
  v_mfma_f32_16x16x32_bf16 v[80:83], a[224:227], a[168:171], v[80:83]
  v_mov_b32 v207, 9
  v_mfma_f32_16x16x32_bf16 v[76:79], a[164:167], a[224:227], v[76:79]
  v_mfma_f32_16x16x32_bf16 v[76:79], a[188:191], a[228:231], v[76:79]
  v_mov_b32 v238, 17
  v_mfma_f32_16x16x32_bf16 v[72:75], a[184:187], a[228:231], v[72:75]
  s_waitcnt vmcnt(14) lgkmcnt(0)
  s_barrier
  v_cndmask_b32 v207, v207, v238, vcc
  v_mfma_f32_16x16x32_bf16 v[72:75], a[160:163], a[224:227], v[72:75]
  ds_read_b64_tr_b16 a[104:105], v186 offset:36864
  v_mfma_f32_16x16x32_bf16 v[68:71], a[156:159], a[224:227], v[68:71]
  ds_read_b64_tr_b16 a[106:107], v186 offset:37376
  s_lshl_b32 s72, s48, 2
  v_mfma_f32_16x16x32_bf16 v[68:71], a[180:183], a[228:231], v[68:71]
  ds_read_b64_tr_b16 a[108:109], v187 offset:36864
  ds_read_b128 a[200:203], v192 offset:0
  v_mfma_f32_16x16x32_bf16 v[64:67], a[176:179], a[228:231], v[64:67]
  ds_read_b64_tr_b16 a[110:111], v187 offset:37376
  ds_read_b128 a[204:207], v193 offset:0
  v_mfma_f32_16x16x32_bf16 v[64:67], a[152:155], a[224:227], v[64:67]
  ds_read_b64_tr_b16 a[112:113], v186 offset:37888
  ds_read_b128 a[208:211], v192 offset:2048
  v_mfma_f32_16x16x32_bf16 v[88:91], a[152:155], a[232:235], v[88:91]
  ds_read_b64_tr_b16 a[114:115], v186 offset:38400
  ds_read_b128 a[212:215], v193 offset:2048
  v_mfma_f32_16x16x32_bf16 v[88:91], a[176:179], a[236:239], v[88:91]
  ds_read_b64_tr_b16 a[116:117], v187 offset:37888
  ds_read_b128 a[216:219], v192 offset:4096
  v_mfma_f32_16x16x32_bf16 v[92:95], a[180:183], a[236:239], v[92:95]
  ds_read_b64_tr_b16 a[118:119], v187 offset:38400
  ds_read_b128 a[220:223], v193 offset:4096
  v_mfma_f32_16x16x32_bf16 v[92:95], a[156:159], a[232:235], v[92:95]
  ds_read_b64_tr_b16 a[120:121], v186 offset:38912
  ds_read_b128 a[224:227], v192 offset:6144
  v_mfma_f32_16x16x32_bf16 v[96:99], a[160:163], a[232:235], v[96:99]
  ds_read_b64_tr_b16 a[122:123], v186 offset:39424
  ds_read_b128 a[228:231], v193 offset:6144
  v_mfma_f32_16x16x32_bf16 v[96:99], a[184:187], a[236:239], v[96:99]
  ds_read_b64_tr_b16 a[124:125], v187 offset:38912
  s_add_u32 s72, s72, s68
  v_mfma_f32_16x16x32_bf16 v[100:103], a[188:191], a[236:239], v[100:103]
  ds_read_b64_tr_b16 a[126:127], v187 offset:39424
  s_mul_i32 s55, s72, 9216
  v_mfma_f32_16x16x32_bf16 v[100:103], a[164:167], a[232:235], v[100:103]
  s_lshl_b32 s72, s72, 7
  v_lshl_add_u32 v214, v216, 10, v214
  v_add_u32 v214, s72, v214
  v_mfma_f32_16x16x32_bf16 v[104:107], a[232:235], a[168:171], v[104:107]
  s_lshr_b32 s72, s68, 1
  s_and_b32 s74, s68, 1
  v_mfma_f32_16x16x32_bf16 v[104:107], a[236:239], a[192:195], v[104:107]
  v_mfma_f32_16x16x32_bf16 v[108:111], a[236:239], a[196:199], v[108:111]
  s_mul_i32 s73, s72, 6
  v_mfma_f32_16x16x32_bf16 v[108:111], a[232:235], a[172:175], v[108:111]
  v_mfma_f32_16x16x32_bf16 v[132:135], a[240:243], a[172:175], v[132:135]
  ds_read_b128 a[232:235], v192 offset:8192
  s_mul_i32 s46, s78, 12
  v_mfma_f32_16x16x32_bf16 v[132:135], a[244:247], a[196:199], v[132:135]
  ds_read_b128 a[236:239], v193 offset:8192
  v_mfma_f32_16x16x32_bf16 v[128:131], a[244:247], a[192:195], v[128:131]
  s_xor_b32 s80, s90, 9
  s_add_u32 s80, s80, 2
  s_mul_i32 s80, s80, 98304
  s_add_u32 m0, s76, 12288
  v_mfma_f32_16x16x32_bf16 v[128:131], a[240:243], a[168:171], v[128:131]
  buffer_load_dwordx4 v176, s[8:11], s80 offen offset:0 lds
  s_add_u32 s46, s46, s73
  v_mfma_f32_16x16x32_bf16 v[124:127], a[164:167], a[240:243], v[124:127]
  s_lshl_b32 s73, s79, 1
  v_mfma_f32_16x16x32_bf16 v[124:127], a[188:191], a[244:247], v[124:127]
  buffer_load_dwordx4 v176, s[8:11], s80 offen offset:1024 lds
  s_add_u32 s73, s73, s74
  v_mfma_f32_16x16x32_bf16 v[120:123], a[184:187], a[244:247], v[120:123]
  v_mfma_f32_16x16x32_bf16 v[120:123], a[160:163], a[240:243], v[120:123]
  s_mul_i32 s85, s46, 72
  v_mfma_f32_16x16x32_bf16 v[116:119], a[156:159], a[240:243], v[116:119]
  buffer_load_dwordx4 v176, s[8:11], s80 offen offset:2048 lds
  s_xor_b32 s92, s91, 640
  v_mfma_f32_16x16x32_bf16 v[116:119], a[180:183], a[244:247], v[116:119]
  s_add_u32 s92, s92, 128
  s_waitcnt vmcnt(14) lgkmcnt(2)
  s_barrier
  v_mfma_f32_16x16x32_bf16 v[112:115], a[176:179], a[244:247], v[112:115]
  s_add_u32 m0, s77, 61440
  ds_read_b64_tr_b16 a[128:129], v186 offset:49152
  ds_read_b64_tr_b16 a[130:131], v186 offset:49664
  v_mfma_f32_16x16x32_bf16 v[112:115], a[152:155], a[240:243], v[112:115]
  buffer_load_dwordx4 v178, s[4:7], s92 offen lds
  ds_read_b64_tr_b16 a[132:133], v187 offset:49152
  v_mfma_f32_16x16x32_bf16 v[136:139], a[152:155], a[248:251], v[136:139]
  ds_read_b64_tr_b16 a[134:135], v187 offset:49664
  ds_read_b64_tr_b16 a[136:137], v186 offset:50176
  v_mfma_f32_16x16x32_bf16 v[136:139], a[176:179], a[252:255], v[136:139]
  s_add_u32 m0, s77, 65536
  ds_read_b64_tr_b16 a[138:139], v186 offset:50688
  ds_read_b128 a[240:243], v192 offset:10240
  v_mfma_f32_16x16x32_bf16 v[140:143], a[180:183], a[252:255], v[140:143]
  buffer_load_dwordx4 v179, s[4:7], s92 offen lds
  ds_read_b64_tr_b16 a[140:141], v187 offset:50176
  v_mfma_f32_16x16x32_bf16 v[140:143], a[156:159], a[248:251], v[140:143]
  ds_read_b64_tr_b16 a[142:143], v187 offset:50688
  ds_read_b64_tr_b16 a[144:145], v186 offset:51200
  v_mfma_f32_16x16x32_bf16 v[144:147], a[160:163], a[248:251], v[144:147]
  s_add_u32 m0, s77, 69632
  ds_read_b64_tr_b16 a[146:147], v186 offset:51712
  ds_read_b64_tr_b16 a[148:149], v187 offset:51200
  v_mfma_f32_16x16x32_bf16 v[144:147], a[184:187], a[252:255], v[144:147]
  buffer_load_dwordx4 v180, s[4:7], s92 offen lds
  ds_read_b64_tr_b16 a[150:151], v187 offset:51712
  v_mfma_f32_16x16x32_bf16 v[148:151], a[188:191], a[252:255], v[148:151]
  ds_read_b128 a[244:247], v193 offset:10240
  s_add_u32 s85, s85, s73
  v_mfma_f32_16x16x32_bf16 v[148:151], a[164:167], a[248:251], v[148:151]
  s_add_u32 m0, s77, 73728
  s_lshr_b32 s73, s73, 2
  s_mul_i32 s72, s73, 5
  v_mfma_f32_16x16x32_bf16 v[152:155], a[248:251], a[168:171], v[152:155]
  buffer_load_dwordx4 v181, s[4:7], s92 offen lds
  s_add_u32 s85, s85, s72
  v_mfma_f32_16x16x32_bf16 v[152:155], a[252:255], a[192:195], v[152:155]
  s_add_u32 s85, s85, 5
  s_lshl_b32 s85, s85, 10
  s_lshl_b32 s73, s73, 7
  v_mfma_f32_16x16x32_bf16 v[156:159], a[252:255], a[196:199], v[156:159]
  v_lshlrev_b32 v210, 20, v208
  v_mfma_f32_16x16x32_bf16 v[156:159], a[248:251], a[172:175], v[156:159]
  s_waitcnt lgkmcnt(1)
  v_add_u32 v210, s73, v210
  v_mfma_f32_16x16x32_bf16 v[0:3], a[112:115], a[200:203], v[0:3]
  s_xor_b32 s92, s91, 640
  s_add_u32 s92, s92, 128
  s_add_u32 m0, s94, 77824
  v_mfma_f32_16x16x32_bf16 v[0:3], a[136:139], a[204:207], v[0:3]
  buffer_load_dwordx4 v182, s[4:7], s92 offen lds
  ds_read_b128 a[248:251], v192 offset:12288
  v_mfma_f32_16x16x32_bf16 v[4:7], a[140:143], a[204:207], v[4:7]
  ds_read_b128 a[252:255], v193 offset:12288
  s_lshl_b32 s46, s46, 10
  v_mfma_f32_16x16x32_bf16 v[4:7], a[116:119], a[200:203], v[4:7]
  v_and_b32 v252, 1, v249
  v_mfma_f32_16x16x32_bf16 v[8:11], a[200:203], a[120:123], v[8:11]
  s_add_u32 m0, s94, 81920
  v_lshlrev_b32 v250, 2, v248
  v_mfma_f32_16x16x32_bf16 v[8:11], a[204:207], a[144:147], v[8:11]
  buffer_load_dwordx4 v183, s[4:7], s92 offen lds
  v_mfma_f32_16x16x32_bf16 v[12:15], a[204:207], a[148:151], v[12:15]
  v_sub_u32 v253, v249, v250
  v_mfma_f32_16x16x32_bf16 v[12:15], a[200:203], a[124:127], v[12:15]
  v_sub_u32 v253, v253, v252
  v_mfma_f32_16x16x32_bf16 v[36:39], a[208:211], a[124:127], v[36:39]
  s_add_u32 m0, s94, 86016
  v_mfma_f32_16x16x32_bf16 v[36:39], a[212:215], a[148:151], v[36:39]
  buffer_load_dwordx4 v184, s[4:7], s92 offen lds
  v_cmp_le_i32 s[36:37], 0, v253
  v_mfma_f32_16x16x32_bf16 v[32:35], a[212:215], a[144:147], v[32:35]
  s_xor_b32 s80, s90, 10
  v_mfma_f32_16x16x32_bf16 v[32:35], a[208:211], a[120:123], v[32:35]
  s_add_u32 s80, s80, 2
  v_cmp_le_i32 s[38:39], 2, v253
  v_mfma_f32_16x16x32_bf16 v[28:31], a[116:119], a[208:211], v[28:31]
  s_mul_i32 s80, s80, 98304
  v_mfma_f32_16x16x32_bf16 v[28:31], a[140:143], a[212:215], v[28:31]
  s_add_u32 m0, s76, 24576
  v_cmp_eq_u32 vcc, 1, v252
  v_mfma_f32_16x16x32_bf16 v[24:27], a[136:139], a[212:215], v[24:27]
  buffer_load_dwordx4 v176, s[8:11], s80 offen offset:0 lds
  v_mov_b32 v254, 0x01000c0c
  v_mfma_f32_16x16x32_bf16 v[24:27], a[112:115], a[208:211], v[24:27]
  v_mfma_f32_16x16x32_bf16 v[20:23], a[108:111], a[208:211], v[20:23]
  v_mov_b32 v255, 0x03020c0c
  v_mfma_f32_16x16x32_bf16 v[20:23], a[132:135], a[212:215], v[20:23]
  v_mfma_f32_16x16x32_bf16 v[16:19], a[128:131], a[212:215], v[16:19]
  buffer_load_dwordx4 v176, s[8:11], s80 offen offset:1024 lds
  v_cndmask_b32 v254, v254, v255, vcc
  v_mfma_f32_16x16x32_bf16 v[16:19], a[104:107], a[208:211], v[16:19]
  v_mfma_f32_16x16x32_bf16 v[40:43], a[104:107], a[216:219], v[40:43]
  v_add_u32 v255, 0x04040000, v254
  v_mfma_f32_16x16x32_bf16 v[40:43], a[128:131], a[220:223], v[40:43]
  v_cndmask_b32 v160, v254, v255, s[36:37]
  v_mfma_f32_16x16x32_bf16 v[44:47], a[132:135], a[220:223], v[44:47]
  buffer_load_dwordx4 v176, s[8:11], s80 offen offset:2048 lds
  v_mfma_f32_16x16x32_bf16 v[44:47], a[108:111], a[216:219], v[44:47]
  s_xor_b32 s80, s90, 11
  v_cndmask_b32 v161, v254, v255, s[38:39]
  v_mfma_f32_16x16x32_bf16 v[48:51], a[112:115], a[216:219], v[48:51]
  s_add_u32 s80, s80, 2
  v_mfma_f32_16x16x32_bf16 v[48:51], a[136:139], a[220:223], v[48:51]
  s_mul_i32 s80, s80, 98304
  v_mov_b32 v246, 0x0c0c0c0c
  v_mfma_f32_16x16x32_bf16 v[52:55], a[140:143], a[220:223], v[52:55]
  s_add_u32 m0, s76, 36864
  v_mfma_f32_16x16x32_bf16 v[52:55], a[116:119], a[216:219], v[52:55]
  buffer_load_dwordx4 v176, s[8:11], s80 offen offset:0 lds
  v_mov_b32 v254, 202113280
  v_mfma_f32_16x16x32_bf16 v[56:59], a[216:219], a[120:123], v[56:59]
  v_mov_b32 v255, 16780300
  v_mfma_f32_16x16x32_bf16 v[56:59], a[220:223], a[144:147], v[56:59]
  v_mfma_f32_16x16x32_bf16 v[60:63], a[220:223], a[148:151], v[60:63]
  v_cndmask_b32 v254, v254, v255, vcc
  v_mfma_f32_16x16x32_bf16 v[60:63], a[216:219], a[124:127], v[60:63]
  buffer_load_dwordx4 v176, s[8:11], s80 offen offset:1024 lds
  v_mfma_f32_16x16x32_bf16 v[84:87], a[224:227], a[124:127], v[84:87]
  v_cndmask_b32 v162, v254, v246, s[36:37]
  v_mfma_f32_16x16x32_bf16 v[84:87], a[228:231], a[148:151], v[84:87]
  v_mfma_f32_16x16x32_bf16 v[80:83], a[228:231], a[144:147], v[80:83]
  v_cndmask_b32 v164, v246, v254, s[36:37]
  v_mfma_f32_16x16x32_bf16 v[80:83], a[224:227], a[120:123], v[80:83]
  v_mov_b32 v254, 202113794
  v_mfma_f32_16x16x32_bf16 v[76:79], a[116:119], a[224:227], v[76:79]
  buffer_load_dwordx4 v176, s[8:11], s80 offen offset:2048 lds
  v_mfma_f32_16x16x32_bf16 v[76:79], a[140:143], a[228:231], v[76:79]
  v_mov_b32 v255, 50465804
  v_mfma_f32_16x16x32_bf16 v[72:75], a[136:139], a[228:231], v[72:75]
  s_waitcnt vmcnt(17) lgkmcnt(0)
  s_barrier
  v_mfma_f32_16x16x32_bf16 v[72:75], a[112:115], a[224:227], v[72:75]
  ds_read_b64_tr_b16 a[152:153], v186 offset:0
  v_cndmask_b32 v254, v254, v255, vcc
  v_mfma_f32_16x16x32_bf16 v[68:71], a[108:111], a[224:227], v[68:71]
  s_xor_b32 s80, s95, 14
  s_mul_i32 s80, s80, 98304
  s_add_u32 m0, s76, 49152
  v_mfma_f32_16x16x32_bf16 v[68:71], a[132:135], a[228:231], v[68:71]
  buffer_load_dwordx4 v176, s[8:11], s80 offen offset:0 lds
  ds_read_b64_tr_b16 a[154:155], v186 offset:512
  v_mfma_f32_16x16x32_bf16 v[64:67], a[128:131], a[228:231], v[64:67]
  ds_read_b64_tr_b16 a[156:157], v187 offset:0
  ds_read_b64_tr_b16 a[158:159], v187 offset:512
  v_mfma_f32_16x16x32_bf16 v[64:67], a[104:107], a[224:227], v[64:67]
  ds_read_b64_tr_b16 a[160:161], v186 offset:1024
  ds_read_b128 a[200:203], v194 offset:0
  v_mfma_f32_16x16x32_bf16 v[88:91], a[104:107], a[232:235], v[88:91]
  buffer_load_dwordx4 v176, s[8:11], s80 offen offset:1024 lds
  ds_read_b64_tr_b16 a[162:163], v186 offset:1536
  v_mfma_f32_16x16x32_bf16 v[88:91], a[128:131], a[236:239], v[88:91]
  ds_read_b64_tr_b16 a[164:165], v187 offset:1024
  ds_read_b128 a[204:207], v195 offset:0
  v_mfma_f32_16x16x32_bf16 v[92:95], a[132:135], a[236:239], v[92:95]
  ds_read_b64_tr_b16 a[166:167], v187 offset:1536
  ds_read_b128 a[208:211], v194 offset:2048
  v_mfma_f32_16x16x32_bf16 v[92:95], a[108:111], a[232:235], v[92:95]
  ds_read_b64_tr_b16 a[168:169], v186 offset:2048
  ds_read_b128 a[212:215], v195 offset:2048
  v_mfma_f32_16x16x32_bf16 v[96:99], a[112:115], a[232:235], v[96:99]
  buffer_load_dwordx4 v176, s[8:11], s80 offen offset:2048 lds
  ds_read_b64_tr_b16 a[170:171], v186 offset:2560
  v_mfma_f32_16x16x32_bf16 v[96:99], a[136:139], a[236:239], v[96:99]
  ds_read_b64_tr_b16 a[172:173], v187 offset:2048
  ds_read_b128 a[216:219], v194 offset:4096
  v_mfma_f32_16x16x32_bf16 v[100:103], a[140:143], a[236:239], v[100:103]
  s_mov_b32 s92, 896
  ds_read_b64_tr_b16 a[174:175], v187 offset:2560
  ds_read_b128 a[220:223], v195 offset:4096
  v_mfma_f32_16x16x32_bf16 v[100:103], a[116:119], a[232:235], v[100:103]
  s_add_u32 m0, s77, 90112
  ds_read_b128 a[224:227], v194 offset:6144
  v_cndmask_b32 v163, v254, v246, s[38:39]
  v_mfma_f32_16x16x32_bf16 v[104:107], a[232:235], a[120:123], v[104:107]
  buffer_load_dwordx4 v178, s[4:7], s92 offen lds
  ds_read_b128 a[228:231], v195 offset:6144
  v_mfma_f32_16x16x32_bf16 v[104:107], a[236:239], a[144:147], v[104:107]
  v_cndmask_b32 v165, v246, v254, s[38:39]
  s_not_b64 s[40:41], s[36:37]
  v_mfma_f32_16x16x32_bf16 v[108:111], a[236:239], a[148:151], v[108:111]
  s_not_b64 s[52:53], s[38:39]
  v_mfma_f32_16x16x32_bf16 v[108:111], a[232:235], a[124:127], v[108:111]
  s_add_u32 m0, s77, 94208
  v_mfma_f32_16x16x32_bf16 v[132:135], a[240:243], a[124:127], v[132:135]
  buffer_load_dwordx4 v179, s[4:7], s92 offen lds
  ds_read_b128 a[232:235], v194 offset:8192
  v_mfma_f32_16x16x32_bf16 v[132:135], a[244:247], a[148:151], v[132:135]
  ds_read_b128 a[236:239], v195 offset:8192
  v_mfma_f32_16x16x32_bf16 v[128:131], a[244:247], a[144:147], v[128:131]
  s_cmp_eq_u32 s46, 0
  s_cselect_b64 s[40:41], s[40:41], 0
  s_cselect_b64 s[52:53], s[52:53], 0
  v_mfma_f32_16x16x32_bf16 v[128:131], a[240:243], a[120:123], v[128:131]
  s_add_u32 m0, s77, 98304
  v_mov_b32 v166, 3480120104
  s_mov_b32 s44, 1052289595
  v_mfma_f32_16x16x32_bf16 v[124:127], a[116:119], a[240:243], v[124:127]
  buffer_load_dwordx4 v180, s[4:7], s92 offen lds
  s_and_b32 s72, s69, 3
  v_mfma_f32_16x16x32_bf16 v[124:127], a[140:143], a[244:247], v[124:127]
  s_lshl_b32 s72, s72, 5
  s_add_u32 s72, s72, s70
  s_mul_i32 s73, s72, 1280
  v_mfma_f32_16x16x32_bf16 v[120:123], a[136:139], a[244:247], v[120:123]
  s_mul_i32 s74, s70, 5120
  s_add_u32 s74, s74, 384
  v_mfma_f32_16x16x32_bf16 v[120:123], a[112:115], a[240:243], v[120:123]
  s_add_u32 m0, s77, 102400
  v_cmp_gt_u32 vcc, 16, v208
  v_mfma_f32_16x16x32_bf16 v[116:119], a[108:111], a[240:243], v[116:119]
  buffer_load_dwordx4 v181, s[4:7], s92 offen lds
  v_mfma_f32_16x16x32_bf16 v[116:119], a[132:135], a[244:247], v[116:119]
  s_waitcnt vmcnt(20) lgkmcnt(5)
  s_barrier
  v_min_u32 v254, 9, v208
  v_mfma_f32_16x16x32_bf16 v[112:115], a[128:131], a[244:247], v[112:115]
  ds_read_b64_tr_b16 a[176:177], v186 offset:12288
  ds_read_b64_tr_b16 a[178:179], v186 offset:12800
  v_mfma_f32_16x16x32_bf16 v[112:115], a[104:107], a[240:243], v[112:115]
  s_add_u32 m0, s94, 106496
  ds_read_b64_tr_b16 a[180:181], v187 offset:12288
  v_mfma_f32_16x16x32_bf16 v[136:139], a[104:107], a[248:251], v[136:139]
  buffer_load_dwordx4 v182, s[4:7], s92 offen lds
  ds_read_b64_tr_b16 a[182:183], v187 offset:12800
  v_mfma_f32_16x16x32_bf16 v[136:139], a[128:131], a[252:255], v[136:139]
  ds_read_b64_tr_b16 a[184:185], v186 offset:13312
  ds_read_b64_tr_b16 a[186:187], v186 offset:13824
  v_mfma_f32_16x16x32_bf16 v[140:143], a[132:135], a[252:255], v[140:143]
  ds_read_b64_tr_b16 a[188:189], v187 offset:13312
  ds_read_b64_tr_b16 a[190:191], v187 offset:13824
  v_mfma_f32_16x16x32_bf16 v[140:143], a[108:111], a[248:251], v[140:143]
  s_add_u32 m0, s94, 110592
  ds_read_b64_tr_b16 a[192:193], v186 offset:14336
  ds_read_b128 a[240:243], v194 offset:10240
  v_mfma_f32_16x16x32_bf16 v[144:147], a[112:115], a[248:251], v[144:147]
  buffer_load_dwordx4 v183, s[4:7], s92 offen lds
  ds_read_b64_tr_b16 a[194:195], v186 offset:14848
  v_mfma_f32_16x16x32_bf16 v[144:147], a[136:139], a[252:255], v[144:147]
  ds_read_b64_tr_b16 a[196:197], v187 offset:14336
  ds_read_b64_tr_b16 a[198:199], v187 offset:14848
  v_mfma_f32_16x16x32_bf16 v[148:151], a[140:143], a[252:255], v[148:151]
  ds_read_b128 a[244:247], v195 offset:10240
  v_lshl_add_u32 v254, v254, 7, s73
  v_mfma_f32_16x16x32_bf16 v[148:151], a[116:119], a[248:251], v[148:151]
  s_add_u32 m0, s94, 114688
  v_min_u32 v237, 20, v208
  v_subrev_u32 v237, 16, v237
  v_mfma_f32_16x16x32_bf16 v[152:155], a[248:251], a[120:123], v[152:155]
  buffer_load_dwordx4 v184, s[4:7], s92 offen lds
  v_lshl_add_u32 v237, v237, 10, s74
  v_mfma_f32_16x16x32_bf16 v[152:155], a[252:255], a[144:147], v[152:155]
  v_cndmask_b32 v254, v237, v254, vcc
  s_lshl_b32 s73, s72, 10
  v_mfma_f32_16x16x32_bf16 v[156:159], a[252:255], a[148:151], v[156:159]
  s_lshl_b32 s74, s70, 12
  v_mfma_f32_16x16x32_bf16 v[156:159], a[248:251], a[124:127], v[156:159]
  s_waitcnt lgkmcnt(1)
  s_add_u32 s74, s74, 384
  v_mfma_f32_16x16x32_bf16 v[0:3], a[160:163], a[200:203], v[0:3]
  ds_read_b128 a[248:251], v194 offset:12288
  v_mfma_f32_16x16x32_bf16 v[0:3], a[184:187], a[204:207], v[0:3]
  ds_read_b128 a[252:255], v195 offset:12288
  v_and_b32 v255, 7, v208
  v_mfma_f32_16x16x32_bf16 v[4:7], a[188:191], a[204:207], v[4:7]
  v_mfma_f32_16x16x32_bf16 v[4:7], a[164:167], a[200:203], v[4:7]
  v_lshl_add_u32 v255, v255, 7, s73
  v_mfma_f32_16x16x32_bf16 v[8:11], a[200:203], a[168:171], v[8:11]
  v_and_b32 v237, 3, v208
  v_mfma_f32_16x16x32_bf16 v[8:11], a[204:207], a[192:195], v[8:11]
  v_mfma_f32_16x16x32_bf16 v[12:15], a[204:207], a[196:199], v[12:15]
  v_lshl_add_u32 v237, v237, 10, s74
  v_mfma_f32_16x16x32_bf16 v[12:15], a[200:203], a[172:175], v[12:15]
  v_mfma_f32_16x16x32_bf16 v[36:39], a[208:211], a[172:175], v[36:39]
  v_cndmask_b32 v255, v237, v255, vcc
  v_mfma_f32_16x16x32_bf16 v[36:39], a[212:215], a[196:199], v[36:39]
  v_mfma_f32_16x16x32_bf16 v[32:35], a[212:215], a[192:195], v[32:35]
  v_mfma_f32_16x16x32_bf16 v[32:35], a[208:211], a[168:171], v[32:35]
  s_xor_b32 s80, s95, 15
  s_mul_i32 s80, s80, 98304
  s_add_u32 m0, s76, 0
  v_mfma_f32_16x16x32_bf16 v[28:31], a[164:167], a[208:211], v[28:31]
  buffer_load_dwordx4 v176, s[8:11], s80 offen offset:0 lds
  v_mfma_f32_16x16x32_bf16 v[28:31], a[188:191], a[212:215], v[28:31]
  v_mfma_f32_16x16x32_bf16 v[24:27], a[184:187], a[212:215], v[24:27]
  v_mfma_f32_16x16x32_bf16 v[24:27], a[160:163], a[208:211], v[24:27]
  v_mfma_f32_16x16x32_bf16 v[20:23], a[156:159], a[208:211], v[20:23]
  buffer_load_dwordx4 v176, s[8:11], s80 offen offset:1024 lds
  v_and_b32 v198, 15, v208
  v_lshrrev_b32 v167, 5, v208
  v_lshlrev_b32 v198, 3, v198
  v_lshl_add_u32 v198, v167, 7, v198
  s_lshr_b32 s75, s46, 3
  v_add_u32 v198, s75, v198
  v_add_u32 v167, 0, v198
  v_min_u32 v167, 16376, v167
  v_mfma_f32_16x16x32_bf16 v[20:23], a[180:183], a[212:215], v[20:23]
  buffer_load_dwordx2 v[188:189], v167, s[32:35], 0 offen sc1
  v_mfma_f32_16x16x32_bf16 v[16:19], a[176:179], a[212:215], v[16:19]
  v_mfma_f32_16x16x32_bf16 v[16:19], a[152:155], a[208:211], v[16:19]
  v_mfma_f32_16x16x32_bf16 v[40:43], a[152:155], a[216:219], v[40:43]
  v_add_u32 v167, 256, v198
  v_mfma_f32_16x16x32_bf16 v[40:43], a[176:179], a[220:223], v[40:43]
  buffer_load_dwordx4 v176, s[8:11], s80 offen offset:2048 lds
  v_min_u32 v167, 16376, v167
  v_mfma_f32_16x16x32_bf16 v[44:47], a[180:183], a[220:223], v[44:47]
  buffer_load_dwordx2 v[196:197], v167, s[32:35], 0 offen sc1
  v_mfma_f32_16x16x32_bf16 v[44:47], a[156:159], a[216:219], v[44:47]
  v_mfma_f32_16x16x32_bf16 v[48:51], a[160:163], a[216:219], v[48:51]
  v_mfma_f32_16x16x32_bf16 v[48:51], a[184:187], a[220:223], v[48:51]
  v_mfma_f32_16x16x32_bf16 v[52:55], a[188:191], a[220:223], v[52:55]
  v_add_u32 v167, 512, v198
  v_mfma_f32_16x16x32_bf16 v[52:55], a[164:167], a[216:219], v[52:55]
  v_min_u32 v167, 16376, v167
  v_mfma_f32_16x16x32_bf16 v[56:59], a[216:219], a[168:171], v[56:59]
  buffer_load_dwordx2 v[222:223], v167, s[32:35], 0 offen sc1
  v_mfma_f32_16x16x32_bf16 v[56:59], a[220:223], a[192:195], v[56:59]
  v_mfma_f32_16x16x32_bf16 v[60:63], a[220:223], a[196:199], v[60:63]
  v_mfma_f32_16x16x32_bf16 v[60:63], a[216:219], a[172:175], v[60:63]
  buffer_load_dword v232, v254, s[24:27], s82 offen
  v_mfma_f32_16x16x32_bf16 v[84:87], a[224:227], a[172:175], v[84:87]
  buffer_load_dword v233, v255, s[20:23], s83 offen
  v_mfma_f32_16x16x32_bf16 v[84:87], a[228:231], a[196:199], v[84:87]
  v_mfma_f32_16x16x32_bf16 v[80:83], a[228:231], a[192:195], v[80:83]
  v_mfma_f32_16x16x32_bf16 v[80:83], a[224:227], a[168:171], v[80:83]
  v_mfma_f32_16x16x32_bf16 v[76:79], a[164:167], a[224:227], v[76:79]
  v_mfma_f32_16x16x32_bf16 v[76:79], a[188:191], a[228:231], v[76:79]
  v_mfma_f32_16x16x32_bf16 v[72:75], a[184:187], a[228:231], v[72:75]
  s_waitcnt vmcnt(18) lgkmcnt(0)
  s_barrier
  v_mfma_f32_16x16x32_bf16 v[72:75], a[160:163], a[224:227], v[72:75]
  v_mfma_f32_16x16x32_bf16 v[68:71], a[156:159], a[224:227], v[68:71]
  ds_read_b64_tr_b16 a[104:105], v186 offset:24576
  ds_read_b64_tr_b16 a[106:107], v186 offset:25088
  v_mfma_f32_16x16x32_bf16 v[68:71], a[180:183], a[228:231], v[68:71]
  ds_read_b64_tr_b16 a[108:109], v187 offset:24576
  ds_read_b64_tr_b16 a[110:111], v187 offset:25088
  v_mfma_f32_16x16x32_bf16 v[64:67], a[176:179], a[228:231], v[64:67]
  ds_read_b64_tr_b16 a[112:113], v186 offset:25600
  v_mfma_f32_16x16x32_bf16 v[64:67], a[152:155], a[224:227], v[64:67]
  ds_read_b64_tr_b16 a[114:115], v186 offset:26112
  ds_read_b64_tr_b16 a[116:117], v187 offset:25600
  v_mfma_f32_16x16x32_bf16 v[88:91], a[152:155], a[232:235], v[88:91]
  ds_read_b64_tr_b16 a[118:119], v187 offset:26112
  v_mfma_f32_16x16x32_bf16 v[88:91], a[176:179], a[236:239], v[88:91]
  ds_read_b64_tr_b16 a[120:121], v186 offset:26624
  ds_read_b64_tr_b16 a[122:123], v186 offset:27136
  v_mfma_f32_16x16x32_bf16 v[92:95], a[180:183], a[236:239], v[92:95]
  ds_read_b64_tr_b16 a[124:125], v187 offset:26624
  ds_read_b64_tr_b16 a[126:127], v187 offset:27136
  v_mfma_f32_16x16x32_bf16 v[92:95], a[156:159], a[232:235], v[92:95]
  ds_read_b64_tr_b16 a[128:129], v186 offset:36864
  v_mfma_f32_16x16x32_bf16 v[96:99], a[160:163], a[232:235], v[96:99]
  ds_read_b64_tr_b16 a[130:131], v186 offset:37376
  ds_read_b64_tr_b16 a[132:133], v187 offset:36864
  v_mfma_f32_16x16x32_bf16 v[96:99], a[184:187], a[236:239], v[96:99]
  ds_read_b64_tr_b16 a[134:135], v187 offset:37376
  v_mfma_f32_16x16x32_bf16 v[100:103], a[188:191], a[236:239], v[100:103]
  ds_read_b64_tr_b16 a[136:137], v186 offset:37888
  ds_read_b64_tr_b16 a[138:139], v186 offset:38400
  v_mfma_f32_16x16x32_bf16 v[100:103], a[164:167], a[232:235], v[100:103]
  ds_read_b64_tr_b16 a[140:141], v187 offset:37888
  ds_read_b64_tr_b16 a[142:143], v187 offset:38400
  v_mfma_f32_16x16x32_bf16 v[104:107], a[232:235], a[168:171], v[104:107]
  ds_read_b64_tr_b16 a[144:145], v186 offset:38912
  v_mfma_f32_16x16x32_bf16 v[104:107], a[236:239], a[192:195], v[104:107]
  ds_read_b64_tr_b16 a[146:147], v186 offset:39424
  ds_read_b64_tr_b16 a[148:149], v187 offset:38912
  v_mfma_f32_16x16x32_bf16 v[108:111], a[236:239], a[196:199], v[108:111]
  ds_read_b64_tr_b16 a[150:151], v187 offset:39424
  v_mfma_f32_16x16x32_bf16 v[108:111], a[232:235], a[172:175], v[108:111]
  v_mfma_f32_16x16x32_bf16 v[132:135], a[240:243], a[172:175], v[132:135]
  v_mfma_f32_16x16x32_bf16 v[132:135], a[244:247], a[196:199], v[132:135]
  v_mfma_f32_16x16x32_bf16 v[128:131], a[244:247], a[192:195], v[128:131]
  s_waitcnt vmcnt(4) lgkmcnt(0)
  s_barrier
  s_waitcnt vmcnt(2)
  v_mfma_f32_16x16x32_bf16 v[128:131], a[240:243], a[168:171], v[128:131]
  ds_read_b64_tr_b16 a[200:201], v186 offset:49152
  ds_read_b64_tr_b16 a[202:203], v186 offset:49664
  v_mfma_f32_16x16x32_bf16 v[124:127], a[164:167], a[240:243], v[124:127]
  ds_read_b64_tr_b16 a[204:205], v187 offset:49152
  v_min_u32 v213, v188, v196
  v_mfma_f32_16x16x32_bf16 v[124:127], a[188:191], a[244:247], v[124:127]
  ds_read_b64_tr_b16 a[206:207], v187 offset:49664
  v_min_u32 v213, v222, v213
  v_mfma_f32_16x16x32_bf16 v[120:123], a[184:187], a[244:247], v[120:123]
  ds_read_b64_tr_b16 a[208:209], v186 offset:50176
  v_mfma_f32_16x16x32_bf16 v[120:123], a[160:163], a[240:243], v[120:123]
  ds_read_b64_tr_b16 a[210:211], v186 offset:50688
  v_mfma_f32_16x16x32_bf16 v[116:119], a[156:159], a[240:243], v[116:119]
  ds_read_b64_tr_b16 a[212:213], v187 offset:50176
  v_mfma_f32_16x16x32_bf16 v[116:119], a[180:183], a[244:247], v[116:119]
  ds_read_b64_tr_b16 a[214:215], v187 offset:50688
  v_mfma_f32_16x16x32_bf16 v[112:115], a[176:179], a[244:247], v[112:115]
  ds_read_b64_tr_b16 a[216:217], v186 offset:51200
  v_mfma_f32_16x16x32_bf16 v[112:115], a[152:155], a[240:243], v[112:115]
  ds_read_b64_tr_b16 a[218:219], v186 offset:51712
  v_mfma_f32_16x16x32_bf16 v[136:139], a[152:155], a[248:251], v[136:139]
  ds_read_b64_tr_b16 a[220:221], v187 offset:51200
  s_add_u32 s81, s82, 0
  v_mfma_f32_16x16x32_bf16 v[136:139], a[176:179], a[252:255], v[136:139]
  ds_read_b64_tr_b16 a[222:223], v187 offset:51712
  s_add_u32 m0, s84, 147456
  v_mfma_f32_16x16x32_bf16 v[140:143], a[180:183], a[252:255], v[140:143]
  ds_read_b128 a[224:227], v190 offset:0
  buffer_load_dwordx4 v212, s[24:27], s81 offen offset:0 lds
  v_mfma_f32_16x16x32_bf16 v[140:143], a[156:159], a[248:251], v[140:143]
  ds_read_b128 a[228:231], v191 offset:0
  v_mfma_f32_16x16x32_bf16 v[144:147], a[160:163], a[248:251], v[144:147]
  ds_read_b128 a[232:235], v190 offset:2048
  v_mfma_f32_16x16x32_bf16 v[144:147], a[184:187], a[252:255], v[144:147]
  ds_read_b128 a[236:239], v191 offset:2048
  v_mfma_f32_16x16x32_bf16 v[148:151], a[188:191], a[252:255], v[148:151]
  v_cmp_eq_u32 vcc, 0, v213
  s_cbranch_vccnz L_gq
L_gq_ret:
  v_mfma_f32_16x16x32_bf16 v[148:151], a[164:167], a[248:251], v[148:151]
  buffer_load_dwordx4 v204, s[24:27], s81 offen offset:1024 lds
  v_mfma_f32_16x16x32_bf16 v[152:155], a[248:251], a[168:171], v[152:155]
  v_mfma_f32_16x16x32_bf16 v[152:155], a[252:255], a[192:195], v[152:155]
  v_mfma_f32_16x16x32_bf16 v[156:159], a[252:255], a[196:199], v[156:159]
  s_waitcnt lgkmcnt(0)
  s_barrier
  v_mfma_f32_16x16x32_bf16 v[156:159], a[248:251], a[172:175], v[156:159]
  buffer_load_dwordx4 v205, s[24:27], s81 offen offset:2048 lds
  v_mfma_f32_16x16x32_bf16 v[0:3], a[112:115], a[224:227], v[0:3]
  ds_read_b128 a[240:243], v190 offset:4096
  v_mfma_f32_16x16x32_bf16 v[0:3], a[136:139], a[228:231], v[0:3]
  ds_read_b64_tr_b16 a[152:153], v186 offset:0
  v_mfma_f32_16x16x32_bf16 v[4:7], a[140:143], a[228:231], v[4:7]
  ds_read_b128 a[244:247], v191 offset:4096
  ds_read_b64_tr_b16 a[154:155], v186 offset:512
  v_mfma_f32_16x16x32_bf16 v[4:7], a[116:119], a[224:227], v[4:7]
  buffer_load_dwordx4 v206, s[24:27], s81 offen offset:3072 lds
  v_mfma_f32_16x16x32_bf16 v[8:11], a[224:227], a[120:123], v[8:11]
  ds_read_b64_tr_b16 a[156:157], v187 offset:0
  v_mfma_f32_16x16x32_bf16 v[8:11], a[228:231], a[144:147], v[8:11]
  ds_read_b64_tr_b16 a[158:159], v187 offset:512
  v_mfma_f32_16x16x32_bf16 v[12:15], a[228:231], a[148:151], v[12:15]
  s_add_u32 s81, s82, 32768
  s_add_u32 m0, s84, 131072
  v_mfma_f32_16x16x32_bf16 v[12:15], a[224:227], a[124:127], v[12:15]
  ds_read_b64_tr_b16 a[160:161], v186 offset:1024
  buffer_load_dwordx4 v212, s[24:27], s81 offen offset:0 lds
  v_mfma_f32_16x16x32_bf16 v[16:19], a[104:107], a[232:235], v[16:19]
  ds_read_b128 a[248:251], v192 offset:0
  ds_read_b64_tr_b16 a[162:163], v186 offset:1536
  v_mfma_f32_16x16x32_bf16 v[16:19], a[128:131], a[236:239], v[16:19]
  v_mfma_f32_16x16x32_bf16 v[20:23], a[132:135], a[236:239], v[20:23]
  ds_read_b128 a[252:255], v193 offset:0
  ds_read_b64_tr_b16 a[164:165], v187 offset:1024
  v_mfma_f32_16x16x32_bf16 v[20:23], a[108:111], a[232:235], v[20:23]
  buffer_load_dwordx4 v204, s[24:27], s81 offen offset:1024 lds
  v_mfma_f32_16x16x32_bf16 v[24:27], a[112:115], a[232:235], v[24:27]
  ds_read_b64_tr_b16 a[166:167], v187 offset:1536
  v_mfma_f32_16x16x32_bf16 v[24:27], a[136:139], a[236:239], v[24:27]
  ds_read_b64_tr_b16 a[168:169], v186 offset:2048
  v_mfma_f32_16x16x32_bf16 v[28:31], a[140:143], a[236:239], v[28:31]
  v_mfma_f32_16x16x32_bf16 v[28:31], a[116:119], a[232:235], v[28:31]
  ds_read_b64_tr_b16 a[170:171], v186 offset:2560
  buffer_load_dwordx4 v205, s[24:27], s81 offen offset:2048 lds
  v_mfma_f32_16x16x32_bf16 v[32:35], a[232:235], a[120:123], v[32:35]
  ds_read_b64_tr_b16 a[172:173], v187 offset:2048
  v_mfma_f32_16x16x32_bf16 v[32:35], a[236:239], a[144:147], v[32:35]
  v_mfma_f32_16x16x32_bf16 v[36:39], a[236:239], a[148:151], v[36:39]
  ds_read_b64_tr_b16 a[174:175], v187 offset:2560
  v_mfma_f32_16x16x32_bf16 v[36:39], a[232:235], a[124:127], v[36:39]
  s_waitcnt lgkmcnt(15)
  s_waitcnt lgkmcnt(13)
  buffer_load_dwordx4 v206, s[24:27], s81 offen offset:3072 lds
  v_mfma_f32_16x16x32_bf16 v[40:43], a[104:107], a[240:243], v[40:43]
  ds_read_b128 a[224:227], v192 offset:2048
  v_mfma_f32_16x16x32_bf16 v[40:43], a[128:131], a[244:247], v[40:43]
  v_mfma_f32_16x16x32_bf16 v[44:47], a[132:135], a[244:247], v[44:47]
  ds_read_b128 a[228:231], v193 offset:2048
  s_add_u32 s81, s82, 65536
  v_mfma_f32_16x16x32_bf16 v[44:47], a[108:111], a[240:243], v[44:47]
  s_add_u32 m0, s84, 16384
  v_mfma_f32_16x16x32_bf16 v[48:51], a[112:115], a[240:243], v[48:51]
  buffer_load_dwordx4 v212, s[24:27], s81 offen offset:0 lds
  v_mfma_f32_16x16x32_bf16 v[48:51], a[136:139], a[244:247], v[48:51]
  v_mfma_f32_16x16x32_bf16 v[52:55], a[140:143], a[244:247], v[52:55]
  v_mfma_f32_16x16x32_bf16 v[52:55], a[116:119], a[240:243], v[52:55]
  v_mfma_f32_16x16x32_bf16 v[56:59], a[240:243], a[120:123], v[56:59]
  buffer_load_dwordx4 v204, s[24:27], s81 offen offset:1024 lds
  v_mfma_f32_16x16x32_bf16 v[56:59], a[244:247], a[144:147], v[56:59]
  v_mfma_f32_16x16x32_bf16 v[60:63], a[244:247], a[148:151], v[60:63]
  v_mfma_f32_16x16x32_bf16 v[60:63], a[240:243], a[124:127], v[60:63]
  s_waitcnt lgkmcnt(10)
  s_waitcnt lgkmcnt(8)
  s_waitcnt lgkmcnt(2)
  v_mfma_f32_16x16x32_bf16 v[0:3], a[208:211], a[248:251], v[0:3]
  ds_read_b128 a[232:235], v192 offset:4096
  buffer_load_dwordx4 v205, s[24:27], s81 offen offset:2048 lds
  v_mfma_f32_16x16x32_bf16 v[0:3], a[160:163], a[252:255], v[0:3]
  v_mfma_f32_16x16x32_bf16 v[4:7], a[164:167], a[252:255], v[4:7]
  ds_read_b128 a[236:239], v193 offset:4096
  v_mfma_f32_16x16x32_bf16 v[4:7], a[212:215], a[248:251], v[4:7]
  v_mfma_f32_16x16x32_bf16 v[8:11], a[248:251], a[216:219], v[8:11]
  buffer_load_dwordx4 v206, s[24:27], s81 offen offset:3072 lds
  v_mfma_f32_16x16x32_bf16 v[8:11], a[252:255], a[168:171], v[8:11]
  v_mfma_f32_16x16x32_bf16 v[12:15], a[252:255], a[172:175], v[12:15]
  v_mfma_f32_16x16x32_bf16 v[12:15], a[248:251], a[220:223], v[12:15]
  s_waitcnt lgkmcnt(3)
  s_waitcnt lgkmcnt(2)
  s_add_u32 s81, s82, 98304
  v_mfma_f32_16x16x32_bf16 v[16:19], a[200:203], a[224:227], v[16:19]
  ds_read_b128 a[240:243], v190 offset:6144
  s_add_u32 m0, s84, 32768
  v_mfma_f32_16x16x32_bf16 v[16:19], a[152:155], a[228:231], v[16:19]
  buffer_load_dwordx4 v212, s[24:27], s81 offen offset:0 lds
  v_mfma_f32_16x16x32_bf16 v[20:23], a[156:159], a[228:231], v[20:23]
  ds_read_b128 a[244:247], v191 offset:6144
  v_mfma_f32_16x16x32_bf16 v[20:23], a[204:207], a[224:227], v[20:23]
  v_mfma_f32_16x16x32_bf16 v[24:27], a[208:211], a[224:227], v[24:27]
  v_mfma_f32_16x16x32_bf16 v[24:27], a[160:163], a[228:231], v[24:27]
  buffer_load_dwordx4 v204, s[24:27], s81 offen offset:1024 lds
  v_mfma_f32_16x16x32_bf16 v[28:31], a[164:167], a[228:231], v[28:31]
  v_mfma_f32_16x16x32_bf16 v[28:31], a[212:215], a[224:227], v[28:31]
  v_mfma_f32_16x16x32_bf16 v[32:35], a[224:227], a[216:219], v[32:35]
  v_mfma_f32_16x16x32_bf16 v[32:35], a[228:231], a[168:171], v[32:35]
  buffer_load_dwordx4 v205, s[24:27], s81 offen offset:2048 lds
  v_mfma_f32_16x16x32_bf16 v[36:39], a[228:231], a[172:175], v[36:39]
  v_mfma_f32_16x16x32_bf16 v[36:39], a[224:227], a[220:223], v[36:39]
  s_waitcnt lgkmcnt(3)
  s_waitcnt lgkmcnt(2)
  v_mfma_f32_16x16x32_bf16 v[40:43], a[200:203], a[232:235], v[40:43]
  ds_read_b128 a[248:251], v190 offset:8192
  v_mfma_f32_16x16x32_bf16 v[40:43], a[152:155], a[236:239], v[40:43]
  buffer_load_dwordx4 v206, s[24:27], s81 offen offset:3072 lds
  v_mfma_f32_16x16x32_bf16 v[44:47], a[156:159], a[236:239], v[44:47]
  ds_read_b128 a[252:255], v191 offset:8192
  v_mfma_f32_16x16x32_bf16 v[44:47], a[204:207], a[232:235], v[44:47]
  v_mfma_f32_16x16x32_bf16 v[48:51], a[208:211], a[232:235], v[48:51]
  v_mfma_f32_16x16x32_bf16 v[48:51], a[160:163], a[236:239], v[48:51]
  v_mfma_f32_16x16x32_bf16 v[52:55], a[164:167], a[236:239], v[52:55]
  v_mfma_f32_16x16x32_bf16 v[52:55], a[212:215], a[232:235], v[52:55]
  v_mfma_f32_16x16x32_bf16 v[56:59], a[232:235], a[216:219], v[56:59]
  v_mfma_f32_16x16x32_bf16 v[56:59], a[236:239], a[168:171], v[56:59]
  v_mfma_f32_16x16x32_bf16 v[60:63], a[236:239], a[172:175], v[60:63]
  s_waitcnt vmcnt(12)
  ds_read_b64_tr_b16 a[0:1], v200 offset:16384
  ds_read_b64_tr_b16 a[2:3], v200 offset:18432
  v_mfma_f32_16x16x32_bf16 v[60:63], a[232:235], a[220:223], v[60:63]
  s_waitcnt lgkmcnt(5)
  s_waitcnt lgkmcnt(4)
  ds_read_b64_tr_b16 a[4:5], v201 offset:16384
  v_mfma_f32_16x16x32_bf16 v[64:67], a[104:107], a[240:243], v[64:67]
  ds_read_b128 a[224:227], v192 offset:6144
  ds_read_b64_tr_b16 a[6:7], v201 offset:18432
  v_mfma_f32_16x16x32_bf16 v[64:67], a[128:131], a[244:247], v[64:67]
  ds_read_b64_tr_b16 a[8:9], v202 offset:16384
  ds_read_b64_tr_b16 a[10:11], v202 offset:18432
  ds_read_b64_tr_b16 a[12:13], v203 offset:16384
  v_cvt_pk_bf16_f32 v0, v0, v1
  v_cvt_pk_bf16_f32 v1, v2, v3
  v_cvt_pk_bf16_f32 v2, v4, v5
  v_cvt_pk_bf16_f32 v3, v6, v7
  v_cvt_pk_bf16_f32 v168, v8, v9
  v_cvt_pk_bf16_f32 v169, v10, v11
  v_cvt_pk_bf16_f32 v240, v12, v13
  v_mfma_f32_16x16x32_bf16 v[68:71], a[132:135], a[244:247], v[68:71]
  ds_read_b128 a[228:231], v193 offset:6144
  ds_read_b64_tr_b16 a[14:15], v203 offset:18432
  v_cvt_pk_bf16_f32 v241, v14, v15
  v_cvt_pk_bf16_f32 v16, v16, v17
  v_cvt_pk_bf16_f32 v17, v18, v19
  v_cvt_pk_bf16_f32 v18, v20, v21
  v_cvt_pk_bf16_f32 v19, v22, v23
  v_cvt_pk_bf16_f32 v20, v24, v25
  v_cvt_pk_bf16_f32 v21, v26, v27
  v_mfma_f32_16x16x32_bf16 v[68:71], a[108:111], a[240:243], v[68:71]
  v_cvt_pk_bf16_f32 v22, v28, v29
  v_cvt_pk_bf16_f32 v23, v30, v31
  v_cvt_pk_bf16_f32 v170, v32, v33
  v_cvt_pk_bf16_f32 v171, v34, v35
  v_cvt_pk_bf16_f32 v242, v36, v37
  v_cvt_pk_bf16_f32 v243, v38, v39
  v_mfma_f32_16x16x32_bf16 v[72:75], a[112:115], a[240:243], v[72:75]
  v_cvt_pk_bf16_f32 v40, v40, v41
  v_cvt_pk_bf16_f32 v41, v42, v43
  v_cvt_pk_bf16_f32 v42, v44, v45
  v_cvt_pk_bf16_f32 v43, v46, v47
  v_cvt_pk_bf16_f32 v44, v48, v49
  v_cvt_pk_bf16_f32 v45, v50, v51
  v_cvt_pk_bf16_f32 v46, v52, v53
  v_mfma_f32_16x16x32_bf16 v[72:75], a[136:139], a[244:247], v[72:75]
  v_cvt_pk_bf16_f32 v47, v54, v55
  v_cvt_pk_bf16_f32 v172, v56, v57
  v_cvt_pk_bf16_f32 v173, v58, v59
  v_cvt_pk_bf16_f32 v244, v60, v61
  v_cvt_pk_bf16_f32 v245, v62, v63
  v_mfma_f32_16x16x16_bf16 v[24:27], v[0:1], v[16:17], 0
  v_mfma_f32_16x16x32_bf16 v[76:79], a[140:143], a[244:247], v[76:79]
  v_mfma_f32_16x16x16_bf16 v[28:31], v[20:21], v[16:17], 0
  v_mfma_f32_16x16x32_bf16 v[76:79], a[116:119], a[240:243], v[76:79]
  s_waitcnt lgkmcnt(0)
  s_add_u32 s81, s82, 131072
  s_add_u32 m0, s84, 147456
  v_mfma_f32_16x16x16_bf16 v[32:35], v[2:3], v[18:19], 0
  v_mfma_f32_16x16x16_bf16 v[36:39], v[22:23], v[18:19], 0
  v_mfma_f32_16x16x32_bf16 v[80:83], a[240:243], a[120:123], v[80:83]
  buffer_load_dwordx4 v212, s[24:27], s81 offen offset:0 lds
  s_waitcnt vmcnt(9)
  ds_read_b64_tr_b16 a[16:17], v200 offset:0
  v_mfma_f32_16x16x16_bf16 v[48:51], v[20:21], v[40:41], 0
  v_mfma_f32_16x16x16_bf16 v[52:55], v[44:45], v[40:41], 0
  v_mfma_f32_16x16x32_bf16 v[80:83], a[244:247], a[144:147], v[80:83]
  ds_read_b64_tr_b16 a[18:19], v200 offset:2048
  ds_read_b64_tr_b16 a[20:21], v201 offset:0
  ds_read_b64_tr_b16 a[22:23], v201 offset:2048
  v_mfma_f32_16x16x16_bf16 v[56:59], v[22:23], v[42:43], 0
  v_mfma_f32_16x16x32_bf16 v[84:87], a[244:247], a[148:151], v[84:87]
  buffer_load_dwordx4 v204, s[24:27], s81 offen offset:1024 lds
  ds_read_b64_tr_b16 a[24:25], v202 offset:0
  ds_read_b64_tr_b16 a[26:27], v202 offset:2048
  v_mfma_f32_16x16x16_bf16 v[60:63], v[46:47], v[42:43], 0
  v_cvt_pk_bf16_f32 v24, v24, v25
  v_cvt_pk_bf16_f32 v25, v26, v27
  v_cvt_pk_bf16_f32 v28, v28, v29
  v_mfma_f32_16x16x32_bf16 v[84:87], a[240:243], a[124:127], v[84:87]
  ds_read_b64_tr_b16 a[28:29], v203 offset:0
  v_cvt_pk_bf16_f32 v29, v30, v31
  v_perm_b32 v26, v28, v24, v160
  v_perm_b32 v27, v29, v25, v161
  v_cndmask_b32 v26, v26, v166, s[40:41]
  v_cndmask_b32 v27, v27, v166, s[52:53]
  v_cvt_pk_bf16_f32 v32, v32, v33
  v_cvt_pk_bf16_f32 v33, v34, v35
  v_mfma_f32_16x16x32_bf16 v[88:91], a[104:107], a[248:251], v[88:91]
  ds_read_b128 a[232:235], v192 offset:8192
  buffer_load_dwordx4 v205, s[24:27], s81 offen offset:2048 lds
  ds_read_b64_tr_b16 a[30:31], v203 offset:2048
  v_cvt_pk_bf16_f32 v36, v36, v37
  v_cvt_pk_bf16_f32 v37, v38, v39
  v_perm_b32 v34, v36, v32, v160
  v_perm_b32 v35, v37, v33, v161
  v_cndmask_b32 v34, v34, v166, s[40:41]
  v_cndmask_b32 v35, v35, v166, s[52:53]
  v_mfma_f32_16x16x32_bf16 v[88:91], a[128:131], a[252:255], v[88:91]
  v_cvt_pk_bf16_f32 v48, v48, v49
  v_cvt_pk_bf16_f32 v49, v50, v51
  v_cvt_pk_bf16_f32 v52, v52, v53
  v_cvt_pk_bf16_f32 v53, v54, v55
  v_perm_b32 v50, v52, v48, v160
  v_perm_b32 v51, v53, v49, v161
  v_cvt_pk_bf16_f32 v56, v56, v57
  v_mfma_f32_16x16x32_bf16 v[92:95], a[132:135], a[252:255], v[92:95]
  ds_read_b128 a[236:239], v193 offset:8192
  buffer_load_dwordx4 v206, s[24:27], s81 offen offset:3072 lds
  v_cvt_pk_bf16_f32 v57, v58, v59
  v_cvt_pk_bf16_f32 v60, v60, v61
  v_cvt_pk_bf16_f32 v61, v62, v63
  v_perm_b32 v58, v60, v56, v160
  v_perm_b32 v59, v61, v57, v161
  v_max_f32 v24, v26, v27
  v_max_f32 v32, v34, v35
  v_mfma_f32_16x16x32_bf16 v[92:95], a[108:111], a[248:251], v[92:95]
  s_waitcnt vmcnt(8)
  ds_read_b64_tr_b16 a[32:33], v217 offset:16384
  ds_read_b64_tr_b16 a[34:35], v217 offset:18432
  v_max_f32 v48, v50, v51
  v_max_f32 v56, v58, v59
  v_permlane16_swap_b32 v24, v32
  s_nop 0
  v_permlane16_swap_b32 v48, v56
  v_mfma_f32_16x16x32_bf16 v[96:99], a[112:115], a[248:251], v[96:99]
  ds_read_b64_tr_b16 a[36:37], v218 offset:16384
  ds_read_b64_tr_b16 a[38:39], v218 offset:18432
  ds_read_b64_tr_b16 a[40:41], v219 offset:16384
  v_max_f32 v24, v24, v32
  v_max_f32 v48, v48, v56
  s_nop 1
  v_permlane32_swap_b32 v24, v48
  v_max_f32 v24, v24, v48
  v_mul_f32 v24, s44, v24
  v_mov_b32 v48, v24
  v_mfma_f32_16x16x32_bf16 v[96:99], a[136:139], a[252:255], v[96:99]
  ds_read_b64_tr_b16 a[42:43], v219 offset:18432
  ds_read_b64_tr_b16 a[44:45], v220 offset:16384
  ds_read_b64_tr_b16 a[46:47], v220 offset:18432
  v_permlane32_swap_b32 v24, v48
  v_mov_b32 v32, v24
  v_mov_b32 v56, v48
  s_nop 0
  v_permlane16_swap_b32 v24, v32
  v_permlane16_swap_b32 v48, v56
  v_mfma_f32_16x16x32_bf16 v[100:103], a[140:143], a[252:255], v[100:103]
  s_waitcnt lgkmcnt(9)
  s_add_u32 s81, s83, 0
  s_add_u32 m0, s84, 131072
  v_fma_f32 v26, v26, s44, -v24
  v_fma_f32 v27, v27, s44, -v24
  v_fma_f32 v34, v34, s44, -v32
  v_fma_f32 v35, v35, s44, -v32
  v_fma_f32 v50, v50, s44, -v48
  v_mfma_f32_16x16x32_bf16 v[100:103], a[116:119], a[248:251], v[100:103]
  buffer_load_dwordx4 v212, s[20:23], s81 offen offset:0 lds
  v_fma_f32 v51, v51, s44, -v48
  v_fma_f32 v58, v58, s44, -v56
  v_fma_f32 v59, v59, s44, -v56
  v_exp_f32 v26, v26
  v_exp_f32 v27, v27
  v_mfma_f32_16x16x32_bf16 v[104:107], a[248:251], a[120:123], v[104:107]
  v_exp_f32 v34, v34
  v_exp_f32 v35, v35
  v_exp_f32 v50, v50
  v_exp_f32 v51, v51
  v_mfma_f32_16x16x32_bf16 v[104:107], a[252:255], a[144:147], v[104:107]
  buffer_load_dwordx4 v204, s[20:23], s81 offen offset:1024 lds
  v_exp_f32 v58, v58
  v_exp_f32 v59, v59
  v_add_f32 v24, v26, v27
  v_mfma_f32_16x16x32_bf16 v[108:111], a[252:255], a[148:151], v[108:111]
  v_add_f32 v32, v34, v35
  v_add_f32 v48, v50, v51
  v_add_f32 v56, v58, v59
  v_permlane16_swap_b32 v24, v32
  s_nop 0
  v_permlane16_swap_b32 v48, v56
  v_mfma_f32_16x16x32_bf16 v[108:111], a[248:251], a[124:127], v[108:111]
  buffer_load_dwordx4 v205, s[20:23], s81 offen offset:2048 lds
  v_add_f32 v24, v24, v32
  v_add_f32 v48, v48, v56
  s_nop 1
  v_permlane32_swap_b32 v24, v48
  v_add_f32 v24, v24, v48
  v_rcp_f32 v24, v24
  v_mfma_f32_16x16x32_bf16 v[64:67], a[200:203], a[224:227], v[64:67]
  ds_read_b128 a[240:243], v190 offset:10240
  s_waitcnt vmcnt(7)
  ds_read_b64_tr_b16 a[48:49], v217 offset:32768
  v_mul_f32 v24, v24, v189
  v_mov_b32 v48, v24
  s_nop 1
  v_permlane32_swap_b32 v24, v48
  v_mov_b32 v32, v24
  v_mov_b32 v56, v48
  v_mfma_f32_16x16x32_bf16 v[64:67], a[152:155], a[228:231], v[64:67]
  buffer_load_dwordx4 v206, s[20:23], s81 offen offset:3072 lds
  ds_read_b64_tr_b16 a[50:51], v217 offset:34816
  ds_read_b64_tr_b16 a[52:53], v218 offset:32768
  v_permlane16_swap_b32 v24, v32
  v_permlane16_swap_b32 v48, v56
  v_mul_f32 v26, v26, v24
  v_mul_f32 v27, v27, v24
  v_mul_f32 v34, v34, v32
  v_mfma_f32_16x16x32_bf16 v[68:71], a[156:159], a[228:231], v[68:71]
  ds_read_b128 a[244:247], v191 offset:10240
  ds_read_b64_tr_b16 a[54:55], v218 offset:34816
  ds_read_b64_tr_b16 a[56:57], v219 offset:32768
  v_mul_f32 v35, v35, v32
  v_mul_f32 v50, v50, v48
  v_mul_f32 v51, v51, v48
  v_mul_f32 v58, v58, v56
  v_mul_f32 v59, v59, v56
  v_cvt_pk_bf16_f32 v24, v26, v27
  v_cvt_pk_bf16_f32 v32, v34, v35
  v_mfma_f32_16x16x32_bf16 v[68:71], a[204:207], a[224:227], v[68:71]
  ds_read_b64_tr_b16 a[58:59], v219 offset:34816
  ds_read_b64_tr_b16 a[60:61], v220 offset:32768
  ds_read_b64_tr_b16 a[62:63], v220 offset:34816
  v_cvt_pk_bf16_f32 v48, v50, v51
  v_cvt_pk_bf16_f32 v56, v58, v59
  v_perm_b32 v28, v24, v24, v162
  v_perm_b32 v29, v24, v24, v163
  v_perm_b32 v30, v24, v24, v164
  v_perm_b32 v31, v24, v24, v165
  v_mfma_f32_16x16x32_bf16 v[72:75], a[208:211], a[224:227], v[72:75]
  s_waitcnt lgkmcnt(10)
  s_add_u32 s81, s83, 32768
  s_add_u32 m0, s84, 16384
  v_perm_b32 v36, v32, v32, v162
  v_perm_b32 v37, v32, v32, v163
  v_perm_b32 v38, v32, v32, v164
  v_perm_b32 v39, v32, v32, v165
  v_perm_b32 v52, v48, v48, v162
  v_perm_b32 v53, v48, v48, v163
  v_perm_b32 v54, v48, v48, v164
  v_mfma_f32_16x16x32_bf16 v[72:75], a[160:163], a[228:231], v[72:75]
  buffer_load_dwordx4 v212, s[20:23], s81 offen offset:0 lds
  v_perm_b32 v55, v48, v48, v165
  v_perm_b32 v60, v56, v56, v162
  v_perm_b32 v61, v56, v56, v163
  v_perm_b32 v62, v56, v56, v164
  v_perm_b32 v63, v56, v56, v165
  v_mfma_f32_16x16x32_bf16 v[24:27], v[168:171], v[28:31], 0
  v_mfma_f32_16x16x32_bf16 v[76:79], a[164:167], a[228:231], v[76:79]
  v_mfma_f32_16x16x32_bf16 v[32:35], v[240:243], v[36:39], 0
  v_mfma_f32_16x16x32_bf16 v[76:79], a[212:215], a[224:227], v[76:79]
  buffer_load_dwordx4 v204, s[20:23], s81 offen offset:1024 lds
  v_mfma_f32_16x16x32_bf16 v[48:51], v[170:173], v[52:55], 0
  v_mfma_f32_16x16x32_bf16 v[56:59], v[242:245], v[60:63], 0
  v_mfma_f32_16x16x32_bf16 v[80:83], a[224:227], a[216:219], v[80:83]
  s_nop 0
  v_cvt_pk_bf16_f32 v16, v24, v25
  v_cvt_pk_bf16_f32 v17, v26, v27
  v_cvt_pk_bf16_f32 v18, v32, v33
  v_cvt_pk_bf16_f32 v19, v34, v35
  s_add_u32 s80, s85, 0
  buffer_store_dwordx4 v[16:19], v209, s[16:19], s80 offen sc1
  v_mfma_f32_16x16x32_bf16 v[80:83], a[228:231], a[168:171], v[80:83]
  buffer_load_dwordx4 v205, s[20:23], s81 offen offset:2048 lds
  v_cvt_pk_bf16_f32 v40, v48, v49
  v_cvt_pk_bf16_f32 v41, v50, v51
  v_cvt_pk_bf16_f32 v42, v56, v57
  v_cvt_pk_bf16_f32 v43, v58, v59
  s_add_u32 s80, s85, 73728
  buffer_store_dwordx4 v[40:43], v209, s[16:19], s80 offen sc1
  v_mfma_f32_16x16x32_bf16 v[84:87], a[228:231], a[172:175], v[84:87]
  v_mfma_f32_16x16x32_bf16 v[84:87], a[224:227], a[220:223], v[84:87]
  v_mfma_f32_16x16x32_bf16 v[88:91], a[200:203], a[232:235], v[88:91]
  ds_read_b128 a[248:251], v190 offset:12288
  buffer_load_dwordx4 v206, s[20:23], s81 offen offset:3072 lds
  v_mfma_f32_16x16x32_bf16 v[88:91], a[152:155], a[236:239], v[88:91]
  v_mfma_f32_16x16x32_bf16 v[92:95], a[156:159], a[236:239], v[92:95]
  ds_read_b128 a[252:255], v191 offset:12288
  v_mfma_f32_16x16x32_bf16 v[92:95], a[204:207], a[232:235], v[92:95]
  s_waitcnt lgkmcnt(2)
  s_add_u32 s81, s83, 65536
  s_add_u32 m0, s84, 32768
  v_mfma_f32_16x16x32_bf16 v[96:99], a[208:211], a[232:235], v[96:99]
  buffer_load_dwordx4 v212, s[20:23], s81 offen offset:0 lds
  v_mfma_f32_16x16x32_bf16 v[96:99], a[160:163], a[236:239], v[96:99]
  v_mfma_f32_16x16x32_bf16 v[100:103], a[164:167], a[236:239], v[100:103]
  v_mfma_f32_16x16x32_bf16 v[100:103], a[212:215], a[232:235], v[100:103]
  v_mfma_f32_16x16x32_bf16 v[104:107], a[232:235], a[216:219], v[104:107]
  buffer_load_dwordx4 v204, s[20:23], s81 offen offset:1024 lds
  v_mfma_f32_16x16x32_bf16 v[104:107], a[236:239], a[168:171], v[104:107]
  v_mfma_f32_16x16x32_bf16 v[108:111], a[236:239], a[172:175], v[108:111]
  v_mfma_f32_16x16x32_bf16 v[108:111], a[232:235], a[220:223], v[108:111]
  v_mfma_f32_16x16x32_bf16 v[112:115], a[104:107], a[240:243], v[112:115]
  ds_read_b128 a[224:227], v192 offset:10240
  v_mov_b32 v182, -1
  v_mfma_f32_16x16x32_bf16 v[112:115], a[128:131], a[244:247], v[112:115]
  v_mov_b32 v183, -1
  buffer_load_dwordx4 v205, s[20:23], s81 offen offset:2048 lds
  v_cvt_pk_bf16_f32 v64, v64, v65
  v_cvt_pk_bf16_f32 v65, v66, v67
  v_cvt_pk_bf16_f32 v66, v68, v69
  v_cvt_pk_bf16_f32 v67, v70, v71
  v_cvt_pk_bf16_f32 v68, v72, v73
  v_cvt_pk_bf16_f32 v69, v74, v75
  v_cvt_pk_bf16_f32 v70, v76, v77
  v_cvt_pk_bf16_f32 v71, v78, v79
  v_cvt_pk_bf16_f32 v174, v80, v81
  v_cvt_pk_bf16_f32 v175, v82, v83
  v_cvt_pk_bf16_f32 v246, v84, v85
  v_cvt_pk_bf16_f32 v247, v86, v87
  v_cvt_pk_bf16_f32 v88, v88, v89
  v_cvt_pk_bf16_f32 v89, v90, v91
  v_cvt_pk_bf16_f32 v90, v92, v93
  v_mfma_f32_16x16x32_bf16 v[116:119], a[132:135], a[244:247], v[116:119]
  ds_read_b128 a[228:231], v193 offset:10240
  v_mov_b32 v184, -1
  buffer_load_dwordx4 v206, s[20:23], s81 offen offset:3072 lds
  v_cvt_pk_bf16_f32 v91, v94, v95
  v_cvt_pk_bf16_f32 v92, v96, v97
  v_cvt_pk_bf16_f32 v93, v98, v99
  v_cvt_pk_bf16_f32 v94, v100, v101
  v_cvt_pk_bf16_f32 v95, v102, v103
  v_cvt_pk_bf16_f32 v176, v104, v105
  v_cvt_pk_bf16_f32 v177, v106, v107
  v_cvt_pk_bf16_f32 v248, v108, v109
  v_cvt_pk_bf16_f32 v249, v110, v111
  v_mfma_f32_16x16x16_bf16 v[72:75], v[44:45], v[64:65], 0
  v_mfma_f32_16x16x16_bf16 v[76:79], v[68:69], v[64:65], 0
  v_mfma_f32_16x16x32_bf16 v[116:119], a[108:111], a[240:243], v[116:119]
  v_mov_b32 v185, -1
  s_waitcnt vmcnt(14)
  ds_read_b64_tr_b16 a[64:65], v200 offset:16384
  v_mfma_f32_16x16x16_bf16 v[80:83], v[46:47], v[66:67], 0
  v_mfma_f32_16x16x16_bf16 v[84:87], v[70:71], v[66:67], 0
  v_mfma_f32_16x16x16_bf16 v[96:99], v[68:69], v[88:89], 0
  v_mfma_f32_16x16x16_bf16 v[100:103], v[92:93], v[88:89], 0
  v_mfma_f32_16x16x32_bf16 v[120:123], a[112:115], a[240:243], v[120:123]
  s_add_u32 s12, s16, 9584640
  s_addc_u32 s13, s17, 0
  ds_read_b64_tr_b16 a[66:67], v200 offset:18432
  ds_read_b64_tr_b16 a[68:69], v201 offset:16384
  v_mfma_f32_16x16x16_bf16 v[104:107], v[70:71], v[90:91], 0
  v_mfma_f32_16x16x16_bf16 v[108:111], v[94:95], v[90:91], 0
  v_cvt_pk_bf16_f32 v72, v72, v73
  v_cvt_pk_bf16_f32 v73, v74, v75
  v_cvt_pk_bf16_f32 v76, v76, v77
  v_cvt_pk_bf16_f32 v77, v78, v79
  v_mfma_f32_16x16x32_bf16 v[120:123], a[136:139], a[244:247], v[120:123]
  s_mov_b32 s14, 2097152
  ds_read_b64_tr_b16 a[70:71], v201 offset:18432
  ds_read_b64_tr_b16 a[72:73], v202 offset:16384
  v_perm_b32 v74, v76, v72, v160
  v_perm_b32 v75, v77, v73, v161
  v_cvt_pk_bf16_f32 v80, v80, v81
  v_cvt_pk_bf16_f32 v81, v82, v83
  v_cvt_pk_bf16_f32 v84, v84, v85
  v_cvt_pk_bf16_f32 v85, v86, v87
  v_perm_b32 v82, v84, v80, v160
  v_perm_b32 v83, v85, v81, v161
  v_cvt_pk_bf16_f32 v96, v96, v97
  v_cvt_pk_bf16_f32 v97, v98, v99
  v_cvt_pk_bf16_f32 v100, v100, v101
  v_cvt_pk_bf16_f32 v101, v102, v103
  v_perm_b32 v98, v100, v96, v160
  v_perm_b32 v99, v101, v97, v161
  v_cvt_pk_bf16_f32 v104, v104, v105
  v_mfma_f32_16x16x32_bf16 v[124:127], a[140:143], a[244:247], v[124:127]
  s_mov_b32 s15, 0x20000
  ds_read_b64_tr_b16 a[74:75], v202 offset:18432
  ds_read_b64_tr_b16 a[76:77], v203 offset:16384
  v_cvt_pk_bf16_f32 v105, v106, v107
  v_cvt_pk_bf16_f32 v108, v108, v109
  v_cvt_pk_bf16_f32 v109, v110, v111
  v_perm_b32 v106, v108, v104, v160
  v_perm_b32 v107, v109, v105, v161
  v_max_f32 v72, v74, v75
  v_max_f32 v80, v82, v83
  v_max_f32 v96, v98, v99
  v_max_f32 v104, v106, v107
  v_permlane16_swap_b32 v72, v80
  s_nop 0
  v_permlane16_swap_b32 v96, v104
  v_max_f32 v72, v72, v80
  v_max_f32 v96, v96, v104
  v_mfma_f32_16x16x32_bf16 v[124:127], a[116:119], a[240:243], v[124:127]
  s_xor_b32 s50, s49, 32768
  ds_read_b64_tr_b16 a[78:79], v203 offset:18432
  v_permlane32_swap_b32 v72, v96
  v_max_f32 v72, v72, v96
  v_mul_f32 v72, s44, v72
  v_mov_b32 v96, v72
  s_nop 1
  v_permlane32_swap_b32 v72, v96
  v_mov_b32 v80, v72
  v_mov_b32 v104, v96
  s_nop 0
  v_permlane16_swap_b32 v72, v80
  v_permlane16_swap_b32 v96, v104
  v_fma_f32 v74, v74, s44, -v72
  v_mfma_f32_16x16x32_bf16 v[128:131], a[240:243], a[120:123], v[128:131]
  buffer_store_dwordx4 v[182:185], v209, s[12:15], s50 offen offset:0 sc1
  s_waitcnt vmcnt(8)
  s_add_u32 s3, s46, 0
  buffer_atomic_add v211, v210, s[60:63], s3 offen sc1
  v_fma_f32 v75, v75, s44, -v72
  v_fma_f32 v82, v82, s44, -v80
  v_fma_f32 v83, v83, s44, -v80
  v_fma_f32 v98, v98, s44, -v96
  v_fma_f32 v99, v99, s44, -v96
  v_fma_f32 v106, v106, s44, -v104
  v_fma_f32 v107, v107, s44, -v104
  v_exp_f32 v74, v74
  v_exp_f32 v75, v75
  v_exp_f32 v82, v82
  v_exp_f32 v83, v83
  v_mfma_f32_16x16x32_bf16 v[128:131], a[244:247], a[144:147], v[128:131]
  buffer_store_dwordx4 v[182:185], v209, s[12:15], s50 offen offset:1024 sc1
  s_waitcnt vmcnt(8)
  s_add_u32 s3, s46, 1024
  buffer_atomic_add v211, v210, s[60:63], s3 offen sc1
  v_exp_f32 v98, v98
  v_exp_f32 v99, v99
  v_exp_f32 v106, v106
  v_exp_f32 v107, v107
  v_add_f32 v72, v74, v75
  v_add_f32 v80, v82, v83
  v_add_f32 v96, v98, v99
  v_add_f32 v104, v106, v107
  v_permlane16_swap_b32 v72, v80
  s_nop 0
  v_permlane16_swap_b32 v96, v104
  v_mfma_f32_16x16x32_bf16 v[132:135], a[244:247], a[148:151], v[132:135]
  s_waitcnt lgkmcnt(0)
  s_add_u32 s81, s83, 98304
  s_add_u32 m0, s84, 147456
  v_add_f32 v72, v72, v80
  v_add_f32 v96, v96, v104
  s_nop 1
  v_permlane32_swap_b32 v72, v96
  v_add_f32 v72, v72, v96
  v_rcp_f32 v72, v72
  s_nop 0
  v_mul_f32 v72, v72, v197
  v_mov_b32 v96, v72
  s_nop 1
  v_permlane32_swap_b32 v72, v96
  v_mov_b32 v80, v72
  v_mov_b32 v104, v96
  s_nop 0
  v_permlane16_swap_b32 v72, v80
  v_mfma_f32_16x16x32_bf16 v[132:135], a[240:243], a[124:127], v[132:135]
  buffer_load_dwordx4 v212, s[20:23], s81 offen offset:0 lds
  v_permlane16_swap_b32 v96, v104
  v_mul_f32 v74, v74, v72
  v_mul_f32 v75, v75, v72
  v_mul_f32 v82, v82, v80
  v_mul_f32 v83, v83, v80
  v_mul_f32 v98, v98, v96
  v_mul_f32 v99, v99, v96
  v_mul_f32 v106, v106, v104
  v_mul_f32 v107, v107, v104
  v_cvt_pk_bf16_f32 v72, v74, v75
  v_cvt_pk_bf16_f32 v80, v82, v83
  v_cvt_pk_bf16_f32 v96, v98, v99
  v_cvt_pk_bf16_f32 v104, v106, v107
  v_mfma_f32_16x16x32_bf16 v[136:139], a[104:107], a[248:251], v[136:139]
  ds_read_b128 a[232:235], v192 offset:12288
  buffer_load_dwordx4 v204, s[20:23], s81 offen offset:1024 lds
  v_perm_b32 v76, v72, v72, v162
  v_perm_b32 v77, v72, v72, v163
  v_perm_b32 v78, v72, v72, v164
  v_perm_b32 v79, v72, v72, v165
  v_perm_b32 v84, v80, v80, v162
  v_perm_b32 v85, v80, v80, v163
  v_perm_b32 v86, v80, v80, v164
  v_perm_b32 v87, v80, v80, v165
  v_perm_b32 v100, v96, v96, v162
  v_perm_b32 v101, v96, v96, v163
  v_perm_b32 v102, v96, v96, v164
  v_perm_b32 v103, v96, v96, v165
  v_perm_b32 v108, v104, v104, v162
  v_perm_b32 v109, v104, v104, v163
  v_perm_b32 v110, v104, v104, v164
  v_mfma_f32_16x16x32_bf16 v[136:139], a[128:131], a[252:255], v[136:139]
  buffer_load_dwordx4 v205, s[20:23], s81 offen offset:2048 lds
  v_perm_b32 v111, v104, v104, v165
  v_mfma_f32_16x16x32_bf16 v[72:75], v[172:175], v[76:79], 0
  v_mfma_f32_16x16x32_bf16 v[80:83], v[244:247], v[84:87], 0
  v_mfma_f32_16x16x32_bf16 v[96:99], v[174:177], v[100:103], 0
  v_mfma_f32_16x16x32_bf16 v[104:107], v[246:249], v[108:111], 0
  v_mfma_f32_16x16x32_bf16 v[140:143], a[132:135], a[252:255], v[140:143]
  ds_read_b128 a[236:239], v193 offset:12288
  buffer_load_dwordx4 v206, s[20:23], s81 offen offset:3072 lds
  s_nop 1
  v_cvt_pk_bf16_f32 v64, v72, v73
  v_cvt_pk_bf16_f32 v65, v74, v75
  v_cvt_pk_bf16_f32 v66, v80, v81
  v_cvt_pk_bf16_f32 v67, v82, v83
  s_add_u32 s80, s85, 147456
  buffer_store_dwordx4 v[64:67], v209, s[16:19], s80 offen sc1
  v_cvt_pk_bf16_f32 v88, v96, v97
  v_cvt_pk_bf16_f32 v89, v98, v99
  v_cvt_pk_bf16_f32 v90, v104, v105
  v_cvt_pk_bf16_f32 v91, v106, v107
  s_add_u32 s80, s85, 221184
  buffer_store_dwordx4 v[88:91], v209, s[16:19], s80 offen sc1
  v_mfma_f32_16x16x32_bf16 v[140:143], a[108:111], a[248:251], v[140:143]
  v_mfma_f32_16x16x32_bf16 v[144:147], a[112:115], a[248:251], v[144:147]
  v_mfma_f32_16x16x32_bf16 v[144:147], a[136:139], a[252:255], v[144:147]
  v_mfma_f32_16x16x32_bf16 v[148:151], a[140:143], a[252:255], v[148:151]
  v_mfma_f32_16x16x32_bf16 v[148:151], a[116:119], a[248:251], v[148:151]
  v_mfma_f32_16x16x32_bf16 v[152:155], a[248:251], a[120:123], v[152:155]
  v_mfma_f32_16x16x32_bf16 v[152:155], a[252:255], a[144:147], v[152:155]
  v_mfma_f32_16x16x32_bf16 v[156:159], a[252:255], a[148:151], v[156:159]
  v_mfma_f32_16x16x32_bf16 v[156:159], a[248:251], a[124:127], v[156:159]
  v_mfma_f32_16x16x32_bf16 v[112:115], a[200:203], a[224:227], v[112:115]
  v_mfma_f32_16x16x32_bf16 v[112:115], a[152:155], a[228:231], v[112:115]
  v_mfma_f32_16x16x32_bf16 v[116:119], a[156:159], a[228:231], v[116:119]
  v_mfma_f32_16x16x32_bf16 v[116:119], a[204:207], a[224:227], v[116:119]
  v_mfma_f32_16x16x32_bf16 v[120:123], a[208:211], a[224:227], v[120:123]
  v_mfma_f32_16x16x32_bf16 v[120:123], a[160:163], a[228:231], v[120:123]
  v_mfma_f32_16x16x32_bf16 v[124:127], a[164:167], a[228:231], v[124:127]
  v_mfma_f32_16x16x32_bf16 v[124:127], a[212:215], a[224:227], v[124:127]
  v_mfma_f32_16x16x32_bf16 v[128:131], a[224:227], a[216:219], v[128:131]
  v_mfma_f32_16x16x32_bf16 v[128:131], a[228:231], a[168:171], v[128:131]
  v_mov_b32 v215, 0
  s_mov_b64 exec, 15
  buffer_atomic_add v215, v214, s[60:63], 0 offen sc0 sc1
  s_mov_b64 exec, -1
  v_mfma_f32_16x16x32_bf16 v[132:135], a[228:231], a[172:175], v[132:135]
  v_mfma_f32_16x16x32_bf16 v[132:135], a[224:227], a[220:223], v[132:135]
  s_waitcnt lgkmcnt(1)
  s_waitcnt lgkmcnt(0)
  v_mfma_f32_16x16x32_bf16 v[136:139], a[200:203], a[232:235], v[136:139]
  v_mfma_f32_16x16x32_bf16 v[136:139], a[152:155], a[236:239], v[136:139]
  s_waitcnt vmcnt(8)
  buffer_atomic_add v211, v221, s[60:63], 0 offen sc1
  v_mfma_f32_16x16x32_bf16 v[140:143], a[156:159], a[236:239], v[140:143]
  v_mfma_f32_16x16x32_bf16 v[140:143], a[204:207], a[232:235], v[140:143]
  v_mfma_f32_16x16x32_bf16 v[144:147], a[208:211], a[232:235], v[144:147]
  v_mfma_f32_16x16x32_bf16 v[144:147], a[160:163], a[236:239], v[144:147]
  v_mfma_f32_16x16x32_bf16 v[148:151], a[164:167], a[236:239], v[148:151]
  v_mfma_f32_16x16x32_bf16 v[148:151], a[212:215], a[232:235], v[148:151]
  v_mfma_f32_16x16x32_bf16 v[152:155], a[232:235], a[216:219], v[152:155]
  v_mfma_f32_16x16x32_bf16 v[152:155], a[236:239], a[168:171], v[152:155]
  v_mfma_f32_16x16x32_bf16 v[156:159], a[236:239], a[172:175], v[156:159]
  v_mfma_f32_16x16x32_bf16 v[156:159], a[232:235], a[220:223], v[156:159]
  v_cvt_pk_bf16_f32 v112, v112, v113
  v_cvt_pk_bf16_f32 v113, v114, v115
  v_cvt_pk_bf16_f32 v114, v116, v117
  v_cvt_pk_bf16_f32 v115, v118, v119
  v_cvt_pk_bf16_f32 v116, v120, v121
  v_cvt_pk_bf16_f32 v117, v122, v123
  v_cvt_pk_bf16_f32 v118, v124, v125
  v_cvt_pk_bf16_f32 v119, v126, v127
  v_cvt_pk_bf16_f32 v178, v128, v129
  v_cvt_pk_bf16_f32 v179, v130, v131
  v_cvt_pk_bf16_f32 v250, v132, v133
  v_cvt_pk_bf16_f32 v251, v134, v135
  v_cvt_pk_bf16_f32 v136, v136, v137
  v_cvt_pk_bf16_f32 v137, v138, v139
  v_cvt_pk_bf16_f32 v138, v140, v141
  v_cvt_pk_bf16_f32 v139, v142, v143
  v_cvt_pk_bf16_f32 v140, v144, v145
  v_cvt_pk_bf16_f32 v141, v146, v147
  v_cvt_pk_bf16_f32 v142, v148, v149
  v_cvt_pk_bf16_f32 v143, v150, v151
  v_cvt_pk_bf16_f32 v180, v152, v153
  v_cvt_pk_bf16_f32 v181, v154, v155
  v_cvt_pk_bf16_f32 v252, v156, v157
  v_cvt_pk_bf16_f32 v253, v158, v159
  v_mfma_f32_16x16x16_bf16 v[120:123], v[92:93], v[112:113], 0
  v_mfma_f32_16x16x16_bf16 v[124:127], v[116:117], v[112:113], 0
  v_mfma_f32_16x16x16_bf16 v[128:131], v[94:95], v[114:115], 0
  v_mfma_f32_16x16x16_bf16 v[132:135], v[118:119], v[114:115], 0
  v_mfma_f32_16x16x16_bf16 v[144:147], v[116:117], v[136:137], 0
  v_mfma_f32_16x16x16_bf16 v[148:151], v[140:141], v[136:137], 0
  v_mfma_f32_16x16x16_bf16 v[152:155], v[118:119], v[138:139], 0
  v_mfma_f32_16x16x16_bf16 v[156:159], v[142:143], v[138:139], 0
  s_nop 0
  v_cvt_pk_bf16_f32 v120, v120, v121
  v_cvt_pk_bf16_f32 v121, v122, v123
  v_cvt_pk_bf16_f32 v124, v124, v125
  v_cvt_pk_bf16_f32 v125, v126, v127
  v_perm_b32 v122, v124, v120, v160
  v_perm_b32 v123, v125, v121, v161
  v_cvt_pk_bf16_f32 v128, v128, v129
  v_cvt_pk_bf16_f32 v129, v130, v131
  v_cvt_pk_bf16_f32 v132, v132, v133
  v_cvt_pk_bf16_f32 v133, v134, v135
  v_perm_b32 v130, v132, v128, v160
  v_perm_b32 v131, v133, v129, v161
  v_cvt_pk_bf16_f32 v144, v144, v145
  v_cvt_pk_bf16_f32 v145, v146, v147
  v_cvt_pk_bf16_f32 v148, v148, v149
  v_cvt_pk_bf16_f32 v149, v150, v151
  v_perm_b32 v146, v148, v144, v160
  v_perm_b32 v147, v149, v145, v161
  v_cvt_pk_bf16_f32 v152, v152, v153
  v_cvt_pk_bf16_f32 v153, v154, v155
  v_cvt_pk_bf16_f32 v156, v156, v157
  v_cvt_pk_bf16_f32 v157, v158, v159
  v_perm_b32 v154, v156, v152, v160
  v_perm_b32 v155, v157, v153, v161
  v_max_f32 v120, v122, v123
  v_max_f32 v128, v130, v131
  v_max_f32 v144, v146, v147
  v_max_f32 v152, v154, v155
  v_permlane16_swap_b32 v120, v128
  s_nop 0
  v_permlane16_swap_b32 v144, v152
  s_waitcnt vmcnt(3)
  s_add_u32 s3, s46, 2048
  buffer_atomic_add v211, v210, s[60:63], s3 offen sc1
  v_max_f32 v120, v120, v128
  s_waitcnt vmcnt(3)
  s_add_u32 s3, s46, 3072
  buffer_atomic_add v211, v210, s[60:63], s3 offen sc1
  v_max_f32 v144, v144, v152
  s_nop 1
  v_permlane32_swap_b32 v120, v144
  v_max_f32 v120, v120, v144
  v_mul_f32 v120, s44, v120
  v_mov_b32 v144, v120
  s_nop 1
  v_permlane32_swap_b32 v120, v144
  v_mov_b32 v128, v120
  v_mov_b32 v152, v144
  s_nop 0
  v_permlane16_swap_b32 v120, v128
  v_permlane16_swap_b32 v144, v152
  v_fma_f32 v122, v122, s44, -v120
  v_fma_f32 v123, v123, s44, -v120
  v_fma_f32 v130, v130, s44, -v128
  v_fma_f32 v131, v131, s44, -v128
  v_fma_f32 v146, v146, s44, -v144
  v_fma_f32 v147, v147, s44, -v144
  v_fma_f32 v154, v154, s44, -v152
  s_waitcnt vmcnt(3)
  v_cmp_gt_u32 vcc, v207, v215
  s_and_b32 s54, vcc_lo, 0xff
  s_and_b32 s51, s54, 3
  s_cselect_b32 s51, 1073741824, 0
  v_fma_f32 v155, v155, s44, -v152
  v_readlane_b32 s56, v216, 0
  s_mul_i32 s56, s56, 73728
  v_exp_f32 v122, v122
  s_add_u32 s56, s56, s55
  s_add_u32 s56, s56, s51
  v_exp_f32 v123, v123
  v_readlane_b32 s57, v216, 1
  s_mul_i32 s57, s57, 73728
  v_exp_f32 v130, v130
  s_add_u32 s57, s57, s55
  s_add_u32 s57, s57, s51
  v_exp_f32 v131, v131
  s_add_u32 s47, s56, 0
  v_exp_f32 v146, v146
  buffer_load_dwordx4 v[0:3], v209, s[16:19], s47 offen offset:0 sc1
  v_exp_f32 v147, v147
  v_exp_f32 v154, v154
  v_exp_f32 v155, v155
  v_add_f32 v120, v122, v123
  v_add_f32 v128, v130, v131
  v_add_f32 v144, v146, v147
  buffer_load_dwordx4 v[4:7], v209, s[16:19], s47 offen offset:1024 sc1
  v_add_f32 v152, v154, v155
  v_permlane16_swap_b32 v120, v128
  s_nop 0
  v_permlane16_swap_b32 v144, v152
  v_add_f32 v120, v120, v128
  v_add_f32 v144, v144, v152
  s_nop 1
  v_permlane32_swap_b32 v120, v144
  buffer_load_dwordx4 v[8:11], v209, s[16:19], s47 offen offset:2048 sc1
  v_add_f32 v120, v120, v144
  v_rcp_f32 v120, v120
  s_nop 0
  v_mul_f32 v120, v120, v223
  v_mov_b32 v144, v120
  s_nop 1
  v_permlane32_swap_b32 v120, v144
  v_mov_b32 v128, v120
  buffer_load_dwordx4 v[12:15], v209, s[16:19], s47 offen offset:3072 sc1
  v_mov_b32 v152, v144
  v_permlane16_swap_b32 v120, v128
  s_nop 0
  v_permlane16_swap_b32 v144, v152
  v_mul_f32 v122, v122, v120
  v_mul_f32 v123, v123, v120
  s_add_u32 s47, s56, 4096
  v_mul_f32 v130, v130, v128
  buffer_load_dwordx4 v[16:19], v209, s[16:19], s47 offen offset:0 sc1
  v_mul_f32 v131, v131, v128
  v_mul_f32 v146, v146, v144
  v_mul_f32 v147, v147, v144
  v_mul_f32 v154, v154, v152
  v_mul_f32 v155, v155, v152
  v_cvt_pk_bf16_f32 v120, v122, v123
  buffer_load_dwordx4 v[20:23], v209, s[16:19], s47 offen offset:1024 sc1
  v_cvt_pk_bf16_f32 v128, v130, v131
  v_cvt_pk_bf16_f32 v144, v146, v147
  v_cvt_pk_bf16_f32 v152, v154, v155
  v_perm_b32 v124, v120, v120, v162
  v_perm_b32 v125, v120, v120, v163
  v_perm_b32 v126, v120, v120, v164
  buffer_load_dwordx4 v[24:27], v209, s[16:19], s47 offen offset:2048 sc1
  v_perm_b32 v127, v120, v120, v165
  v_perm_b32 v132, v128, v128, v162
  v_perm_b32 v133, v128, v128, v163
  v_perm_b32 v134, v128, v128, v164
  v_perm_b32 v135, v128, v128, v165
  v_perm_b32 v148, v144, v144, v162
  buffer_load_dwordx4 v[28:31], v209, s[16:19], s47 offen offset:3072 sc1
  v_perm_b32 v149, v144, v144, v163
  v_perm_b32 v150, v144, v144, v164
  v_perm_b32 v151, v144, v144, v165
  v_perm_b32 v156, v152, v152, v162
  v_perm_b32 v157, v152, v152, v163
  s_add_u32 s47, s56, 8192
  v_perm_b32 v158, v152, v152, v164
  buffer_load_dwordx4 v[32:35], v209, s[16:19], s47 offen offset:0 sc1
  v_perm_b32 v159, v152, v152, v165
  v_mfma_f32_16x16x32_bf16 v[120:123], v[176:179], v[124:127], 0
  v_mfma_f32_16x16x32_bf16 v[128:131], v[248:251], v[132:135], 0
  v_mfma_f32_16x16x32_bf16 v[144:147], v[178:181], v[148:151], 0
  v_mfma_f32_16x16x32_bf16 v[152:155], v[250:253], v[156:159], 0
  s_add_u32 s47, s57, 0
  s_nop 3
  v_cvt_pk_bf16_f32 v112, v120, v121
  buffer_load_dwordx4 v[36:39], v209, s[16:19], s47 offen offset:0 sc1
  v_cvt_pk_bf16_f32 v113, v122, v123
  v_cvt_pk_bf16_f32 v114, v128, v129
  v_cvt_pk_bf16_f32 v115, v130, v131
  s_add_u32 s80, s85, 294912
  buffer_store_dwordx4 v[112:115], v209, s[16:19], s80 offen sc1
  v_cvt_pk_bf16_f32 v136, v144, v145
  buffer_load_dwordx4 v[40:43], v209, s[16:19], s47 offen offset:1024 sc1
  v_cvt_pk_bf16_f32 v137, v146, v147
  s_and_b32 s74, s54, 15
  s_cselect_b32 s74, 0, 1073741824
  v_mov_b32 v215, 0
  s_mov_b64 exec, 15
  buffer_atomic_add v215, v214, s[60:63], s74 offen sc0 sc1
  s_mov_b64 exec, -1
  v_cvt_pk_bf16_f32 v138, v152, v153
  v_cvt_pk_bf16_f32 v139, v154, v155
  s_add_u32 s80, s85, 368640
  buffer_store_dwordx4 v[136:139], v209, s[16:19], s80 offen sc1
  s_cmp_lg_u32 s51, 0
  s_cbranch_scc1 L_thiq
L_thiq_ret:
  s_waitcnt vmcnt(13)
  v_mfma_f32_16x16x32_bf16 v[80:83], a[0:3], v[0:3], 0
  v_mfma_f32_16x16x32_bf16 v[84:87], a[4:7], v[0:3], 0
  ds_read_b64_tr_b16 a[80:81], v200 offset:0
  v_mfma_f32_16x16x32_bf16 v[88:91], a[8:11], v[0:3], 0
  ds_read_b64_tr_b16 a[82:83], v200 offset:2048
  ds_read_b64_tr_b16 a[84:85], v201 offset:0
  v_mfma_f32_16x16x32_bf16 v[92:95], a[12:15], v[0:3], 0
  s_waitcnt vmcnt(12)
  ds_read_b64_tr_b16 a[86:87], v201 offset:2048
  ds_read_b64_tr_b16 a[88:89], v202 offset:0
  v_mfma_f32_16x16x32_bf16 v[80:83], a[16:19], v[4:7], v[80:83]
  buffer_load_dwordx4 v[0:3], v209, s[16:19], s47 offen offset:2048 sc1
  ds_read_b64_tr_b16 a[90:91], v202 offset:2048
  ds_read_b64_tr_b16 a[92:93], v203 offset:0
  v_mfma_f32_16x16x32_bf16 v[84:87], a[20:23], v[4:7], v[84:87]
  ds_read_b64_tr_b16 a[94:95], v203 offset:2048
  v_mfma_f32_16x16x32_bf16 v[88:91], a[24:27], v[4:7], v[88:91]
  ds_read_b64_tr_b16 a[96:97], v217 offset:16384
  v_mfma_f32_16x16x32_bf16 v[92:95], a[28:31], v[4:7], v[92:95]
  s_waitcnt vmcnt(12)
  ds_read_b64_tr_b16 a[98:99], v217 offset:18432
  ds_read_b64_tr_b16 a[100:101], v218 offset:16384
  v_mfma_f32_16x16x32_bf16 v[80:83], a[32:35], v[8:11], v[80:83]
  buffer_load_dwordx4 v[4:7], v209, s[16:19], s47 offen offset:3072 sc1
  ds_read_b64_tr_b16 a[102:103], v218 offset:18432
  ds_read_b64_tr_b16 a[104:105], v219 offset:16384
  v_mfma_f32_16x16x32_bf16 v[84:87], a[36:39], v[8:11], v[84:87]
  ds_read_b64_tr_b16 a[106:107], v219 offset:18432
  ds_read_b64_tr_b16 a[108:109], v220 offset:16384
  v_mfma_f32_16x16x32_bf16 v[88:91], a[40:43], v[8:11], v[88:91]
  ds_read_b64_tr_b16 a[110:111], v220 offset:18432
  v_mfma_f32_16x16x32_bf16 v[92:95], a[44:47], v[8:11], v[92:95]
  s_waitcnt vmcnt(12)
  s_add_u32 s47, s57, 4096
  ds_read_b64_tr_b16 a[112:113], v217 offset:32768
  v_mfma_f32_16x16x32_bf16 v[80:83], a[48:51], v[12:15], v[80:83]
  buffer_load_dwordx4 v[8:11], v209, s[16:19], s47 offen offset:0 sc1
  ds_read_b64_tr_b16 a[114:115], v217 offset:34816
  ds_read_b64_tr_b16 a[116:117], v218 offset:32768
  v_mfma_f32_16x16x32_bf16 v[84:87], a[52:55], v[12:15], v[84:87]
  ds_read_b64_tr_b16 a[118:119], v218 offset:34816
  ds_read_b64_tr_b16 a[120:121], v219 offset:32768
  v_mfma_f32_16x16x32_bf16 v[88:91], a[56:59], v[12:15], v[88:91]
  ds_read_b64_tr_b16 a[122:123], v219 offset:34816
  ds_read_b64_tr_b16 a[124:125], v220 offset:32768
  v_mfma_f32_16x16x32_bf16 v[92:95], a[60:63], v[12:15], v[92:95]
  s_waitcnt vmcnt(12)
  ds_read_b64_tr_b16 a[126:127], v220 offset:34816
  v_mfma_f32_16x16x32_bf16 v[80:83], a[64:67], v[16:19], v[80:83]
  buffer_load_dwordx4 v[12:15], v209, s[16:19], s47 offen offset:1024 sc1
  ds_read_b64_tr_b16 v[224:225], v200 offset:16384
  v_mfma_f32_16x16x32_bf16 v[84:87], a[68:71], v[16:19], v[84:87]
  ds_read_b64_tr_b16 v[226:227], v200 offset:18432
  ds_read_b64_tr_b16 v[228:229], v201 offset:16384
  v_mfma_f32_16x16x32_bf16 v[88:91], a[72:75], v[16:19], v[88:91]
  ds_read_b64_tr_b16 v[230:231], v201 offset:18432
  ds_read_b64_tr_b16 v[232:233], v202 offset:16384
  v_mfma_f32_16x16x32_bf16 v[92:95], a[76:79], v[16:19], v[92:95]
  s_waitcnt lgkmcnt(15)
  s_waitcnt vmcnt(12)
  ds_read_b64_tr_b16 v[234:235], v202 offset:18432
  ds_read_b64_tr_b16 v[236:237], v203 offset:16384
  v_mfma_f32_16x16x32_bf16 v[80:83], a[80:83], v[20:23], v[80:83]
  buffer_load_dwordx4 v[16:19], v209, s[16:19], s47 offen offset:2048 sc1
  ds_read_b64_tr_b16 v[238:239], v203 offset:18432
  v_and_b32 v160, 15, v208
  v_mfma_f32_16x16x32_bf16 v[84:87], a[84:87], v[20:23], v[84:87]
  v_lshrrev_b32 v161, 4, v208
  v_mfma_f32_16x16x32_bf16 v[88:91], a[88:91], v[20:23], v[88:91]
  v_and_b32 v162, 7, v208
  v_mfma_f32_16x16x32_bf16 v[92:95], a[92:95], v[20:23], v[92:95]
  s_waitcnt lgkmcnt(15)
  s_waitcnt vmcnt(12)
  v_xor_b32 v161, v162, v161
  v_mfma_f32_16x16x32_bf16 v[80:83], a[96:99], v[24:27], v[80:83]
  buffer_load_dwordx4 v[20:23], v209, s[16:19], s47 offen offset:3072 sc1
  v_lshlrev_b32 v161, 4, v161
  v_mfma_f32_16x16x32_bf16 v[84:87], a[100:103], v[24:27], v[84:87]
  v_lshl_add_u32 v161, v160, 8, v161
  v_mfma_f32_16x16x32_bf16 v[88:91], a[104:107], v[24:27], v[88:91]
  v_add_u32 v152, s84, v161
  v_mfma_f32_16x16x32_bf16 v[92:95], a[108:111], v[24:27], v[92:95]
  s_waitcnt lgkmcnt(8)
  s_waitcnt vmcnt(12)
  s_add_u32 s47, s57, 8192
  v_xor_b32 v153, 64, v152
  v_mfma_f32_16x16x32_bf16 v[80:83], a[112:115], v[28:31], v[80:83]
  buffer_load_dwordx4 v[24:27], v209, s[16:19], s47 offen offset:0 sc1
  v_xor_b32 v154, 128, v152
  v_mfma_f32_16x16x32_bf16 v[84:87], a[116:119], v[28:31], v[84:87]
  s_waitcnt vmcnt(8)
  v_cmp_gt_u32 vcc, v207, v215
  s_and_b32 s54, s54, vcc_lo
  s_and_b32 s73, s54, 12
  s_cbranch_scc1 L_ckq1
L_ckq1_ret:
  v_readlane_b32 s56, v216, 2
  v_xor_b32 v155, 192, v152
  v_mfma_f32_16x16x32_bf16 v[88:91], a[120:123], v[28:31], v[88:91]
  s_mul_i32 s56, s56, 73728
  s_add_u32 s56, s56, s55
  v_lshrrev_b32 v161, 3, v208
  v_mfma_f32_16x16x32_bf16 v[92:95], a[124:127], v[28:31], v[92:95]
  s_waitcnt lgkmcnt(0)
  s_add_u32 s47, s56, 0
  v_lshlrev_b32 v156, 1, v162
  v_mfma_f32_16x16x32_bf16 v[80:83], v[224:227], v[32:35], v[80:83]
  buffer_load_dwordx4 v[28:31], v209, s[16:19], s47 offen offset:0 sc1
  v_xor_b32 v156, v156, v161
  v_mfma_f32_16x16x32_bf16 v[84:87], v[228:231], v[32:35], v[84:87]
  v_lshlrev_b32 v156, 4, v156
  v_mfma_f32_16x16x32_bf16 v[88:91], v[232:235], v[32:35], v[88:91]
  v_lshl_add_u32 v156, v161, 8, v156
  v_mfma_f32_16x16x32_bf16 v[92:95], v[236:239], v[32:35], v[92:95]
  v_lshlrev_b32 v158, 4, v162
  v_mfma_f32_16x16x32_bf16 v[96:99], a[0:3], v[36:39], 0
  buffer_load_dwordx4 v[32:35], v209, s[16:19], s47 offen offset:1024 sc1
  v_lshl_add_u32 v158, v161, 10, v158
  v_mfma_f32_16x16x32_bf16 v[100:103], a[4:7], v[36:39], 0
  v_add_u32 v158, s71, v158
  v_mfma_f32_16x16x32_bf16 v[104:107], a[8:11], v[36:39], 0
  v_mfma_f32_16x16x32_bf16 v[108:111], a[12:15], v[36:39], 0
  v_mfma_f32_16x16x32_bf16 v[96:99], a[16:19], v[40:43], v[96:99]
  buffer_load_dwordx4 v[36:39], v209, s[16:19], s47 offen offset:2048 sc1
  v_mfma_f32_16x16x32_bf16 v[100:103], a[20:23], v[40:43], v[100:103]
  ds_write_b128 v152, v[80:83] offset:16384
  v_mfma_f32_16x16x32_bf16 v[104:107], a[24:27], v[40:43], v[104:107]
  ds_write_b128 v153, v[84:87] offset:16384
  v_mfma_f32_16x16x32_bf16 v[108:111], a[28:31], v[40:43], v[108:111]
  s_waitcnt vmcnt(9)
  ds_write_b128 v154, v[88:91] offset:16384
  v_mfma_f32_16x16x32_bf16 v[96:99], a[32:35], v[0:3], v[96:99]
  buffer_load_dwordx4 v[40:43], v209, s[16:19], s47 offen offset:3072 sc1
  ds_write_b128 v155, v[92:95] offset:16384
  v_mfma_f32_16x16x32_bf16 v[100:103], a[36:39], v[0:3], v[100:103]
  v_mfma_f32_16x16x32_bf16 v[104:107], a[40:43], v[0:3], v[104:107]
  v_mfma_f32_16x16x32_bf16 v[108:111], a[44:47], v[0:3], v[108:111]
  s_waitcnt vmcnt(9)
  s_add_u32 s47, s56, 4096
  v_mfma_f32_16x16x32_bf16 v[96:99], a[48:51], v[4:7], v[96:99]
  buffer_load_dwordx4 v[0:3], v209, s[16:19], s47 offen offset:0 sc1
  v_mfma_f32_16x16x32_bf16 v[100:103], a[52:55], v[4:7], v[100:103]
  v_mfma_f32_16x16x32_bf16 v[104:107], a[56:59], v[4:7], v[104:107]
  v_mfma_f32_16x16x32_bf16 v[108:111], a[60:63], v[4:7], v[108:111]
  s_waitcnt vmcnt(9)
  v_mfma_f32_16x16x32_bf16 v[96:99], a[64:67], v[8:11], v[96:99]
  buffer_load_dwordx4 v[4:7], v209, s[16:19], s47 offen offset:1024 sc1
  v_mfma_f32_16x16x32_bf16 v[100:103], a[68:71], v[8:11], v[100:103]
  v_mfma_f32_16x16x32_bf16 v[104:107], a[72:75], v[8:11], v[104:107]
  v_mfma_f32_16x16x32_bf16 v[108:111], a[76:79], v[8:11], v[108:111]
  s_waitcnt vmcnt(9)
  v_mfma_f32_16x16x32_bf16 v[96:99], a[80:83], v[12:15], v[96:99]
  s_add_u32 s3, s46, 4096
  buffer_atomic_add v211, v210, s[60:63], s3 offen sc1
  buffer_load_dwordx4 v[8:11], v209, s[16:19], s47 offen offset:2048 sc1
  v_mfma_f32_16x16x32_bf16 v[100:103], a[84:87], v[12:15], v[100:103]
  v_mfma_f32_16x16x32_bf16 v[104:107], a[88:91], v[12:15], v[104:107]
  s_add_u32 s3, s46, 5120
  buffer_atomic_add v211, v210, s[60:63], s3 offen sc1
  v_mfma_f32_16x16x32_bf16 v[108:111], a[92:95], v[12:15], v[108:111]
  s_waitcnt vmcnt(11)
  v_mfma_f32_16x16x32_bf16 v[96:99], a[96:99], v[16:19], v[96:99]
  buffer_load_dwordx4 v[12:15], v209, s[16:19], s47 offen offset:3072 sc1
  v_mfma_f32_16x16x32_bf16 v[100:103], a[100:103], v[16:19], v[100:103]
  s_and_b32 s74, s54, 48
  s_cselect_b32 s74, 0, 1073741824
  v_mov_b32 v172, 0
  s_mov_b64 exec, 48
  buffer_atomic_add v172, v214, s[60:63], s74 offen sc0 sc1
  s_mov_b64 exec, -1
  v_mfma_f32_16x16x32_bf16 v[104:107], a[104:107], v[16:19], v[104:107]
  v_mfma_f32_16x16x32_bf16 v[108:111], a[108:111], v[16:19], v[108:111]
  s_waitcnt vmcnt(12)
  s_add_u32 s47, s56, 8192
  v_mfma_f32_16x16x32_bf16 v[96:99], a[112:115], v[20:23], v[96:99]
  buffer_load_dwordx4 v[16:19], v209, s[16:19], s47 offen offset:0 sc1
  v_mfma_f32_16x16x32_bf16 v[100:103], a[116:119], v[20:23], v[100:103]
  v_readlane_b32 s57, v216, 3
  v_mfma_f32_16x16x32_bf16 v[104:107], a[120:123], v[20:23], v[104:107]
  s_mul_i32 s57, s57, 73728
  s_add_u32 s57, s57, s55
  v_mfma_f32_16x16x32_bf16 v[108:111], a[124:127], v[20:23], v[108:111]
  s_waitcnt vmcnt(12)
  s_add_u32 s47, s57, 0
  v_mfma_f32_16x16x32_bf16 v[96:99], v[224:227], v[24:27], v[96:99]
  buffer_load_dwordx4 v[20:23], v209, s[16:19], s47 offen offset:0 sc1
  v_mfma_f32_16x16x32_bf16 v[100:103], v[228:231], v[24:27], v[100:103]
  v_mfma_f32_16x16x32_bf16 v[104:107], v[232:235], v[24:27], v[104:107]
  v_mfma_f32_16x16x32_bf16 v[108:111], v[236:239], v[24:27], v[108:111]
  s_waitcnt vmcnt(12)
  v_mfma_f32_16x16x32_bf16 v[80:83], a[0:3], v[28:31], 0
  buffer_load_dwordx4 v[24:27], v209, s[16:19], s47 offen offset:1024 sc1
  v_mfma_f32_16x16x32_bf16 v[84:87], a[4:7], v[28:31], 0
  v_mfma_f32_16x16x32_bf16 v[88:91], a[8:11], v[28:31], 0
  v_mfma_f32_16x16x32_bf16 v[92:95], a[12:15], v[28:31], 0
  s_waitcnt vmcnt(12)
  v_mfma_f32_16x16x32_bf16 v[80:83], a[16:19], v[32:35], v[80:83]
  buffer_load_dwordx4 v[28:31], v209, s[16:19], s47 offen offset:2048 sc1
  v_mfma_f32_16x16x32_bf16 v[84:87], a[20:23], v[32:35], v[84:87]
  ds_write_b128 v152, v[96:99] offset:32768
  v_mfma_f32_16x16x32_bf16 v[88:91], a[24:27], v[32:35], v[88:91]
  ds_write_b128 v153, v[100:103] offset:32768
  v_mfma_f32_16x16x32_bf16 v[92:95], a[28:31], v[32:35], v[92:95]
  s_waitcnt vmcnt(12)
  ds_write_b128 v154, v[104:107] offset:32768
  v_mfma_f32_16x16x32_bf16 v[80:83], a[32:35], v[36:39], v[80:83]
  buffer_load_dwordx4 v[32:35], v209, s[16:19], s47 offen offset:3072 sc1
  ds_write_b128 v155, v[108:111] offset:32768
  v_mfma_f32_16x16x32_bf16 v[84:87], a[36:39], v[36:39], v[84:87]
  v_mfma_f32_16x16x32_bf16 v[88:91], a[40:43], v[36:39], v[88:91]
  v_mfma_f32_16x16x32_bf16 v[92:95], a[44:47], v[36:39], v[92:95]
  s_waitcnt vmcnt(12)
  s_add_u32 s47, s57, 4096
  v_mfma_f32_16x16x32_bf16 v[80:83], a[48:51], v[40:43], v[80:83]
  buffer_load_dwordx4 v[36:39], v209, s[16:19], s47 offen offset:0 sc1
  v_mfma_f32_16x16x32_bf16 v[84:87], a[52:55], v[40:43], v[84:87]
  v_mfma_f32_16x16x32_bf16 v[88:91], a[56:59], v[40:43], v[88:91]
  v_mfma_f32_16x16x32_bf16 v[92:95], a[60:63], v[40:43], v[92:95]
  s_waitcnt vmcnt(12)
  v_mfma_f32_16x16x32_bf16 v[80:83], a[64:67], v[0:3], v[80:83]
  buffer_load_dwordx4 v[40:43], v209, s[16:19], s47 offen offset:1024 sc1
  v_mfma_f32_16x16x32_bf16 v[84:87], a[68:71], v[0:3], v[84:87]
  v_mfma_f32_16x16x32_bf16 v[88:91], a[72:75], v[0:3], v[88:91]
  v_mfma_f32_16x16x32_bf16 v[92:95], a[76:79], v[0:3], v[92:95]
  s_waitcnt vmcnt(12)
  v_mfma_f32_16x16x32_bf16 v[80:83], a[80:83], v[4:7], v[80:83]
  buffer_load_dwordx4 v[0:3], v209, s[16:19], s47 offen offset:2048 sc1
  v_mfma_f32_16x16x32_bf16 v[84:87], a[84:87], v[4:7], v[84:87]
  v_mfma_f32_16x16x32_bf16 v[88:91], a[88:91], v[4:7], v[88:91]
  v_mfma_f32_16x16x32_bf16 v[92:95], a[92:95], v[4:7], v[92:95]
  s_waitcnt vmcnt(11)
  v_mfma_f32_16x16x32_bf16 v[80:83], a[96:99], v[8:11], v[80:83]
  buffer_load_dwordx4 v[4:7], v209, s[16:19], s47 offen offset:3072 sc1
  v_mfma_f32_16x16x32_bf16 v[84:87], a[100:103], v[8:11], v[84:87]
  v_mfma_f32_16x16x32_bf16 v[88:91], a[104:107], v[8:11], v[88:91]
  v_mfma_f32_16x16x32_bf16 v[92:95], a[108:111], v[8:11], v[92:95]
  s_waitcnt vmcnt(10)
  s_add_u32 s47, s57, 8192
  v_mfma_f32_16x16x32_bf16 v[80:83], a[112:115], v[12:15], v[80:83]
  buffer_load_dwordx4 v[8:11], v209, s[16:19], s47 offen offset:0 sc1
  s_mov_b32 s75, 16384
  v_mfma_f32_16x16x32_bf16 v[84:87], a[116:119], v[12:15], v[84:87]
  s_waitcnt vmcnt(10)
  v_cmp_gt_u32 vcc, v207, v172
  s_and_b32 s54, s54, vcc_lo
  s_and_b32 s73, s54, 48
  s_cbranch_scc1 L_ckq2
L_ckq2_ret:
  v_readlane_b32 s56, v216, 4
  v_mfma_f32_16x16x32_bf16 v[88:91], a[120:123], v[12:15], v[88:91]
  s_mul_i32 s56, s56, 73728
  s_add_u32 s56, s56, s55
  s_cmp_eq_u32 s68, 1
  s_cselect_b32 s75, 32768, s75
  v_mfma_f32_16x16x32_bf16 v[92:95], a[124:127], v[12:15], v[92:95]
  s_waitcnt vmcnt(9)
  s_add_u32 s47, s56, 0
  v_mfma_f32_16x16x32_bf16 v[80:83], v[224:227], v[16:19], v[80:83]
  buffer_load_dwordx4 v[12:15], v209, s[16:19], s47 offen offset:0 sc1
  s_cmp_eq_u32 s68, 2
  s_cselect_b32 s75, 131072, s75
  v_mfma_f32_16x16x32_bf16 v[84:87], v[228:231], v[16:19], v[84:87]
  v_mfma_f32_16x16x32_bf16 v[88:91], v[232:235], v[16:19], v[88:91]
  s_cmp_eq_u32 s68, 3
  s_cselect_b32 s75, 147456, s75
  v_mfma_f32_16x16x32_bf16 v[92:95], v[236:239], v[16:19], v[92:95]
  s_waitcnt vmcnt(9)
  v_mfma_f32_16x16x32_bf16 v[96:99], a[0:3], v[20:23], 0
  buffer_load_dwordx4 v[16:19], v209, s[16:19], s47 offen offset:1024 sc1
  v_add_u32 v160, s75, v156
  v_mfma_f32_16x16x32_bf16 v[100:103], a[4:7], v[20:23], 0
  v_mfma_f32_16x16x32_bf16 v[104:107], a[8:11], v[20:23], 0
  v_xor_b32 v161, 16, v160
  v_mfma_f32_16x16x32_bf16 v[108:111], a[12:15], v[20:23], 0
  s_waitcnt vmcnt(9)
  v_mfma_f32_16x16x32_bf16 v[96:99], a[16:19], v[24:27], v[96:99]
  buffer_load_dwordx4 v[20:23], v209, s[16:19], s47 offen offset:2048 sc1
  v_mfma_f32_16x16x32_bf16 v[100:103], a[20:23], v[24:27], v[100:103]
  v_add_u32 v152, 131072, v152
  v_mfma_f32_16x16x32_bf16 v[104:107], a[24:27], v[24:27], v[104:107]
  ds_write_b128 v152, v[80:83] offset:0
  v_mfma_f32_16x16x32_bf16 v[108:111], a[28:31], v[24:27], v[108:111]
  s_waitcnt vmcnt(9)
  v_add_u32 v153, 131072, v153
  v_mfma_f32_16x16x32_bf16 v[96:99], a[32:35], v[28:31], v[96:99]
  buffer_load_dwordx4 v[24:27], v209, s[16:19], s47 offen offset:3072 sc1
  ds_write_b128 v153, v[84:87] offset:0
  v_mfma_f32_16x16x32_bf16 v[100:103], a[36:39], v[28:31], v[100:103]
  v_add_u32 v154, 131072, v154
  v_mfma_f32_16x16x32_bf16 v[104:107], a[40:43], v[28:31], v[104:107]
  ds_write_b128 v154, v[88:91] offset:0
  v_mfma_f32_16x16x32_bf16 v[108:111], a[44:47], v[28:31], v[108:111]
  s_waitcnt vmcnt(9)
  s_add_u32 s47, s56, 4096
  v_add_u32 v155, 131072, v155
  v_mfma_f32_16x16x32_bf16 v[96:99], a[48:51], v[32:35], v[96:99]
  buffer_load_dwordx4 v[28:31], v209, s[16:19], s47 offen offset:0 sc1
  ds_write_b128 v155, v[92:95] offset:0
  v_mfma_f32_16x16x32_bf16 v[100:103], a[52:55], v[32:35], v[100:103]
  v_mfma_f32_16x16x32_bf16 v[104:107], a[56:59], v[32:35], v[104:107]
  v_mfma_f32_16x16x32_bf16 v[108:111], a[60:63], v[32:35], v[108:111]
  s_waitcnt vmcnt(9)
  v_mfma_f32_16x16x32_bf16 v[96:99], a[64:67], v[36:39], v[96:99]
  buffer_load_dwordx4 v[32:35], v209, s[16:19], s47 offen offset:1024 sc1
  v_mfma_f32_16x16x32_bf16 v[100:103], a[68:71], v[36:39], v[100:103]
  v_mfma_f32_16x16x32_bf16 v[104:107], a[72:75], v[36:39], v[104:107]
  v_mfma_f32_16x16x32_bf16 v[108:111], a[76:79], v[36:39], v[108:111]
  s_waitcnt vmcnt(9)
  v_mfma_f32_16x16x32_bf16 v[96:99], a[80:83], v[40:43], v[96:99]
  buffer_load_dwordx4 v[36:39], v209, s[16:19], s47 offen offset:2048 sc1
  v_mfma_f32_16x16x32_bf16 v[100:103], a[84:87], v[40:43], v[100:103]
  v_mfma_f32_16x16x32_bf16 v[104:107], a[88:91], v[40:43], v[104:107]
  v_mfma_f32_16x16x32_bf16 v[108:111], a[92:95], v[40:43], v[108:111]
  s_waitcnt vmcnt(9)
  v_mfma_f32_16x16x32_bf16 v[96:99], a[96:99], v[0:3], v[96:99]
  buffer_load_dwordx4 v[40:43], v209, s[16:19], s47 offen offset:3072 sc1
  v_mfma_f32_16x16x32_bf16 v[100:103], a[100:103], v[0:3], v[100:103]
  s_and_b32 s74, s54, 192
  s_cselect_b32 s74, 0, 1073741824
  v_mov_b32 v173, 0
  s_mov_b64 exec, 192
  buffer_atomic_add v173, v214, s[60:63], s74 offen sc0 sc1
  s_mov_b64 exec, -1
  v_mfma_f32_16x16x32_bf16 v[104:107], a[104:107], v[0:3], v[104:107]
  v_mfma_f32_16x16x32_bf16 v[108:111], a[108:111], v[0:3], v[108:111]
  s_waitcnt vmcnt(10)
  s_add_u32 s47, s56, 8192
  v_mfma_f32_16x16x32_bf16 v[96:99], a[112:115], v[4:7], v[96:99]
  buffer_load_dwordx4 v[0:3], v209, s[16:19], s47 offen offset:0 sc1
  v_mfma_f32_16x16x32_bf16 v[100:103], a[116:119], v[4:7], v[100:103]
  v_readlane_b32 s57, v216, 5
  v_mfma_f32_16x16x32_bf16 v[104:107], a[120:123], v[4:7], v[104:107]
  s_mul_i32 s57, s57, 73728
  s_add_u32 s57, s57, s55
  v_mfma_f32_16x16x32_bf16 v[108:111], a[124:127], v[4:7], v[108:111]
  s_waitcnt vmcnt(10)
  s_add_u32 s47, s57, 0
  v_mfma_f32_16x16x32_bf16 v[96:99], v[224:227], v[8:11], v[96:99]
  buffer_load_dwordx4 v[4:7], v209, s[16:19], s47 offen offset:0 sc1
  v_mfma_f32_16x16x32_bf16 v[100:103], v[228:231], v[8:11], v[100:103]
  v_mfma_f32_16x16x32_bf16 v[104:107], v[232:235], v[8:11], v[104:107]
  v_mfma_f32_16x16x32_bf16 v[108:111], v[236:239], v[8:11], v[108:111]
  s_waitcnt vmcnt(10)
  v_mfma_f32_16x16x32_bf16 v[80:83], a[0:3], v[12:15], 0
  buffer_load_dwordx4 v[8:11], v209, s[16:19], s47 offen offset:1024 sc1
  v_mfma_f32_16x16x32_bf16 v[84:87], a[4:7], v[12:15], 0
  v_mfma_f32_16x16x32_bf16 v[88:91], a[8:11], v[12:15], 0
  v_mfma_f32_16x16x32_bf16 v[92:95], a[12:15], v[12:15], 0
  s_waitcnt vmcnt(10)
  v_mfma_f32_16x16x32_bf16 v[80:83], a[16:19], v[16:19], v[80:83]
  buffer_load_dwordx4 v[12:15], v209, s[16:19], s47 offen offset:2048 sc1
  v_mfma_f32_16x16x32_bf16 v[84:87], a[20:23], v[16:19], v[84:87]
  ds_write_b128 v152, v[96:99] offset:16384
  v_mfma_f32_16x16x32_bf16 v[88:91], a[24:27], v[16:19], v[88:91]
  ds_write_b128 v153, v[100:103] offset:16384
  v_mfma_f32_16x16x32_bf16 v[92:95], a[28:31], v[16:19], v[92:95]
  s_waitcnt vmcnt(10)
  ds_write_b128 v154, v[104:107] offset:16384
  v_mfma_f32_16x16x32_bf16 v[80:83], a[32:35], v[20:23], v[80:83]
  buffer_load_dwordx4 v[16:19], v209, s[16:19], s47 offen offset:3072 sc1
  ds_write_b128 v155, v[108:111] offset:16384
  v_mfma_f32_16x16x32_bf16 v[84:87], a[36:39], v[20:23], v[84:87]
  v_mfma_f32_16x16x32_bf16 v[88:91], a[40:43], v[20:23], v[88:91]
  v_mfma_f32_16x16x32_bf16 v[92:95], a[44:47], v[20:23], v[92:95]
  s_waitcnt vmcnt(10)
  s_add_u32 s47, s57, 4096
  v_mfma_f32_16x16x32_bf16 v[80:83], a[48:51], v[24:27], v[80:83]
  buffer_load_dwordx4 v[20:23], v209, s[16:19], s47 offen offset:0 sc1
  v_mfma_f32_16x16x32_bf16 v[84:87], a[52:55], v[24:27], v[84:87]
  s_waitcnt lgkmcnt(0)
  s_barrier
  v_mfma_f32_16x16x32_bf16 v[88:91], a[56:59], v[24:27], v[88:91]
  ds_read_b128 v[176:179], v160 offset:0
  v_mfma_f32_16x16x32_bf16 v[92:95], a[60:63], v[24:27], v[92:95]
  s_waitcnt vmcnt(10)
  ds_read_b128 v[180:183], v161 offset:0
  v_mfma_f32_16x16x32_bf16 v[80:83], a[64:67], v[28:31], v[80:83]
  buffer_load_dwordx4 v[24:27], v209, s[16:19], s47 offen offset:1024 sc1
  ds_read_b128 v[184:187], v160 offset:4096
  v_mfma_f32_16x16x32_bf16 v[84:87], a[68:71], v[28:31], v[84:87]
  ds_read_b128 v[188:191], v161 offset:4096
  v_mfma_f32_16x16x32_bf16 v[88:91], a[72:75], v[28:31], v[88:91]
  ds_read_b128 v[240:243], v160 offset:8192
  v_mfma_f32_16x16x32_bf16 v[92:95], a[76:79], v[28:31], v[92:95]
  s_waitcnt vmcnt(10)
  ds_read_b128 v[244:247], v161 offset:8192
  v_mfma_f32_16x16x32_bf16 v[80:83], a[80:83], v[32:35], v[80:83]
  buffer_load_dwordx4 v[28:31], v209, s[16:19], s47 offen offset:2048 sc1
  ds_read_b128 v[248:251], v160 offset:12288
  v_mfma_f32_16x16x32_bf16 v[84:87], a[84:87], v[32:35], v[84:87]
  ds_read_b128 v[252:255], v161 offset:12288
  v_mfma_f32_16x16x32_bf16 v[88:91], a[88:91], v[32:35], v[88:91]
  v_mfma_f32_16x16x32_bf16 v[92:95], a[92:95], v[32:35], v[92:95]
  s_waitcnt vmcnt(10)
  v_mfma_f32_16x16x32_bf16 v[80:83], a[96:99], v[36:39], v[80:83]
  buffer_load_dwordx4 v[32:35], v209, s[16:19], s47 offen offset:3072 sc1
  v_mfma_f32_16x16x32_bf16 v[84:87], a[100:103], v[36:39], v[84:87]
  v_mfma_f32_16x16x32_bf16 v[88:91], a[104:107], v[36:39], v[88:91]
  s_waitcnt lgkmcnt(0)
  v_add_f32 v176, v176, v184
  v_mfma_f32_16x16x32_bf16 v[92:95], a[108:111], v[36:39], v[92:95]
  s_waitcnt vmcnt(10)
  s_add_u32 s47, s57, 8192
  v_add_f32 v177, v177, v185
  v_mfma_f32_16x16x32_bf16 v[80:83], a[112:115], v[40:43], v[80:83]
  buffer_load_dwordx4 v[36:39], v209, s[16:19], s47 offen offset:0 sc1
  v_add_f32 v178, v178, v186
  v_mfma_f32_16x16x32_bf16 v[84:87], a[116:119], v[40:43], v[84:87]
  s_waitcnt vmcnt(10)
  v_cmp_gt_u32 vcc, v207, v173
  s_and_b32 s54, s54, vcc_lo
  s_and_b32 s73, s54, 192
  s_cbranch_scc1 L_ckq3
L_ckq3_ret:
  v_readlane_b32 s56, v216, 6
  v_add_f32 v179, v179, v187
  v_add_f32 v180, v180, v188
  v_mfma_f32_16x16x32_bf16 v[88:91], a[120:123], v[40:43], v[88:91]
  s_mul_i32 s56, s56, 73728
  s_add_u32 s56, s56, s55
  v_add_f32 v181, v181, v189
  v_mfma_f32_16x16x32_bf16 v[92:95], a[124:127], v[40:43], v[92:95]
  s_waitcnt vmcnt(9)
  s_add_u32 s47, s56, 0
  v_add_f32 v182, v182, v190
  v_mfma_f32_16x16x32_bf16 v[80:83], v[224:227], v[0:3], v[80:83]
  buffer_load_dwordx4 v[40:43], v209, s[16:19], s47 offen offset:0 sc1
  v_add_f32 v183, v183, v191
  v_add_f32 v240, v240, v248
  v_mfma_f32_16x16x32_bf16 v[84:87], v[228:231], v[0:3], v[84:87]
  v_add_f32 v241, v241, v249
  v_mfma_f32_16x16x32_bf16 v[88:91], v[232:235], v[0:3], v[88:91]
  v_add_f32 v242, v242, v250
  v_mfma_f32_16x16x32_bf16 v[92:95], v[236:239], v[0:3], v[92:95]
  s_waitcnt vmcnt(9)
  v_add_f32 v243, v243, v251
  v_add_f32 v244, v244, v252
  v_mfma_f32_16x16x32_bf16 v[96:99], a[0:3], v[4:7], 0
  buffer_load_dwordx4 v[0:3], v209, s[16:19], s47 offen offset:1024 sc1
  v_add_f32 v245, v245, v253
  v_mfma_f32_16x16x32_bf16 v[100:103], a[4:7], v[4:7], 0
  v_add_f32 v246, v246, v254
  v_mfma_f32_16x16x32_bf16 v[104:107], a[8:11], v[4:7], 0
  v_add_f32 v247, v247, v255
  v_add_f32 v176, v176, v240
  v_mfma_f32_16x16x32_bf16 v[108:111], a[12:15], v[4:7], 0
  s_waitcnt vmcnt(9)
  v_add_f32 v177, v177, v241
  v_mfma_f32_16x16x32_bf16 v[96:99], a[16:19], v[8:11], v[96:99]
  buffer_load_dwordx4 v[4:7], v209, s[16:19], s47 offen offset:2048 sc1
  v_add_f32 v178, v178, v242
  v_mfma_f32_16x16x32_bf16 v[100:103], a[20:23], v[8:11], v[100:103]
  v_add_u32 v152, 4294836224, v152
  v_add_f32 v179, v179, v243
  v_add_f32 v180, v180, v244
  v_mfma_f32_16x16x32_bf16 v[104:107], a[24:27], v[8:11], v[104:107]
  ds_write_b128 v152, v[80:83] offset:0
  v_add_f32 v181, v181, v245
  v_mfma_f32_16x16x32_bf16 v[108:111], a[28:31], v[8:11], v[108:111]
  s_waitcnt vmcnt(9)
  v_add_u32 v153, 4294836224, v153
  v_add_f32 v182, v182, v246
  v_mfma_f32_16x16x32_bf16 v[96:99], a[32:35], v[12:15], v[96:99]
  buffer_load_dwordx4 v[8:11], v209, s[16:19], s47 offen offset:3072 sc1
  ds_write_b128 v153, v[84:87] offset:0
  v_add_f32 v183, v183, v247
  v_cvt_pk_bf16_f32 v164, v176, v177
  v_mfma_f32_16x16x32_bf16 v[100:103], a[36:39], v[12:15], v[100:103]
  v_add_u32 v154, 4294836224, v154
  v_cvt_pk_bf16_f32 v165, v178, v179
  v_mfma_f32_16x16x32_bf16 v[104:107], a[40:43], v[12:15], v[104:107]
  ds_write_b128 v154, v[88:91] offset:0
  v_cvt_pk_bf16_f32 v166, v180, v181
  v_mfma_f32_16x16x32_bf16 v[108:111], a[44:47], v[12:15], v[108:111]
  s_waitcnt vmcnt(9)
  s_add_u32 s47, s56, 4096
  v_add_u32 v155, 4294836224, v155
  v_cvt_pk_bf16_f32 v167, v182, v183
  v_min_u32 v164, -2, v164
  v_mfma_f32_16x16x32_bf16 v[96:99], a[48:51], v[16:19], v[96:99]
  buffer_load_dwordx4 v[12:15], v209, s[16:19], s47 offen offset:0 sc1
  ds_write_b128 v155, v[92:95] offset:0
  v_min_u32 v165, -2, v165
  v_mfma_f32_16x16x32_bf16 v[100:103], a[52:55], v[16:19], v[100:103]
  v_min_u32 v166, -2, v166
  v_mfma_f32_16x16x32_bf16 v[104:107], a[56:59], v[16:19], v[104:107]
  v_min_u32 v167, -2, v167
  buffer_store_dwordx4 v[164:167], v209, s[12:15], s50 offen offset:0 sc1
  v_mfma_f32_16x16x32_bf16 v[108:111], a[60:63], v[16:19], v[108:111]
  s_waitcnt vmcnt(10)
  v_mfma_f32_16x16x32_bf16 v[96:99], a[64:67], v[20:23], v[96:99]
  buffer_load_dwordx4 v[16:19], v209, s[16:19], s47 offen offset:1024 sc1
  v_mfma_f32_16x16x32_bf16 v[100:103], a[68:71], v[20:23], v[100:103]
  ds_read_b128 v[176:179], v160 offset:2048
  v_mfma_f32_16x16x32_bf16 v[104:107], a[72:75], v[20:23], v[104:107]
  ds_read_b128 v[180:183], v161 offset:2048
  v_mfma_f32_16x16x32_bf16 v[108:111], a[76:79], v[20:23], v[108:111]
  s_waitcnt vmcnt(10)
  ds_read_b128 v[184:187], v160 offset:6144
  v_mfma_f32_16x16x32_bf16 v[96:99], a[80:83], v[24:27], v[96:99]
  buffer_load_dwordx4 v[20:23], v209, s[16:19], s47 offen offset:2048 sc1
  ds_read_b128 v[188:191], v161 offset:6144
  v_mfma_f32_16x16x32_bf16 v[100:103], a[84:87], v[24:27], v[100:103]
  ds_read_b128 v[240:243], v160 offset:10240
  v_mfma_f32_16x16x32_bf16 v[104:107], a[88:91], v[24:27], v[104:107]
  ds_read_b128 v[244:247], v161 offset:10240
  v_mfma_f32_16x16x32_bf16 v[108:111], a[92:95], v[24:27], v[108:111]
  s_waitcnt vmcnt(10)
  ds_read_b128 v[248:251], v160 offset:14336
  v_mfma_f32_16x16x32_bf16 v[96:99], a[96:99], v[28:31], v[96:99]
  buffer_load_dwordx4 v[24:27], v209, s[16:19], s47 offen offset:3072 sc1
  ds_read_b128 v[252:255], v161 offset:14336
  v_mfma_f32_16x16x32_bf16 v[100:103], a[100:103], v[28:31], v[100:103]
  v_mfma_f32_16x16x32_bf16 v[104:107], a[104:107], v[28:31], v[104:107]
  v_mfma_f32_16x16x32_bf16 v[108:111], a[108:111], v[28:31], v[108:111]
  s_waitcnt vmcnt(10)
  s_add_u32 s47, s56, 8192
  v_mfma_f32_16x16x32_bf16 v[96:99], a[112:115], v[32:35], v[96:99]
  buffer_load_dwordx4 v[28:31], v209, s[16:19], s47 offen offset:0 sc1
  v_mfma_f32_16x16x32_bf16 v[100:103], a[116:119], v[32:35], v[100:103]
  v_readlane_b32 s57, v216, 7
  s_waitcnt lgkmcnt(0)
  v_add_f32 v176, v176, v184
  v_mfma_f32_16x16x32_bf16 v[104:107], a[120:123], v[32:35], v[104:107]
  s_mul_i32 s57, s57, 73728
  s_add_u32 s57, s57, s55
  v_add_f32 v177, v177, v185
  v_mfma_f32_16x16x32_bf16 v[108:111], a[124:127], v[32:35], v[108:111]
  s_waitcnt vmcnt(10)
  s_add_u32 s47, s57, 0
  v_add_f32 v178, v178, v186
  v_mfma_f32_16x16x32_bf16 v[96:99], v[224:227], v[36:39], v[96:99]
  buffer_load_dwordx4 v[32:35], v209, s[16:19], s47 offen offset:0 sc1
  v_add_f32 v179, v179, v187
  v_add_f32 v180, v180, v188
  v_mfma_f32_16x16x32_bf16 v[100:103], v[228:231], v[36:39], v[100:103]
  v_add_f32 v181, v181, v189
  v_mfma_f32_16x16x32_bf16 v[104:107], v[232:235], v[36:39], v[104:107]
  v_add_f32 v182, v182, v190
  v_mfma_f32_16x16x32_bf16 v[108:111], v[236:239], v[36:39], v[108:111]
  s_waitcnt vmcnt(10)
  v_add_f32 v183, v183, v191
  v_add_f32 v240, v240, v248
  v_mfma_f32_16x16x32_bf16 v[80:83], a[0:3], v[40:43], 0
  buffer_load_dwordx4 v[36:39], v209, s[16:19], s47 offen offset:1024 sc1
  v_add_f32 v241, v241, v249
  v_mfma_f32_16x16x32_bf16 v[84:87], a[4:7], v[40:43], 0
  v_add_f32 v242, v242, v250
  v_mfma_f32_16x16x32_bf16 v[88:91], a[8:11], v[40:43], 0
  v_add_f32 v243, v243, v251
  v_add_f32 v244, v244, v252
  v_mfma_f32_16x16x32_bf16 v[92:95], a[12:15], v[40:43], 0
  s_waitcnt vmcnt(10)
  v_add_f32 v245, v245, v253
  v_mfma_f32_16x16x32_bf16 v[80:83], a[16:19], v[0:3], v[80:83]
  buffer_load_dwordx4 v[40:43], v209, s[16:19], s47 offen offset:2048 sc1
  v_add_f32 v246, v246, v254
  v_mfma_f32_16x16x32_bf16 v[84:87], a[20:23], v[0:3], v[84:87]
  ds_write_b128 v152, v[96:99] offset:49152
  v_add_f32 v247, v247, v255
  v_add_f32 v176, v176, v240
  v_mfma_f32_16x16x32_bf16 v[88:91], a[24:27], v[0:3], v[88:91]
  ds_write_b128 v153, v[100:103] offset:49152
  v_add_f32 v177, v177, v241
  v_mfma_f32_16x16x32_bf16 v[92:95], a[28:31], v[0:3], v[92:95]
  s_waitcnt vmcnt(10)
  ds_write_b128 v154, v[104:107] offset:49152
  v_add_f32 v178, v178, v242
  v_mfma_f32_16x16x32_bf16 v[80:83], a[32:35], v[4:7], v[80:83]
  buffer_load_dwordx4 v[0:3], v209, s[16:19], s47 offen offset:3072 sc1
  ds_write_b128 v155, v[108:111] offset:49152
  v_add_f32 v179, v179, v243
  v_add_f32 v180, v180, v244
  v_mfma_f32_16x16x32_bf16 v[84:87], a[36:39], v[4:7], v[84:87]
  v_add_f32 v181, v181, v245
  v_mfma_f32_16x16x32_bf16 v[88:91], a[40:43], v[4:7], v[88:91]
  v_add_f32 v182, v182, v246
  v_mfma_f32_16x16x32_bf16 v[92:95], a[44:47], v[4:7], v[92:95]
  s_waitcnt vmcnt(10)
  s_add_u32 s47, s57, 4096
  v_add_f32 v183, v183, v247
  v_cvt_pk_bf16_f32 v168, v176, v177
  v_mfma_f32_16x16x32_bf16 v[80:83], a[48:51], v[8:11], v[80:83]
  buffer_load_dwordx4 v[4:7], v209, s[16:19], s47 offen offset:0 sc1
  v_cvt_pk_bf16_f32 v169, v178, v179
  v_mfma_f32_16x16x32_bf16 v[84:87], a[52:55], v[8:11], v[84:87]
  v_cvt_pk_bf16_f32 v170, v180, v181
  v_mfma_f32_16x16x32_bf16 v[88:91], a[56:59], v[8:11], v[88:91]
  v_cvt_pk_bf16_f32 v171, v182, v183
  v_min_u32 v168, -2, v168
  v_mfma_f32_16x16x32_bf16 v[92:95], a[60:63], v[8:11], v[92:95]
  s_waitcnt vmcnt(10)
  v_min_u32 v169, -2, v169
  v_mfma_f32_16x16x32_bf16 v[80:83], a[64:67], v[12:15], v[80:83]
  buffer_load_dwordx4 v[8:11], v209, s[16:19], s47 offen offset:1024 sc1
  v_min_u32 v170, -2, v170
  v_mfma_f32_16x16x32_bf16 v[84:87], a[68:71], v[12:15], v[84:87]
  v_min_u32 v171, -2, v171
  buffer_store_dwordx4 v[168:171], v209, s[12:15], s50 offen offset:1024 sc1
  v_mfma_f32_16x16x32_bf16 v[88:91], a[72:75], v[12:15], v[88:91]
  v_mfma_f32_16x16x32_bf16 v[92:95], a[76:79], v[12:15], v[92:95]
  s_waitcnt vmcnt(10)
  v_mfma_f32_16x16x32_bf16 v[80:83], a[80:83], v[16:19], v[80:83]
  buffer_load_dwordx4 v[12:15], v209, s[16:19], s47 offen offset:2048 sc1
  v_mfma_f32_16x16x32_bf16 v[84:87], a[84:87], v[16:19], v[84:87]
  v_mfma_f32_16x16x32_bf16 v[88:91], a[88:91], v[16:19], v[88:91]
  v_mfma_f32_16x16x32_bf16 v[92:95], a[92:95], v[16:19], v[92:95]
  s_waitcnt vmcnt(10)
  v_mfma_f32_16x16x32_bf16 v[80:83], a[96:99], v[20:23], v[80:83]
  buffer_load_dwordx4 v[16:19], v209, s[16:19], s47 offen offset:3072 sc1
  v_mfma_f32_16x16x32_bf16 v[84:87], a[100:103], v[20:23], v[84:87]
  v_mfma_f32_16x16x32_bf16 v[88:91], a[104:107], v[20:23], v[88:91]
  v_mfma_f32_16x16x32_bf16 v[92:95], a[108:111], v[20:23], v[92:95]
  s_waitcnt vmcnt(10)
  s_add_u32 s47, s57, 8192
  v_mfma_f32_16x16x32_bf16 v[80:83], a[112:115], v[24:27], v[80:83]
  buffer_load_dwordx4 v[20:23], v209, s[16:19], s47 offen offset:0 sc1
  v_mfma_f32_16x16x32_bf16 v[84:87], a[116:119], v[24:27], v[84:87]
  v_mfma_f32_16x16x32_bf16 v[88:91], a[120:123], v[24:27], v[88:91]
  v_mfma_f32_16x16x32_bf16 v[92:95], a[124:127], v[24:27], v[92:95]
  s_waitcnt vmcnt(10)
  v_mfma_f32_16x16x32_bf16 v[80:83], v[224:227], v[28:31], v[80:83]
  v_mfma_f32_16x16x32_bf16 v[84:87], v[228:231], v[28:31], v[84:87]
  v_mfma_f32_16x16x32_bf16 v[88:91], v[232:235], v[28:31], v[88:91]
  s_mov_b32 s75, 0
  v_mfma_f32_16x16x32_bf16 v[92:95], v[236:239], v[28:31], v[92:95]
  s_waitcnt vmcnt(9)
  v_mfma_f32_16x16x32_bf16 v[96:99], a[0:3], v[32:35], 0
  s_cmp_eq_u32 s68, 1
  s_cselect_b32 s75, 49152, s75
  v_mfma_f32_16x16x32_bf16 v[100:103], a[4:7], v[32:35], 0
  v_mfma_f32_16x16x32_bf16 v[104:107], a[8:11], v[32:35], 0
  s_cmp_eq_u32 s68, 2
  s_cselect_b32 s75, 81920, s75
  v_mfma_f32_16x16x32_bf16 v[108:111], a[12:15], v[32:35], 0
  s_waitcnt vmcnt(8)
  v_mfma_f32_16x16x32_bf16 v[96:99], a[16:19], v[36:39], v[96:99]
  s_cmp_eq_u32 s68, 3
  s_cselect_b32 s75, 98304, s75
  v_mfma_f32_16x16x32_bf16 v[100:103], a[20:23], v[36:39], v[100:103]
  v_add_u32 v152, 81920, v152
  v_mfma_f32_16x16x32_bf16 v[104:107], a[24:27], v[36:39], v[104:107]
  v_add_u32 v156, s75, v156
  ds_write_b128 v152, v[80:83] offset:0
  v_mfma_f32_16x16x32_bf16 v[108:111], a[28:31], v[36:39], v[108:111]
  s_waitcnt vmcnt(7)
  v_add_u32 v153, 81920, v153
  v_mfma_f32_16x16x32_bf16 v[96:99], a[32:35], v[40:43], v[96:99]
  v_xor_b32 v157, 16, v156
  ds_write_b128 v153, v[84:87] offset:0
  v_mfma_f32_16x16x32_bf16 v[100:103], a[36:39], v[40:43], v[100:103]
  v_add_u32 v154, 81920, v154
  v_mfma_f32_16x16x32_bf16 v[104:107], a[40:43], v[40:43], v[104:107]
  s_add_u32 s74, s68, 4
  ds_write_b128 v154, v[88:91] offset:0
  v_mfma_f32_16x16x32_bf16 v[108:111], a[44:47], v[40:43], v[108:111]
  s_waitcnt vmcnt(6)
  v_add_u32 v155, 81920, v155
  v_mfma_f32_16x16x32_bf16 v[96:99], a[48:51], v[0:3], v[96:99]
  v_readlane_b32 s82, v216, s74
  ds_write_b128 v155, v[92:95] offset:0
  v_mfma_f32_16x16x32_bf16 v[100:103], a[52:55], v[0:3], v[100:103]
  v_mfma_f32_16x16x32_bf16 v[104:107], a[56:59], v[0:3], v[104:107]
  s_lshl_b32 s82, s82, 14
  v_mfma_f32_16x16x32_bf16 v[108:111], a[60:63], v[0:3], v[108:111]
  s_waitcnt vmcnt(5)
  v_mfma_f32_16x16x32_bf16 v[96:99], a[64:67], v[4:7], v[96:99]
  s_add_u32 s83, s82, 8192
  v_mfma_f32_16x16x32_bf16 v[100:103], a[68:71], v[4:7], v[100:103]
  v_mfma_f32_16x16x32_bf16 v[104:107], a[72:75], v[4:7], v[104:107]
  buffer_load_dwordx4 v[164:167], v209, s[12:15], s49 offen offset:0 sc1
  v_mfma_f32_16x16x32_bf16 v[108:111], a[76:79], v[4:7], v[108:111]
  s_waitcnt vmcnt(5)
  buffer_load_dwordx4 v[168:171], v209, s[12:15], s49 offen offset:1024 sc1
  v_mfma_f32_16x16x32_bf16 v[96:99], a[80:83], v[8:11], v[96:99]
  v_mfma_f32_16x16x32_bf16 v[100:103], a[84:87], v[8:11], v[100:103]
  v_mfma_f32_16x16x32_bf16 v[104:107], a[88:91], v[8:11], v[104:107]
  v_mfma_f32_16x16x32_bf16 v[108:111], a[92:95], v[8:11], v[108:111]
  s_waitcnt vmcnt(4)
  v_mfma_f32_16x16x32_bf16 v[96:99], a[96:99], v[12:15], v[96:99]
  v_mfma_f32_16x16x32_bf16 v[100:103], a[100:103], v[12:15], v[100:103]
  v_mfma_f32_16x16x32_bf16 v[104:107], a[104:107], v[12:15], v[104:107]
  v_mfma_f32_16x16x32_bf16 v[108:111], a[108:111], v[12:15], v[108:111]
  s_waitcnt vmcnt(3)
  v_mfma_f32_16x16x32_bf16 v[96:99], a[112:115], v[16:19], v[96:99]
  v_mfma_f32_16x16x32_bf16 v[100:103], a[116:119], v[16:19], v[100:103]
  v_mfma_f32_16x16x32_bf16 v[104:107], a[120:123], v[16:19], v[104:107]
  v_mfma_f32_16x16x32_bf16 v[108:111], a[124:127], v[16:19], v[108:111]
  s_waitcnt vmcnt(2)
  v_mfma_f32_16x16x32_bf16 v[96:99], v[224:227], v[20:23], v[96:99]
  v_mfma_f32_16x16x32_bf16 v[100:103], v[228:231], v[20:23], v[100:103]
  v_mfma_f32_16x16x32_bf16 v[104:107], v[232:235], v[20:23], v[104:107]
  v_mfma_f32_16x16x32_bf16 v[108:111], v[236:239], v[20:23], v[108:111]
  s_nop 4
  ds_write_b128 v152, v[96:99] offset:16384
  ds_write_b128 v153, v[100:103] offset:16384
  ds_write_b128 v154, v[104:107] offset:16384
  ds_write_b128 v155, v[108:111] offset:16384
  s_waitcnt lgkmcnt(0)
  s_barrier
  ds_read_b128 v[0:3], v156 offset:0
  ds_read_b128 v[4:7], v157 offset:0
  ds_read_b128 v[8:11], v156 offset:4096
  ds_read_b128 v[12:15], v157 offset:4096
  ds_read_b128 v[16:19], v156 offset:8192
  ds_read_b128 v[20:23], v157 offset:8192
  ds_read_b128 v[24:27], v156 offset:12288
  ds_read_b128 v[28:31], v157 offset:12288
  ds_read_b128 v[32:35], v156 offset:2048
  ds_read_b128 v[36:39], v157 offset:2048
  ds_read_b128 v[40:43], v156 offset:6144
  ds_read_b128 v[44:47], v157 offset:6144
  ds_read_b128 v[48:51], v156 offset:10240
  ds_read_b128 v[52:55], v157 offset:10240
  ds_read_b128 v[56:59], v156 offset:14336
  ds_read_b128 v[60:63], v157 offset:14336
  s_waitcnt vmcnt(0)
  v_max3_u32 v160, v164, v165, v166
  v_max3_u32 v160, v167, v168, v160
  v_max3_u32 v160, v169, v170, v160
  v_max_u32 v160, v171, v160
  v_cmp_eq_u32 vcc, -1, v160
  s_cbranch_vccnz L_inq
L_inq_ret:
  v_lshlrev_b32 v176, 16, v164
  v_and_b32 v177, 0xffff0000, v164
  v_lshlrev_b32 v178, 16, v165
  v_and_b32 v179, 0xffff0000, v165
  v_lshlrev_b32 v180, 16, v166
  v_and_b32 v181, 0xffff0000, v166
  v_lshlrev_b32 v182, 16, v167
  v_and_b32 v183, 0xffff0000, v167
  v_lshlrev_b32 v184, 16, v168
  v_and_b32 v185, 0xffff0000, v168
  v_lshlrev_b32 v186, 16, v169
  v_and_b32 v187, 0xffff0000, v169
  v_lshlrev_b32 v188, 16, v170
  v_and_b32 v189, 0xffff0000, v170
  v_lshlrev_b32 v190, 16, v171
  v_and_b32 v191, 0xffff0000, v171
  s_waitcnt lgkmcnt(8)
  v_pk_add_f32 v[0:1], v[0:1], v[8:9]
  v_pk_add_f32 v[2:3], v[2:3], v[10:11]
  v_pk_add_f32 v[4:5], v[4:5], v[12:13]
  v_pk_add_f32 v[6:7], v[6:7], v[14:15]
  v_pk_add_f32 v[16:17], v[16:17], v[24:25]
  v_pk_add_f32 v[18:19], v[18:19], v[26:27]
  v_pk_add_f32 v[20:21], v[20:21], v[28:29]
  v_pk_add_f32 v[22:23], v[22:23], v[30:31]
  v_pk_add_f32 v[0:1], v[0:1], v[176:177]
  v_pk_add_f32 v[2:3], v[2:3], v[178:179]
  v_pk_add_f32 v[4:5], v[4:5], v[180:181]
  v_pk_add_f32 v[6:7], v[6:7], v[182:183]
  v_pk_add_f32 v[0:1], v[0:1], v[16:17]
  v_pk_add_f32 v[2:3], v[2:3], v[18:19]
  v_pk_add_f32 v[4:5], v[4:5], v[20:21]
  v_pk_add_f32 v[6:7], v[6:7], v[22:23]
  v_cvt_pk_bf16_f32 v8, v0, v1
  v_cvt_pk_bf16_f32 v9, v2, v3
  v_cvt_pk_bf16_f32 v10, v4, v5
  v_cvt_pk_bf16_f32 v11, v6, v7
  buffer_store_dwordx4 v[8:11], v158, s[28:31], s82 offen sc1
  s_waitcnt lgkmcnt(0)
  v_pk_add_f32 v[32:33], v[32:33], v[40:41]
  v_pk_add_f32 v[34:35], v[34:35], v[42:43]
  v_pk_add_f32 v[36:37], v[36:37], v[44:45]
  v_pk_add_f32 v[38:39], v[38:39], v[46:47]
  v_pk_add_f32 v[48:49], v[48:49], v[56:57]
  v_pk_add_f32 v[50:51], v[50:51], v[58:59]
  v_pk_add_f32 v[52:53], v[52:53], v[60:61]
  v_pk_add_f32 v[54:55], v[54:55], v[62:63]
  v_pk_add_f32 v[32:33], v[32:33], v[184:185]
  v_pk_add_f32 v[34:35], v[34:35], v[186:187]
  v_pk_add_f32 v[36:37], v[36:37], v[188:189]
  v_pk_add_f32 v[38:39], v[38:39], v[190:191]
  v_pk_add_f32 v[32:33], v[32:33], v[48:49]
  v_pk_add_f32 v[34:35], v[34:35], v[50:51]
  v_pk_add_f32 v[36:37], v[36:37], v[52:53]
  v_pk_add_f32 v[38:39], v[38:39], v[54:55]
  v_cvt_pk_bf16_f32 v40, v32, v33
  v_cvt_pk_bf16_f32 v41, v34, v35
  v_cvt_pk_bf16_f32 v42, v36, v37
  v_cvt_pk_bf16_f32 v43, v38, v39
  buffer_store_dwordx4 v[40:43], v158, s[28:31], s83 offen sc1
L_join:
L_done:
  s_endpgm
L_rdyf:
  s_nop 7
  s_mov_b32 s89, 200000
L_rdylf:
  v_lshlrev_b32 v213, 2, v208
  buffer_load_dword v213, v213, s[64:67], 0 offen sc1
  s_waitcnt vmcnt(0)
  v_cmp_eq_u32 s[100:101], 0, v213
  s_and_b32 s101, s101, 0xffff
  s_or_b32 s88, s100, s101
  s_cbranch_scc0 L_rdyf_ret
  s_sleep 4
  s_sub_u32 s89, s89, 1
  s_cmp_lg_u32 s89, 0
  s_cbranch_scc1 L_rdylf
  s_nop 1
  s_branch L_rdyf_ret
L_gf:
  s_nop 7
  s_mov_b32 s73, 200000
L_glf:
  buffer_load_dword v240, v196, s[32:35], 0 offen sc1
  buffer_load_dword v244, v197, s[32:35], 0 offen sc1
  buffer_load_dword v248, v198, s[32:35], 0 offen sc1
  s_waitcnt vmcnt(0)
  v_min_u32 v213, v240, v244
  v_min_u32 v213, v248, v213
  v_cmp_eq_u32 vcc, 0, v213
  s_cbranch_vccz L_gf_ret
  s_sleep 4
  s_sub_u32 s73, s73, 1
  s_cmp_lg_u32 s73, 0
  s_cbranch_scc1 L_glf
  s_nop 1
  s_branch L_gf_ret
L_thif:
  s_nop 7
  s_waitcnt vmcnt(15)
  v_cmp_gt_u32 vcc, v207, v213
  s_and_b32 s73, vcc_lo, 3
  s_cbranch_scc0 L_gotf0
  s_waitcnt vmcnt(0)
  s_lshl_b32 s3, s43, 10
  buffer_atomic_add v211, v210, s[60:63], s3 offen sc1
  s_lshl_b32 s3, s44, 10
  buffer_atomic_add v211, v210, s[60:63], s3 offen sc1
  s_lshl_b32 s3, s45, 10
  buffer_atomic_add v211, v210, s[60:63], s3 offen sc1
  s_lshl_b32 s3, s46, 10
  buffer_atomic_add v211, v210, s[60:63], s3 offen sc1
  v_mov_b32 v210, 1073741824
  v_mov_b32 v221, 1073741824
  s_mov_b32 s72, 200000
L_pollf0:
  v_cmp_gt_u32 vcc, v207, v215
  s_and_b32 s73, vcc_lo, 3
  s_cbranch_scc0 L_gotf0
  v_mov_b32 v215, 0
  buffer_atomic_add v215, v214, s[60:63], 0 offen sc0 sc1
  s_waitcnt vmcnt(0)
  s_sub_u32 s72, s72, 1
  s_cmp_lg_u32 s72, 0
  s_cbranch_scc1 L_pollf0
L_gotf0:
  s_and_b32 s54, vcc_lo, 0xff
  s_sub_u32 s56, s56, 1073741824
  s_sub_u32 s57, s57, 1073741824
  s_add_u32 s47, s56, 0
  buffer_load_dwordx4 v[0:3], v209, s[16:19], s47 offen offset:0 sc1
  buffer_load_dwordx4 v[4:7], v209, s[16:19], s47 offen offset:1024 sc1
  buffer_load_dword v213, v209, s[60:63], s51 offen
  buffer_load_dwordx4 v[8:11], v209, s[16:19], s47 offen offset:2048 sc1
  buffer_load_dword v213, v209, s[60:63], s51 offen
  buffer_load_dword v213, v209, s[60:63], s51 offen
  buffer_load_dwordx4 v[12:15], v209, s[16:19], s47 offen offset:3072 sc1
  s_add_u32 s47, s56, 4096
  buffer_load_dwordx4 v[16:19], v209, s[16:19], s47 offen offset:0 sc1
  buffer_load_dwordx4 v[20:23], v209, s[16:19], s47 offen offset:1024 sc1
  buffer_load_dword v213, v209, s[60:63], s51 offen
  buffer_load_dwordx4 v[24:27], v209, s[16:19], s47 offen offset:2048 sc1
  buffer_load_dword v213, v209, s[60:63], s51 offen
  buffer_load_dwordx4 v[28:31], v209, s[16:19], s47 offen offset:3072 sc1
  s_add_u32 s47, s56, 8192
  buffer_load_dwordx4 v[32:35], v209, s[16:19], s47 offen offset:0 sc1
  s_add_u32 s47, s57, 0
  buffer_load_dwordx4 v[36:39], v209, s[16:19], s47 offen offset:0 sc1
  buffer_load_dwordx4 v[40:43], v209, s[16:19], s47 offen offset:1024 sc1
  buffer_load_dwordx4 v[44:47], v209, s[16:19], s47 offen offset:2048 sc1
  buffer_load_dwordx4 v[48:51], v209, s[16:19], s47 offen offset:3072 sc1
  buffer_load_dword v213, v209, s[60:63], s51 offen
  buffer_load_dword v213, v209, s[60:63], s51 offen
  s_nop 1
  s_branch L_thif_ret
L_ckf1:
  s_nop 7
  v_mov_b32 v215, 0
  buffer_atomic_add v215, v214, s[60:63], 0 offen sc0 sc1
  s_waitcnt vmcnt(0)
  s_lshl_b32 s3, s44, 10
  buffer_atomic_add v211, v210, s[60:63], s3 offen sc1
  s_lshl_b32 s3, s45, 10
  buffer_atomic_add v211, v210, s[60:63], s3 offen sc1
  s_lshl_b32 s3, s46, 10
  buffer_atomic_add v211, v210, s[60:63], s3 offen sc1
  v_mov_b32 v210, 1073741824
  v_mov_b32 v221, 1073741824
  s_mov_b32 s72, 200000
L_pollf1:
  v_cmp_gt_u32 vcc, v207, v215
  s_and_b32 s73, vcc_lo, 12
  s_cbranch_scc0 L_gotf1
  v_mov_b32 v215, 0
  buffer_atomic_add v215, v214, s[60:63], 0 offen sc0 sc1
  s_waitcnt vmcnt(0)
  s_sub_u32 s72, s72, 1
  s_cmp_lg_u32 s72, 0
  s_cbranch_scc1 L_pollf1
L_gotf1:
  s_and_b32 s54, vcc_lo, 0xff
  s_nop 1
  s_branch L_ckf1_ret
L_ckf2:
  s_nop 7
  v_mov_b32 v172, 0
  buffer_atomic_add v172, v214, s[60:63], 0 offen sc0 sc1
  s_waitcnt vmcnt(0)
  s_mov_b32 s72, 200000
L_pollf2:
  v_cmp_gt_u32 vcc, v207, v172
  s_and_b32 s73, vcc_lo, 48
  s_cbranch_scc0 L_gotf2
  v_mov_b32 v172, 0
  buffer_atomic_add v172, v214, s[60:63], 0 offen sc0 sc1
  s_waitcnt vmcnt(0)
  s_sub_u32 s72, s72, 1
  s_cmp_lg_u32 s72, 0
  s_cbranch_scc1 L_pollf2
L_gotf2:
  s_and_b32 s54, vcc_lo, 0xff
  s_nop 1
  s_branch L_ckf2_ret
L_ckf3:
  s_nop 7
  v_mov_b32 v173, 0
  buffer_atomic_add v173, v214, s[60:63], 0 offen sc0 sc1
  s_waitcnt vmcnt(0)
  s_mov_b32 s72, 200000
L_pollf3:
  v_cmp_gt_u32 vcc, v207, v173
  s_and_b32 s73, vcc_lo, 192
  s_cbranch_scc0 L_gotf3
  v_mov_b32 v173, 0
  buffer_atomic_add v173, v214, s[60:63], 0 offen sc0 sc1
  s_waitcnt vmcnt(0)
  s_sub_u32 s72, s72, 1
  s_cmp_lg_u32 s72, 0
  s_cbranch_scc1 L_pollf3
L_gotf3:
  s_and_b32 s54, vcc_lo, 0xff
  s_nop 1
  s_branch L_ckf3_ret
L_inf:
  s_nop 7
  s_mov_b32 s73, 200000
L_inlf:
  buffer_load_dwordx4 v[164:167], v209, s[12:15], s49 offen offset:0 sc1
  buffer_load_dwordx4 v[168:171], v209, s[12:15], s49 offen offset:1024 sc1
  s_waitcnt vmcnt(0)
  v_max3_u32 v160, v164, v165, v166
  v_max3_u32 v160, v167, v168, v160
  v_max3_u32 v160, v169, v170, v160
  v_max_u32 v160, v171, v160
  v_cmp_eq_u32 vcc, -1, v160
  s_cbranch_vccz L_inf_ret
  s_sub_u32 s73, s73, 1
  s_cmp_lg_u32 s73, 0
  s_cbranch_scc1 L_inlf
  s_nop 1
  s_branch L_inf_ret
L_rdyq:
  s_nop 7
  s_mov_b32 s89, 200000
L_rdylq:
  v_lshlrev_b32 v213, 2, v208
  buffer_load_dword v213, v213, s[64:67], 0 offen sc1
  s_waitcnt vmcnt(0)
  v_cmp_eq_u32 s[100:101], 0, v213
  s_and_b32 s101, s101, 0xffff
  s_or_b32 s88, s100, s101
  s_cbranch_scc0 L_rdyq_ret
  s_sleep 4
  s_sub_u32 s89, s89, 1
  s_cmp_lg_u32 s89, 0
  s_cbranch_scc1 L_rdylq
  s_nop 1
  s_branch L_rdyq_ret
L_gq:
  s_nop 7
  s_mov_b32 s73, 200000
L_glq:
  v_and_b32 v198, 15, v208
  v_lshrrev_b32 v167, 5, v208
  v_lshlrev_b32 v198, 3, v198
  v_lshl_add_u32 v198, v167, 7, v198
  s_lshr_b32 s75, s46, 3
  v_add_u32 v198, s75, v198
  v_add_u32 v167, 0, v198
  v_min_u32 v167, 16376, v167
  buffer_load_dwordx2 v[188:189], v167, s[32:35], 0 offen sc1
  v_add_u32 v167, 256, v198
  v_min_u32 v167, 16376, v167
  buffer_load_dwordx2 v[196:197], v167, s[32:35], 0 offen sc1
  v_add_u32 v167, 512, v198
  v_min_u32 v167, 16376, v167
  buffer_load_dwordx2 v[222:223], v167, s[32:35], 0 offen sc1
  s_waitcnt vmcnt(0)
  v_min_u32 v213, v188, v196
  v_min_u32 v213, v222, v213
  v_cmp_eq_u32 vcc, 0, v213
  s_cbranch_vccz L_gq_ret
  s_sleep 4
  s_sub_u32 s73, s73, 1
  s_cmp_lg_u32 s73, 0
  s_cbranch_scc1 L_glq
  s_nop 1
  s_branch L_gq_ret
L_thiq:
  s_nop 7
  s_waitcnt vmcnt(0)
  s_add_u32 s3, s46, 4096
  buffer_atomic_add v211, v210, s[60:63], s3 offen sc1
  s_add_u32 s3, s46, 5120
  buffer_atomic_add v211, v210, s[60:63], s3 offen sc1
  v_mov_b32 v210, 1073741824
  v_mov_b32 v221, 1073741824
  s_mov_b32 s72, 200000
L_pollq0:
  v_cmp_gt_u32 vcc, v207, v215
  s_and_b32 s73, vcc_lo, 3
  s_cbranch_scc0 L_gotq0
  v_mov_b32 v215, 0
  buffer_atomic_add v215, v214, s[60:63], 0 offen sc0 sc1
  s_waitcnt vmcnt(0)
  s_sub_u32 s72, s72, 1
  s_cmp_lg_u32 s72, 0
  s_cbranch_scc1 L_pollq0
L_gotq0:
  s_and_b32 s54, vcc_lo, 0xff
  s_sub_u32 s56, s56, 1073741824
  s_sub_u32 s57, s57, 1073741824
  s_add_u32 s47, s56, 0
  buffer_load_dwordx4 v[0:3], v209, s[16:19], s47 offen offset:0 sc1
  buffer_load_dwordx4 v[4:7], v209, s[16:19], s47 offen offset:1024 sc1
  buffer_load_dwordx4 v[8:11], v209, s[16:19], s47 offen offset:2048 sc1
  buffer_load_dwordx4 v[12:15], v209, s[16:19], s47 offen offset:3072 sc1
  s_add_u32 s47, s56, 4096
  buffer_load_dwordx4 v[16:19], v209, s[16:19], s47 offen offset:0 sc1
  buffer_load_dwordx4 v[20:23], v209, s[16:19], s47 offen offset:1024 sc1
  buffer_load_dwordx4 v[24:27], v209, s[16:19], s47 offen offset:2048 sc1
  buffer_load_dwordx4 v[28:31], v209, s[16:19], s47 offen offset:3072 sc1
  s_add_u32 s47, s56, 8192
  buffer_load_dwordx4 v[32:35], v209, s[16:19], s47 offen offset:0 sc1
  s_add_u32 s47, s57, 0
  buffer_load_dwordx4 v[36:39], v209, s[16:19], s47 offen offset:0 sc1
  buffer_load_dword v213, v209, s[60:63], s51 offen
  buffer_load_dwordx4 v[40:43], v209, s[16:19], s47 offen offset:1024 sc1
  buffer_load_dword v213, v209, s[60:63], s51 offen
  buffer_load_dword v213, v209, s[60:63], s51 offen
  s_nop 1
  s_branch L_thiq_ret
L_ckq1:
  s_nop 7
  v_mov_b32 v215, 0
  buffer_atomic_add v215, v214, s[60:63], 0 offen sc0 sc1
  s_waitcnt vmcnt(0)
  s_add_u32 s3, s46, 4096
  buffer_atomic_add v211, v210, s[60:63], s3 offen sc1
  s_add_u32 s3, s46, 5120
  buffer_atomic_add v211, v210, s[60:63], s3 offen sc1
  v_mov_b32 v210, 1073741824
  v_mov_b32 v221, 1073741824
  s_mov_b32 s72, 200000
L_pollq1:
  v_cmp_gt_u32 vcc, v207, v215
  s_and_b32 s73, vcc_lo, 12
  s_cbranch_scc0 L_gotq1
  v_mov_b32 v215, 0
  buffer_atomic_add v215, v214, s[60:63], 0 offen sc0 sc1
  s_waitcnt vmcnt(0)
  s_sub_u32 s72, s72, 1
  s_cmp_lg_u32 s72, 0
  s_cbranch_scc1 L_pollq1
L_gotq1:
  s_and_b32 s54, vcc_lo, 0xff
  s_nop 1
  s_branch L_ckq1_ret
L_ckq2:
  s_nop 7
  v_mov_b32 v172, 0
  buffer_atomic_add v172, v214, s[60:63], 0 offen sc0 sc1
  s_waitcnt vmcnt(0)
  s_mov_b32 s72, 200000
L_pollq2:
  v_cmp_gt_u32 vcc, v207, v172
  s_and_b32 s73, vcc_lo, 48
  s_cbranch_scc0 L_gotq2
  v_mov_b32 v172, 0
  buffer_atomic_add v172, v214, s[60:63], 0 offen sc0 sc1
  s_waitcnt vmcnt(0)
  s_sub_u32 s72, s72, 1
  s_cmp_lg_u32 s72, 0
  s_cbranch_scc1 L_pollq2
L_gotq2:
  s_and_b32 s54, vcc_lo, 0xff
  s_nop 1
  s_branch L_ckq2_ret
L_ckq3:
  s_nop 7
  v_mov_b32 v173, 0
  buffer_atomic_add v173, v214, s[60:63], 0 offen sc0 sc1
  s_waitcnt vmcnt(0)
  s_mov_b32 s72, 200000
L_pollq3:
  v_cmp_gt_u32 vcc, v207, v173
  s_and_b32 s73, vcc_lo, 192
  s_cbranch_scc0 L_gotq3
  v_mov_b32 v173, 0
  buffer_atomic_add v173, v214, s[60:63], 0 offen sc0 sc1
  s_waitcnt vmcnt(0)
  s_sub_u32 s72, s72, 1
  s_cmp_lg_u32 s72, 0
  s_cbranch_scc1 L_pollq3
L_gotq3:
  s_and_b32 s54, vcc_lo, 0xff
  s_nop 1
  s_branch L_ckq3_ret
L_inq:
  s_nop 7
  s_mov_b32 s73, 200000
L_inlq:
  buffer_load_dwordx4 v[164:167], v209, s[12:15], s49 offen offset:0 sc1
  buffer_load_dwordx4 v[168:171], v209, s[12:15], s49 offen offset:1024 sc1
  s_waitcnt vmcnt(0)
  v_max3_u32 v160, v164, v165, v166
  v_max3_u32 v160, v167, v168, v160
  v_max3_u32 v160, v169, v170, v160
  v_max_u32 v160, v171, v160
  v_cmp_eq_u32 vcc, -1, v160
  s_cbranch_vccz L_inq_ret
  s_sub_u32 s73, s73, 1
  s_cmp_lg_u32 s73, 0
  s_cbranch_scc1 L_inlq
  s_nop 1
  s_branch L_inq_ret
.fill 1280, 4, 0xbf800000
.section .rodata,"a"
.p2align 6
.amdhsa_kernel gated_mix__sliding_local_dilated__glu_gated_glu__prompt_kernel
  .amdhsa_next_free_vgpr 512
  .amdhsa_next_free_sgpr 102
  .amdhsa_accum_offset 256
  .amdhsa_group_segment_fixed_size 0
  .amdhsa_kernarg_size 88
  .amdhsa_user_sgpr_count 2
  .amdhsa_user_sgpr_kernarg_segment_ptr 1
  .amdhsa_system_sgpr_workgroup_id_x 1
.end_amdhsa_kernel
```
